```python
import torch

def _softmax(x, axis=-1):
    return torch.softmax(x, dim=axis)
def _gelu(x):
    return torch.nn.functional.gelu(x, approximate="tanh")
def _silu(x):
    return torch.nn.functional.silu(x)
def _sigmoid(x):
    return torch.sigmoid(x)
def _layernorm(x, axis=-1, eps=1e-5):
    m = x.mean(dim=axis, keepdim=True)
    v = x.var(dim=axis, keepdim=True, unbiased=False)
    return (x - m) / torch.sqrt(v + eps)
def _scatter_add(tgt, idx, src, axis=0):
    return tgt.clone().index_add_(axis, idx, src)
def _segment_sum(src, seg, n):
    out = torch.zeros((n,) + src.shape[1:], dtype=src.dtype)
    return out.index_add_(0, seg, src)
def _pad(x, pw):
    flat = tuple(v for pair in reversed(pw) for v in pair)
    return torch.nn.functional.pad(x, flat)

kernel_name = 'parallel_sum__spectral_gfnet__glu_gated_bilinear__prompt'

def setup_inputs():

    _w = (lambda a: (lambda t: t.to(torch.bfloat16) if t.is_floating_point() else t)(torch.as_tensor(a)))
    def _A_setup():
        B, S, D = 1, 2048, 640
        Df = D // 2 + 1
        return {
            "x": _w((lambda *s: torch.randn(*s, dtype=torch.bfloat16) * 0.05)(B, S, D)),
            "w_r": _w((lambda *s: torch.randn(*s, dtype=torch.bfloat16) * 0.4)(S, Df) * 0.02),
            "w_i": _w((lambda *s: torch.randn(*s, dtype=torch.bfloat16) * 0.4)(S, Df) * 0.02),
        }
    _A_in = _A_setup()

    def _B_setup():
        B, S, D, F = 1, 2048, 640, 1728
        return {
            "x": _w((lambda *s: torch.randn(*s, dtype=torch.bfloat16) * 0.05)(B, S, D)),
            "w_gate": _w((lambda *s: torch.randn(*s, dtype=torch.bfloat16) * 0.2)(D, F) * (D ** -0.5)),
            "w_up": _w((lambda *s: torch.randn(*s, dtype=torch.bfloat16) * 0.2)(D, F) * (D ** -0.5)),
            "w_down": _w((lambda *s: torch.randn(*s, dtype=torch.bfloat16) * 0.2)(F, D) * (F ** -0.5)),
        }
    _B_in = _B_setup()

    return {
        "A_x": _A_in["x"],
        "A_w_r": _A_in["w_r"],
        "A_w_i": _A_in["w_i"],
        "B_x": _B_in["x"],
        "B_w_gate": _B_in["w_gate"],
        "B_w_up": _B_in["w_up"],
        "B_w_down": _B_in["w_down"],
    }

def reference(A_x, A_w_r, A_w_i, B_x, B_w_gate, B_w_up, B_w_down):
    def _A_ref(x, w_r, w_i):
        B, S, D = x.shape
        X = (lambda x, axes=(-2,-1): torch.fft.rfft2(x.float(), dim=axes))(x, axes=(-2, -1))
        W = w_r + 1j * w_i
        X = X * W
        y = (lambda x, s, axes=(-2,-1): torch.fft.irfft2(x, s=s, dim=axes).to(torch.bfloat16))(X, (S, D), axes=(-2, -1))
        return y

    def _B_ref(x, w_gate, w_up, w_down):
        g = torch.einsum("bsd,df->bsf", x, w_gate)
        u = torch.einsum("bsd,df->bsf", x, w_up)
        h = g * u
        return torch.einsum("bsf,fd->bsd", h, w_down)

    x = A_x
    xn = _layernorm(x, axis=-1)
    return x + _A_ref(xn, A_w_r, A_w_i) + _B_ref(xn, B_w_gate, B_w_up, B_w_down)
```

```asm
; @launch kernel=k1_kernel grid=(256,1,1) block=(512,1,1) lds=163840
; @launch kernel=k2c_kernel grid=(256,1,1) block=(256,1,1) lds=131072
.amdgcn_target "amdgcn-amd-amdhsa--gfx950"
.text
.globl k1_kernel
.p2align 8
.type k1_kernel,@function
k1_kernel:
    s_cmp_ge_u32 s2, 256
    s_cbranch_scc1 L_k1_exit
    s_load_dwordx2 s[4:5], s[0:1], 0
    s_load_dwordx4 s[64:67], s[0:1], 32
    s_load_dwordx2 s[6:7], s[0:1], 72
    s_load_dwordx4 s[52:55], s[0:1], 8
    s_load_dwordx2 s[56:57], s[0:1], 48
    s_load_dwordx2 s[50:51], s[0:1], 64
    v_lshrrev_b32 v4, 6, v0
    v_and_b32 v1, 63, v0
    v_readfirstlane_b32 s28, v4
    v_lshrrev_b32 v2, 3, v1
    v_and_b32 v3, 7, v1
    s_and_b32 s40, s2, 1
    s_lshl_b32 s40, s40, 2
    s_lshr_b32 s41, s2, 3
    s_and_b32 s42, s41, 3
    s_add_u32 s29, s40, s42
    s_and_b32 s40, s2, 7
    s_lshr_b32 s40, s40, 1
    s_lshl_b32 s40, s40, 3
    s_lshr_b32 s41, s41, 2
    s_add_u32 s30, s40, s41
    s_cmp_ge_u32 s28, 3
    s_cbranch_scc1 L_cpf4E
    s_getpc_b64 s[76:77]
L_cpfE:
    s_cmp_eq_u32 s28, 1
    s_cbranch_scc1 L_cpf1E
    s_cmp_eq_u32 s28, 2
    s_cbranch_scc1 L_cpf2E
    s_add_u32 s76, s76, k1_kernel-L_cpfE
    s_addc_u32 s77, s77, -1
    s_mov_b32 s78, k1_kernel_end-k1_kernel
    s_branch L_cpf3E
L_cpf1E:
    s_add_u32 s76, s76, k2c_kernel-L_cpfE
    s_addc_u32 s77, s77, 0
    s_mov_b32 s78, k2c_kernel_end-k2c_kernel
    s_branch L_cpf3E
L_cpf2E:
    s_getpc_b64 s[76:77]
    s_add_u32 s76, s76, fft_table@rel32@lo+4
    s_addc_u32 s77, s77, fft_table@rel32@hi+12
    s_mov_b32 s78, 23040
L_cpf3E:
    s_mov_b32 s79, 0x00020000
    s_lshr_b32 s40, s2, 3
    s_and_b32 s40, s40, 7
    s_lshl_b32 s40, s40, 13
    v_lshlrev_b32 v24, 7, v1
    v_add_u32 v24, s40, v24
    buffer_load_dword v20, v24, s[76:79], 0 offen
L_cpf4E:
    s_getpc_b64 s[68:69]
    s_add_u32 s68, s68, ft_table@rel32@lo+4
    s_addc_u32 s69, s69, ft_table@rel32@hi+12
    s_cmp_lt_u32 s28, 4
    s_cbranch_scc1 L_k1_mfma
    s_cmp_ge_u32 s30, 27
    s_cbranch_scc1 L_k1_load_dft
    s_sub_u32 s31, s28, 4
    s_lshl_b32 s40, s31, 4
    v_add_u32 v4, s40, v2
    v_mul_u32_u24 v4, 3456, v4
    s_lshl_b32 s40, s30, 7
    v_add_u32 v4, s40, v4
    v_bfe_u32 v7, v2, 1, 1
    v_lshlrev_b32 v7, 1, v7
    v_xor_b32 v7, v7, v3
    v_lshlrev_b32 v6, 4, v7
    v_add_u32 v16, v4, v6
    v_xor_b32 v7, 4, v7
    v_lshlrev_b32 v7, 4, v7
    v_add_u32 v17, v4, v7
    v_add_u32 v17, 26624, v17
    s_lshl_b32 s36, s31, 13
    s_lshl_b32 s37, s31, 12
    s_add_u32 s37, s37, 32768
    s_lshr_b32 s88, s29, 1
    s_and_b32 s88, s88, 1
    s_lshl_b32 s88, s88, 10
    s_and_b32 s41, s29, 1
    s_lshl_b32 s41, s41, 8
    s_add_u32 s88, s88, s41
    s_lshr_b32 s41, s29, 2
    s_lshl_b32 s41, s41, 5
    s_add_u32 s88, s88, s41
    s_lshl_b32 s41, s31, 3
    s_add_u32 s40, s88, s41
    v_lshrrev_b32 v4, 2, v2
    v_lshlrev_b32 v4, 3, v4
    v_and_b32 v5, 3, v2
    v_add_u32 v4, v4, v5
    v_lshlrev_b32 v4, 6, v4
    v_add_u32 v4, s40, v4
    v_mul_u32_u24 v4, 1280, v4
    v_lshrrev_b32 v5, 1, v2
    v_xor_b32 v5, v5, v3
    v_lshlrev_b32 v6, 4, v5
    v_add_u32 v8, v4, v6
    v_xor_b32 v6, 4, v5
    v_lshlrev_b32 v6, 4, v6
    v_add_u32 v6, 256, v6
    v_add_u32 v9, v4, v6
    v_lshlrev_b32 v6, 4, v5
    v_add_u32 v6, 512, v6
    v_add_u32 v10, v4, v6
    v_xor_b32 v6, 4, v5
    v_lshlrev_b32 v6, 4, v6
    v_add_u32 v6, 768, v6
    v_add_u32 v11, v4, v6
    v_lshlrev_b32 v6, 4, v5
    v_add_u32 v6, 5120, v6
    v_add_u32 v12, v4, v6
    v_xor_b32 v6, 4, v5
    v_lshlrev_b32 v6, 4, v6
    v_add_u32 v6, 5376, v6
    v_add_u32 v13, v4, v6
    v_lshlrev_b32 v6, 4, v5
    v_add_u32 v6, 5632, v6
    v_add_u32 v14, v4, v6
    v_xor_b32 v6, 4, v5
    v_lshlrev_b32 v6, 4, v6
    v_add_u32 v6, 5888, v6
    v_add_u32 v15, v4, v6
    s_waitcnt lgkmcnt(0)
    s_mov_b32 s8, s4
    s_mov_b32 s9, s5
    s_mov_b32 s10, 2621440
    s_mov_b32 s11, 0x00020000
    s_cmp_ge_u32 s30, 27
    s_cselect_b32 s12, s68, s64
    s_cselect_b32 s13, s69, s65
    s_mov_b32 s14, 2211840
    s_cselect_b32 s14, 819200, s14
    s_mov_b32 s15, 0x00020000
    s_sub_u32 s16, s66, 2048
    s_subb_u32 s17, s67, 0
    s_mov_b32 s18, 2213888
    s_mov_b32 s19, 0x00020000
    s_mov_b32 s20, s6
    s_mov_b32 s21, s7
    s_mov_b32 s22, 25165824
    s_mov_b32 s23, 0x00020000
    s_mov_b32 s58, s66
    s_mov_b32 s59, s67
    v_mov_b32 v59, 0
    s_cmp_eq_u32 s2, 0
    s_cselect_b32 s89, 1, 0
    s_cmp_eq_u32 s31, 0
    s_cselect_b32 s89, s89, 0
    s_cmp_eq_u32 s89, 1
    s_cbranch_scc0 L_l_nreqG
    s_mov_b32 s40, 19922952
    buffer_load_dwordx2 v[60:61], v59, s[20:23], s40 offen sc1
L_l_nreqG:
    s_mov_b32 s34, 0
    s_add_u32 m0, s37, 0
    s_nop 0
    buffer_load_dwordx4 v16, s[12:15], s34 offen offset:0 lds
    buffer_load_dwordx4 v17, s[12:15], s34 offen offset:1024 lds
    buffer_load_dwordx4 v16, s[16:19], s34 offen offset:2048 lds
    buffer_load_dwordx4 v17, s[16:19], s34 offen offset:3072 lds
    s_mov_b32 s33, 0
    s_add_u32 m0, s36, 0
    s_nop 0
    buffer_load_dwordx4 v8, s[8:11], s33 offen offset:0 lds
    buffer_load_dwordx4 v9, s[8:11], s33 offen offset:1024 lds
    buffer_load_dwordx4 v10, s[8:11], s33 offen offset:2048 lds
    buffer_load_dwordx4 v11, s[8:11], s33 offen offset:3072 lds
    s_add_u32 m0, s36, 4096
    s_nop 0
    buffer_load_dwordx4 v12, s[8:11], s33 offen offset:0 lds
    buffer_load_dwordx4 v13, s[8:11], s33 offen offset:1024 lds
    buffer_load_dwordx4 v14, s[8:11], s33 offen offset:2048 lds
    buffer_load_dwordx4 v15, s[8:11], s33 offen offset:3072 lds
    s_mov_b32 s34, 221184
    s_add_u32 m0, s37, 49152
    s_nop 0
    buffer_load_dwordx4 v16, s[12:15], s34 offen offset:0 lds
    buffer_load_dwordx4 v17, s[12:15], s34 offen offset:1024 lds
    buffer_load_dwordx4 v16, s[16:19], s34 offen offset:2048 lds
    buffer_load_dwordx4 v17, s[16:19], s34 offen offset:3072 lds
    s_mov_b32 s33, 128
    s_add_u32 m0, s36, 49152
    s_nop 0
    buffer_load_dwordx4 v8, s[8:11], s33 offen offset:0 lds
    buffer_load_dwordx4 v9, s[8:11], s33 offen offset:1024 lds
    buffer_load_dwordx4 v10, s[8:11], s33 offen offset:2048 lds
    buffer_load_dwordx4 v11, s[8:11], s33 offen offset:3072 lds
    s_add_u32 m0, s36, 53248
    s_nop 0
    buffer_load_dwordx4 v12, s[8:11], s33 offen offset:0 lds
    buffer_load_dwordx4 v13, s[8:11], s33 offen offset:1024 lds
    buffer_load_dwordx4 v14, s[8:11], s33 offen offset:2048 lds
    buffer_load_dwordx4 v15, s[8:11], s33 offen offset:3072 lds
    s_waitcnt vmcnt(12)
    s_barrier
    s_mov_b32 s34, 442368
    s_add_u32 m0, s37, 98304
    s_nop 0
    buffer_load_dwordx4 v16, s[12:15], s34 offen offset:0 lds
    v_lshrrev_b32 v20, 5, v1
    s_lshl_b32 s40, s31, 1
    v_add_u32 v20, s40, v20
    buffer_load_dwordx4 v17, s[12:15], s34 offen offset:1024 lds
    v_lshrrev_b32 v5, 2, v20
    v_lshlrev_b32 v5, 3, v5
    v_and_b32 v6, 3, v20
    buffer_load_dwordx4 v16, s[16:19], s34 offen offset:2048 lds
    v_add_u32 v5, v5, v6
    v_lshlrev_b32 v5, 6, v5
    s_add_u32 s40, s88, s30
    buffer_load_dwordx4 v17, s[16:19], s34 offen offset:3072 lds
    v_add_u32 v5, s40, v5
    v_mul_u32_u24 v5, 1280, v5
    v_and_b32 v6, 31, v1
    s_mov_b32 s33, 256
    s_add_u32 m0, s36, 98304
    s_nop 0
    buffer_load_dwordx4 v8, s[8:11], s33 offen offset:0 lds
    v_lshlrev_b32 v6, 3, v6
    v_add_u32 v56, v5, v6
    s_mul_i32 s40, s29, 80
    buffer_load_dwordx4 v9, s[8:11], s33 offen offset:1024 lds
    s_and_b32 s41, s31, 1
    s_mul_i32 s41, s41, 40
    s_add_u32 s40, s40, s41
    buffer_load_dwordx4 v10, s[8:11], s33 offen offset:2048 lds
    v_add_u32 v7, s40, v2
    v_mul_u32_u24 v7, 3456, v7
    s_lshl_b32 s40, s30, 7
    buffer_load_dwordx4 v11, s[8:11], s33 offen offset:3072 lds
    v_add_u32 v7, s40, v7
    v_lshlrev_b32 v6, 4, v3
    v_add_u32 v57, v7, v6
    s_add_u32 m0, s36, 102400
    s_nop 0
    buffer_load_dwordx4 v12, s[8:11], s33 offen offset:0 lds
    s_mov_b32 s24, s50
    s_mov_b32 s25, s51
    s_mov_b32 s26, 256
    s_mov_b32 s27, 0x00020000
    s_cmp_eq_u32 s89, 1
    s_cbranch_scc0 L_l_notagG
    v_add_co_u32 v60, vcc, 1, v60
    s_nop 1
    v_addc_co_u32 v61, vcc, 0, v61, vcc
    v_or_b32 v62, v60, v61
    v_cmp_eq_u32 vcc, 0, v62
    s_nop 1
    v_cndmask_b32 v60, v60, 1, vcc
    v_cmp_eq_u32 vcc, 0, v1
    v_mov_b32 v63, 0x7f000000
    s_nop 0
    v_cndmask_b32 v62, v63, v59, vcc
    buffer_store_dwordx2 v[60:61], v62, s[24:27], 0 offen sc1
    v_lshlrev_b32 v62, 7, v1
    v_add_u32 v62, 20512768, v62
    buffer_store_dword v59, v62, s[20:23], 0 offen
    v_lshlrev_b32 v62, 7, v1
    v_add_u32 v62, 20520960, v62
    buffer_store_dword v59, v62, s[20:23], 0 offen
L_l_notagG:
    buffer_load_dwordx4 v13, s[8:11], s33 offen offset:1024 lds
    buffer_load_dwordx4 v14, s[8:11], s33 offen offset:2048 lds
    buffer_load_dwordx4 v15, s[8:11], s33 offen offset:3072 lds
    s_waitcnt vmcnt(12)
    buffer_load_dwordx2 v[24:25], v56, s[8:11], 0 offen offset:0
    buffer_load_dwordx2 v[26:27], v56, s[8:11], 0 offen offset:256
    buffer_load_dwordx2 v[28:29], v56, s[8:11], 0 offen offset:512
    buffer_load_dwordx2 v[30:31], v56, s[8:11], 0 offen offset:768
    buffer_load_dwordx2 v[32:33], v56, s[8:11], 0 offen offset:1024
    s_barrier
    s_mov_b32 s34, 663552
    s_add_u32 m0, s37, 0
    s_nop 0
    buffer_load_dwordx4 v16, s[12:15], s34 offen offset:0 lds
    buffer_load_dwordx4 v17, s[12:15], s34 offen offset:1024 lds
    buffer_load_dwordx4 v16, s[16:19], s34 offen offset:2048 lds
    buffer_load_dwordx4 v17, s[16:19], s34 offen offset:3072 lds
    s_mov_b32 s33, 384
    s_add_u32 m0, s36, 0
    s_nop 0
    buffer_load_dwordx4 v8, s[8:11], s33 offen offset:0 lds
    buffer_load_dwordx4 v9, s[8:11], s33 offen offset:1024 lds
    buffer_load_dwordx4 v10, s[8:11], s33 offen offset:2048 lds
    buffer_load_dwordx4 v11, s[8:11], s33 offen offset:3072 lds
    s_add_u32 m0, s36, 4096
    s_nop 0
    buffer_load_dwordx4 v12, s[8:11], s33 offen offset:0 lds
    buffer_load_dwordx4 v13, s[8:11], s33 offen offset:1024 lds
    buffer_load_dwordx4 v14, s[8:11], s33 offen offset:2048 lds
    buffer_load_dwordx4 v15, s[8:11], s33 offen offset:3072 lds
    s_waitcnt vmcnt(17)
    s_cmp_lt_u32 s31, 2
    s_cselect_b32 s64, s12, s58
    s_cselect_b32 s65, s13, s59
    s_mov_b32 s66, 2211840
    s_mov_b32 s67, 0x00020000
    s_mov_b32 s69, 0
    buffer_load_dwordx4 v[36:39], v57, s[64:67], s69 offen
    s_add_u32 s69, s69, 27648
    buffer_load_dwordx4 v[40:43], v57, s[64:67], s69 offen
    s_add_u32 s69, s69, 27648
    buffer_load_dwordx4 v[44:47], v57, s[64:67], s69 offen
    s_add_u32 s69, s69, 27648
    buffer_load_dwordx4 v[48:51], v57, s[64:67], s69 offen
    s_add_u32 s69, s69, 27648
    buffer_load_dwordx4 v[52:55], v57, s[64:67], s69 offen
    s_add_u32 s69, s69, 27648
    s_barrier
    s_mov_b32 s34, 884736
    s_add_u32 m0, s37, 49152
    s_nop 0
    buffer_load_dwordx4 v16, s[12:15], s34 offen offset:0 lds
    s_cmp_eq_u32 s31, 3
    s_cbranch_scc1 L_l_wp3G
    s_cmp_eq_u32 s31, 2
    s_cbranch_scc1 L_l_v2G
    s_lshl_b32 s40, s2, 1
    s_add_u32 s40, s40, s31
    s_branch L_l_wdG
L_l_v2G:
    s_cmp_lt_u32 s2, 96
    s_cbranch_scc1 L_l_wp2G
    s_add_u32 s40, s2, 416
L_l_wdG:
    s_cmp_lt_u32 s40, 540
    s_cselect_b32 s46, 0, 2
    s_cselect_b32 s42, 2211840, 0
    s_mul_i32 s62, s40, 6554
    s_lshr_b32 s62, s62, 16
    s_mul_i32 s41, s62, 10
    s_sub_u32 s63, s40, s41
    s_mov_b32 s76, s56
    s_mov_b32 s77, s57
    s_mov_b32 s78, s42
    s_mov_b32 s79, 0x00020000
    s_mov_b32 s80, s56
    s_mov_b32 s81, s57
    s_mov_b32 s82, 0
    s_mov_b32 s83, 0x00020000
    s_lshl_b32 s40, s62, 5
    v_add_u32 v58, s40, v2
    v_mul_u32_u24 v58, 1280, v58
    s_lshl_b32 s40, s63, 7
    v_add_u32 v58, s40, v58
    v_lshlrev_b32 v62, 4, v3
    v_add_u32 v58, v58, v62
    s_mov_b32 s85, 10240
    s_branch L_l_rl_setG
L_l_wp2G:
    s_add_u32 s40, s2, 256
    s_branch L_l_wpG
L_l_wp3G:
    s_mov_b32 s40, s2
L_l_wpG:
    s_mov_b32 s46, 1
    s_mul_i32 s62, s40, 5958
    s_lshr_b32 s62, s62, 16
    s_mul_i32 s41, s62, 11
    s_sub_u32 s63, s40, s41
    s_lshl_b32 s63, s63, 5
    s_min_u32 s63, s63, 289
    s_and_b32 s40, s62, 1
    s_lshl_b32 s40, s40, 4
    s_lshr_b32 s41, s62, 4
    s_lshl_b32 s41, s41, 5
    s_add_u32 s40, s40, s41
    s_lshr_b32 s41, s62, 2
    s_and_b32 s41, s41, 3
    s_lshl_b32 s41, s41, 9
    s_add_u32 s40, s40, s41
    s_lshr_b32 s41, s62, 1
    s_and_b32 s41, s41, 1
    s_lshl_b32 s41, s41, 8
    s_add_u32 s40, s40, s41
    v_lshrrev_b32 v58, 4, v1
    v_bfe_u32 v62, v1, 2, 2
    v_lshlrev_b32 v62, 6, v62
    v_add_u32 v58, v58, v62
    v_add_u32 v58, s40, v58
    v_mul_u32_u24 v58, 642, v58
    s_lshl_b32 s40, s63, 1
    v_add_u32 v58, s40, v58
    v_and_b32 v62, 3, v1
    v_lshlrev_b32 v62, 4, v62
    v_add_u32 v58, v58, v62
    s_mov_b32 s76, s52
    s_mov_b32 s77, s53
    s_mov_b32 s78, 1314816
    s_mov_b32 s79, 0x00020000
    s_mov_b32 s80, s54
    s_mov_b32 s81, s55
    s_mov_b32 s82, 1314816
    s_mov_b32 s83, 0x00020000
    s_mov_b32 s85, 2568
L_l_rl_setG:
    s_mov_b32 s84, 0
    buffer_load_dwordx4 v17, s[12:15], s34 offen offset:1024 lds
    buffer_load_dwordx4 v16, s[16:19], s34 offen offset:2048 lds
    buffer_load_dwordx4 v17, s[16:19], s34 offen offset:3072 lds
    s_mov_b32 s33, 512
    s_add_u32 m0, s36, 49152
    s_nop 0
    buffer_load_dwordx4 v8, s[8:11], s33 offen offset:0 lds
    buffer_load_dwordx4 v9, s[8:11], s33 offen offset:1024 lds
    buffer_load_dwordx4 v10, s[8:11], s33 offen offset:2048 lds
    buffer_load_dwordx4 v11, s[8:11], s33 offen offset:3072 lds
    s_add_u32 m0, s36, 53248
    s_nop 0
    buffer_load_dwordx4 v12, s[8:11], s33 offen offset:0 lds
    buffer_load_dwordx4 v13, s[8:11], s33 offen offset:1024 lds
    buffer_load_dwordx4 v14, s[8:11], s33 offen offset:2048 lds
    buffer_load_dwordx4 v15, s[8:11], s33 offen offset:3072 lds
    s_waitcnt vmcnt(17)
    buffer_load_dwordx2 v[96:97], v59, s[24:27], 0 offen sc1
    s_barrier
    s_mov_b32 s34, 1105920
    s_add_u32 m0, s37, 98304
    s_nop 0
    buffer_load_dwordx4 v16, s[12:15], s34 offen offset:0 lds
    s_waitcnt vmcnt(31)
    v_mov_b32 v21, 0
    v_mov_b32 v22, 0
    v_lshlrev_b32 v4, 16, v24
    v_and_b32 v5, 0xffff0000, v24
    v_add_f32 v21, v21, v4
    v_add_f32 v22, v22, v5
    v_lshlrev_b32 v4, 16, v25
    v_and_b32 v5, 0xffff0000, v25
    v_add_f32 v21, v21, v4
    v_add_f32 v22, v22, v5
    buffer_load_dwordx4 v17, s[12:15], s34 offen offset:1024 lds
    v_lshlrev_b32 v4, 16, v26
    v_and_b32 v5, 0xffff0000, v26
    v_add_f32 v21, v21, v4
    v_add_f32 v22, v22, v5
    v_lshlrev_b32 v4, 16, v27
    v_and_b32 v5, 0xffff0000, v27
    v_add_f32 v21, v21, v4
    v_add_f32 v22, v22, v5
    v_lshlrev_b32 v4, 16, v28
    v_and_b32 v5, 0xffff0000, v28
    v_add_f32 v21, v21, v4
    buffer_load_dwordx4 v16, s[16:19], s34 offen offset:2048 lds
    v_add_f32 v22, v22, v5
    v_lshlrev_b32 v4, 16, v29
    v_and_b32 v5, 0xffff0000, v29
    v_add_f32 v21, v21, v4
    v_add_f32 v22, v22, v5
    v_lshlrev_b32 v4, 16, v30
    v_and_b32 v5, 0xffff0000, v30
    v_add_f32 v21, v21, v4
    v_add_f32 v22, v22, v5
    v_lshlrev_b32 v4, 16, v31
    v_and_b32 v5, 0xffff0000, v31
    buffer_load_dwordx4 v17, s[16:19], s34 offen offset:3072 lds
    v_add_f32 v21, v21, v4
    v_add_f32 v22, v22, v5
    v_lshlrev_b32 v4, 16, v32
    v_and_b32 v5, 0xffff0000, v32
    v_add_f32 v21, v21, v4
    v_add_f32 v22, v22, v5
    v_lshlrev_b32 v4, 16, v33
    v_and_b32 v5, 0xffff0000, v33
    v_add_f32 v21, v21, v4
    v_add_f32 v22, v22, v5
    v_add_f32 v21, v21, v22
    s_mov_b32 s33, 640
    s_add_u32 m0, s36, 98304
    s_nop 0
    buffer_load_dwordx4 v8, s[8:11], s33 offen offset:0 lds
    v_add_f32_dpp v21, v21, v21 quad_perm:[1,0,3,2] row_mask:0xf bank_mask:0xf
    s_nop 1
    v_add_f32_dpp v21, v21, v21 quad_perm:[2,3,0,1] row_mask:0xf bank_mask:0xf
    s_nop 1
    v_add_f32_dpp v21, v21, v21 row_half_mirror row_mask:0xf bank_mask:0xf
    s_nop 1
    v_add_f32_dpp v21, v21, v21 row_ror:8 row_mask:0xf bank_mask:0xf
    v_mov_b32 v4, v21
    s_nop 1
    v_permlane16_swap_b32 v21, v4
    v_add_f32 v21, v21, v4
    v_mul_f32 v100, 0x3acccccd, v21
    v_mov_b32 v21, 0
    v_mov_b32 v23, 0
    v_lshlrev_b32 v4, 16, v24
    buffer_load_dwordx4 v9, s[8:11], s33 offen offset:1024 lds
    v_and_b32 v5, 0xffff0000, v24
    v_sub_f32 v4, v4, v100
    v_sub_f32 v5, v5, v100
    v_fmac_f32 v21, v4, v4
    v_fmac_f32 v23, v5, v5
    v_lshlrev_b32 v4, 16, v25
    v_and_b32 v5, 0xffff0000, v25
    v_sub_f32 v4, v4, v100
    v_sub_f32 v5, v5, v100
    v_fmac_f32 v21, v4, v4
    v_fmac_f32 v23, v5, v5
    buffer_load_dwordx4 v10, s[8:11], s33 offen offset:2048 lds
    v_lshlrev_b32 v4, 16, v26
    v_and_b32 v5, 0xffff0000, v26
    v_sub_f32 v4, v4, v100
    v_sub_f32 v5, v5, v100
    v_fmac_f32 v21, v4, v4
    v_fmac_f32 v23, v5, v5
    v_lshlrev_b32 v4, 16, v27
    v_and_b32 v5, 0xffff0000, v27
    v_sub_f32 v4, v4, v100
    v_sub_f32 v5, v5, v100
    v_fmac_f32 v21, v4, v4
    buffer_load_dwordx4 v11, s[8:11], s33 offen offset:3072 lds
    v_fmac_f32 v23, v5, v5
    v_lshlrev_b32 v4, 16, v28
    v_and_b32 v5, 0xffff0000, v28
    v_sub_f32 v4, v4, v100
    v_sub_f32 v5, v5, v100
    v_fmac_f32 v21, v4, v4
    v_fmac_f32 v23, v5, v5
    v_lshlrev_b32 v4, 16, v29
    v_and_b32 v5, 0xffff0000, v29
    v_sub_f32 v4, v4, v100
    v_sub_f32 v5, v5, v100
    s_add_u32 m0, s36, 102400
    s_nop 0
    buffer_load_dwordx4 v12, s[8:11], s33 offen offset:0 lds
    v_fmac_f32 v21, v4, v4
    v_fmac_f32 v23, v5, v5
    v_lshlrev_b32 v4, 16, v30
    v_and_b32 v5, 0xffff0000, v30
    v_sub_f32 v4, v4, v100
    v_sub_f32 v5, v5, v100
    v_fmac_f32 v21, v4, v4
    v_fmac_f32 v23, v5, v5
    v_lshlrev_b32 v4, 16, v31
    v_and_b32 v5, 0xffff0000, v31
    v_sub_f32 v4, v4, v100
    buffer_load_dwordx4 v13, s[8:11], s33 offen offset:1024 lds
    v_sub_f32 v5, v5, v100
    v_fmac_f32 v21, v4, v4
    v_fmac_f32 v23, v5, v5
    v_lshlrev_b32 v4, 16, v32
    v_and_b32 v5, 0xffff0000, v32
    v_sub_f32 v4, v4, v100
    v_sub_f32 v5, v5, v100
    v_fmac_f32 v21, v4, v4
    v_fmac_f32 v23, v5, v5
    v_lshlrev_b32 v4, 16, v33
    v_and_b32 v5, 0xffff0000, v33
    buffer_load_dwordx4 v14, s[8:11], s33 offen offset:2048 lds
    v_sub_f32 v4, v4, v100
    v_sub_f32 v5, v5, v100
    v_fmac_f32 v21, v4, v4
    v_fmac_f32 v23, v5, v5
    v_add_f32 v21, v21, v23
    s_nop 1
    v_add_f32_dpp v21, v21, v21 quad_perm:[1,0,3,2] row_mask:0xf bank_mask:0xf
    s_nop 1
    v_add_f32_dpp v21, v21, v21 quad_perm:[2,3,0,1] row_mask:0xf bank_mask:0xf
    s_nop 1
    v_add_f32_dpp v21, v21, v21 row_half_mirror row_mask:0xf bank_mask:0xf
    s_nop 1
    v_add_f32_dpp v21, v21, v21 row_ror:8 row_mask:0xf bank_mask:0xf
    v_mov_b32 v4, v21
    s_nop 1
    v_permlane16_swap_b32 v21, v4
    buffer_load_dwordx4 v15, s[8:11], s33 offen offset:3072 lds
    v_add_f32 v21, v21, v4
    v_mov_b32 v101, 0x3727c5ac
    v_fmac_f32 v101, 0x3acccccd, v21
    v_rsq_f32 v101, v101
    s_waitcnt vmcnt(13)
    s_barrier
    s_mov_b32 s34, 1327104
    s_add_u32 m0, s37, 0
    s_nop 0
    buffer_load_dwordx4 v16, s[12:15], s34 offen offset:0 lds
    s_waitcnt vmcnt(26)
    v_mov_b32 v24, 0
    v_mov_b32 v25, 0
    v_mov_b32 v26, 0
    v_mov_b32 v27, 0
    v_mov_b32 v28, 0
    v_mov_b32 v29, 0
    v_mov_b32 v30, 0
    v_mov_b32 v31, 0
    buffer_load_dwordx4 v17, s[12:15], s34 offen offset:1024 lds
    v_lshlrev_b32 v4, 16, v36
    v_and_b32 v5, 0xffff0000, v36
    v_add_f32 v24, v24, v4
    v_add_f32 v25, v25, v5
    v_lshlrev_b32 v4, 16, v37
    v_and_b32 v5, 0xffff0000, v37
    v_add_f32 v26, v26, v4
    v_add_f32 v27, v27, v5
    v_lshlrev_b32 v4, 16, v38
    buffer_load_dwordx4 v16, s[16:19], s34 offen offset:2048 lds
    v_and_b32 v5, 0xffff0000, v38
    v_add_f32 v28, v28, v4
    v_add_f32 v29, v29, v5
    v_lshlrev_b32 v4, 16, v39
    v_and_b32 v5, 0xffff0000, v39
    v_add_f32 v30, v30, v4
    v_add_f32 v31, v31, v5
    v_lshlrev_b32 v4, 16, v40
    v_and_b32 v5, 0xffff0000, v40
    buffer_load_dwordx4 v17, s[16:19], s34 offen offset:3072 lds
    v_add_f32 v24, v24, v4
    v_add_f32 v25, v25, v5
    v_lshlrev_b32 v4, 16, v41
    v_and_b32 v5, 0xffff0000, v41
    v_add_f32 v26, v26, v4
    v_add_f32 v27, v27, v5
    v_lshlrev_b32 v4, 16, v42
    v_and_b32 v5, 0xffff0000, v42
    v_add_f32 v28, v28, v4
    s_mov_b32 s33, 768
    s_add_u32 m0, s36, 0
    s_nop 0
    buffer_load_dwordx4 v8, s[8:11], s33 offen offset:0 lds
    v_add_f32 v29, v29, v5
    v_lshlrev_b32 v4, 16, v43
    v_and_b32 v5, 0xffff0000, v43
    v_add_f32 v30, v30, v4
    v_add_f32 v31, v31, v5
    v_lshlrev_b32 v4, 16, v44
    v_and_b32 v5, 0xffff0000, v44
    v_add_f32 v24, v24, v4
    v_add_f32 v25, v25, v5
    buffer_load_dwordx4 v9, s[8:11], s33 offen offset:1024 lds
    v_lshlrev_b32 v4, 16, v45
    v_and_b32 v5, 0xffff0000, v45
    v_add_f32 v26, v26, v4
    v_add_f32 v27, v27, v5
    v_lshlrev_b32 v4, 16, v46
    v_and_b32 v5, 0xffff0000, v46
    v_add_f32 v28, v28, v4
    v_add_f32 v29, v29, v5
    v_lshlrev_b32 v4, 16, v47
    buffer_load_dwordx4 v10, s[8:11], s33 offen offset:2048 lds
    v_and_b32 v5, 0xffff0000, v47
    v_add_f32 v30, v30, v4
    v_add_f32 v31, v31, v5
    v_lshlrev_b32 v4, 16, v48
    v_and_b32 v5, 0xffff0000, v48
    v_add_f32 v24, v24, v4
    v_add_f32 v25, v25, v5
    v_lshlrev_b32 v4, 16, v49
    v_and_b32 v5, 0xffff0000, v49
    buffer_load_dwordx4 v11, s[8:11], s33 offen offset:3072 lds
    v_add_f32 v26, v26, v4
    v_add_f32 v27, v27, v5
    v_lshlrev_b32 v4, 16, v50
    v_and_b32 v5, 0xffff0000, v50
    v_add_f32 v28, v28, v4
    v_add_f32 v29, v29, v5
    v_lshlrev_b32 v4, 16, v51
    v_and_b32 v5, 0xffff0000, v51
    v_add_f32 v30, v30, v4
    s_add_u32 m0, s36, 4096
    s_nop 0
    buffer_load_dwordx4 v12, s[8:11], s33 offen offset:0 lds
    v_add_f32 v31, v31, v5
    v_lshlrev_b32 v4, 16, v52
    v_and_b32 v5, 0xffff0000, v52
    v_add_f32 v24, v24, v4
    v_add_f32 v25, v25, v5
    v_lshlrev_b32 v4, 16, v53
    v_and_b32 v5, 0xffff0000, v53
    v_add_f32 v26, v26, v4
    v_add_f32 v27, v27, v5
    buffer_load_dwordx4 v13, s[8:11], s33 offen offset:1024 lds
    v_lshlrev_b32 v4, 16, v54
    v_and_b32 v5, 0xffff0000, v54
    v_add_f32 v28, v28, v4
    v_add_f32 v29, v29, v5
    v_lshlrev_b32 v4, 16, v55
    v_and_b32 v5, 0xffff0000, v55
    v_add_f32 v30, v30, v4
    v_add_f32 v31, v31, v5
    v_permlane32_swap_b32 v24, v28
    buffer_load_dwordx4 v14, s[8:11], s33 offen offset:2048 lds
    v_permlane32_swap_b32 v25, v29
    v_permlane32_swap_b32 v26, v30
    v_permlane32_swap_b32 v27, v31
    v_add_f32 v24, v24, v28
    v_add_f32 v25, v25, v29
    v_add_f32 v26, v26, v30
    v_add_f32 v27, v27, v31
    s_nop 0
    v_permlane16_swap_b32 v24, v26
    v_permlane16_swap_b32 v25, v27
    buffer_load_dwordx4 v15, s[8:11], s33 offen offset:3072 lds
    v_add_f32 v24, v24, v26
    v_add_f32 v25, v25, v27
    s_nop 0
    v_add_f32_dpp v24, v24, v24 row_ror:8 row_mask:0xf bank_mask:0xf
    v_add_f32_dpp v25, v25, v25 row_ror:8 row_mask:0xf bank_mask:0xf
    s_waitcnt vmcnt(12)
    s_barrier
    s_mov_b32 s34, 1548288
    s_add_u32 m0, s37, 49152
    s_nop 0
    buffer_load_dwordx4 v16, s[12:15], s34 offen offset:0 lds
    s_waitcnt vmcnt(25)
    s_mov_b32 s41, 0
L_l_tagG:
    v_readfirstlane_b32 s60, v96
    v_readfirstlane_b32 s61, v97
    s_nop 0
    s_or_b32 s68, s60, s61
    s_cmp_lg_u32 s68, 0
    s_cbranch_scc1 L_l_taggedG
    s_add_u32 s41, s41, 1
    s_cmp_ge_u32 s41, 65536
    s_cbranch_scc1 L_l_taggedG
    s_sleep 2
    buffer_load_dwordx2 v[96:97], v59, s[24:27], 0 offen sc1
    s_waitcnt vmcnt(0)
    s_branch L_l_tagG
L_l_taggedG:
    s_lshl_b32 s40, s29, 8
    s_lshl_b32 s41, s30, 3
    buffer_load_dwordx4 v17, s[12:15], s34 offen offset:1024 lds
    s_add_u32 s40, s40, s41
    v_add_u32 v4, s40, v20
    v_lshlrev_b32 v4, 4, v4
    buffer_load_dwordx4 v16, s[16:19], s34 offen offset:2048 lds
    v_add_u32 v4, 19922944, v4
    v_and_b32 v5, 31, v1
    v_cmp_eq_u32 vcc, 0, v5
    buffer_load_dwordx4 v17, s[16:19], s34 offen offset:3072 lds
    v_mov_b32 v21, 0x7f000000
    v_cndmask_b32 v4, v21, v4, vcc
    v_mov_b32 v102, v96
    s_mov_b32 s33, 896
    s_add_u32 m0, s36, 49152
    s_nop 0
    buffer_load_dwordx4 v8, s[8:11], s33 offen offset:0 lds
    v_mov_b32 v103, v97
    buffer_store_dwordx4 v[100:103], v4, s[20:23], 0 offen sc1
    s_lshl_b32 s40, s30, 3
    buffer_load_dwordx4 v9, s[8:11], s33 offen offset:1024 lds
    s_add_u32 s40, s40, s29
    s_lshl_b32 s40, s40, 1
    s_and_b32 s41, s31, 1
    buffer_load_dwordx4 v10, s[8:11], s33 offen offset:2048 lds
    s_add_u32 s40, s40, s41
    s_lshl_b32 s40, s40, 10
    s_lshr_b32 s41, s31, 1
    buffer_load_dwordx4 v11, s[8:11], s33 offen offset:3072 lds
    s_lshl_b32 s41, s41, 9
    s_add_u32 s40, s40, s41
    s_add_u32 s40, s40, 19988480
    s_add_u32 m0, s36, 53248
    s_nop 0
    buffer_load_dwordx4 v12, s[8:11], s33 offen offset:0 lds
    v_lshlrev_b32 v6, 6, v3
    v_lshrrev_b32 v7, 4, v1
    v_lshlrev_b32 v7, 4, v7
    buffer_load_dwordx4 v13, s[8:11], s33 offen offset:1024 lds
    v_add_u32 v6, v6, v7
    v_add_u32 v6, s40, v6
    v_and_b32 v7, 8, v1
    buffer_load_dwordx4 v14, s[8:11], s33 offen offset:2048 lds
    v_cmp_eq_u32 vcc, 0, v7
    s_nop 1
    v_cndmask_b32 v6, v21, v6, vcc
    v_mov_b32 v26, v96
    buffer_load_dwordx4 v15, s[8:11], s33 offen offset:3072 lds
    v_mov_b32 v27, v97
    buffer_store_dwordx4 v[24:27], v6, s[20:23], 0 offen sc1
    s_waitcnt vmcnt(14)
    s_barrier
    s_mov_b32 s34, 1769472
    s_add_u32 m0, s37, 98304
    s_nop 0
    buffer_load_dwordx4 v16, s[12:15], s34 offen offset:0 lds
    s_lshl_b32 s40, s29, 8
    s_lshl_b32 s41, s31, 6
    buffer_load_dwordx4 v17, s[12:15], s34 offen offset:1024 lds
    s_add_u32 s40, s40, s41
    s_lshl_b32 s40, s40, 4
    buffer_load_dwordx4 v16, s[16:19], s34 offen offset:2048 lds
    s_add_u32 s86, s40, 19922944
    v_lshlrev_b32 v98, 4, v1
    buffer_load_dwordx4 v17, s[16:19], s34 offen offset:3072 lds
    s_lshl_b32 s40, s30, 14
    s_lshl_b32 s41, s31, 8
    s_mov_b32 s33, 1024
    s_add_u32 m0, s36, 98304
    s_nop 0
    buffer_load_dwordx4 v8, s[8:11], s33 offen offset:0 lds
    s_add_u32 s40, s40, s41
    s_add_u32 s87, s40, 19988480
    buffer_load_dwordx4 v9, s[8:11], s33 offen offset:1024 lds
    v_and_b32 v4, 15, v1
    v_lshlrev_b32 v4, 4, v4
    buffer_load_dwordx4 v10, s[8:11], s33 offen offset:2048 lds
    v_lshrrev_b32 v5, 4, v1
    v_lshlrev_b32 v5, 12, v5
    buffer_load_dwordx4 v11, s[8:11], s33 offen offset:3072 lds
    v_add_u32 v99, v4, v5
    s_add_u32 m0, s36, 102400
    s_nop 0
    buffer_load_dwordx4 v12, s[8:11], s33 offen offset:0 lds
    buffer_load_dwordx4 v13, s[8:11], s33 offen offset:1024 lds
    buffer_load_dwordx4 v14, s[8:11], s33 offen offset:2048 lds
    buffer_load_dwordx4 v15, s[8:11], s33 offen offset:3072 lds
    s_waitcnt vmcnt(13)
    buffer_load_dwordx4 v[64:67], v58, s[76:79], s84 offen
    s_add_u32 s84, s84, s85
    buffer_load_dwordx4 v[68:71], v58, s[76:79], s84 offen
    s_add_u32 s84, s84, s85
    buffer_load_dwordx4 v[72:75], v58, s[76:79], s84 offen
    s_add_u32 s84, s84, s85
    buffer_load_dwordx4 v[76:79], v58, s[76:79], s84 offen
    s_add_u32 s84, s84, s85
    buffer_load_dwordx4 v[104:107], v98, s[20:23], s86 offen sc1
    buffer_load_dwordx4 v[28:31], v99, s[20:23], s87 offen offset:0 sc1
    buffer_load_dwordx4 v[32:35], v99, s[20:23], s87 offen offset:1024 sc1
    buffer_load_dwordx4 v[36:39], v99, s[20:23], s87 offen offset:2048 sc1
    buffer_load_dwordx4 v[40:43], v99, s[20:23], s87 offen offset:3072 sc1
    s_barrier
    s_mov_b32 s34, 1990656
    s_add_u32 m0, s37, 0
    s_nop 0
    buffer_load_dwordx4 v16, s[12:15], s34 offen offset:0 lds
    buffer_load_dwordx4 v17, s[12:15], s34 offen offset:1024 lds
    buffer_load_dwordx4 v16, s[16:19], s34 offen offset:2048 lds
    buffer_load_dwordx4 v17, s[16:19], s34 offen offset:3072 lds
    s_mov_b32 s33, 1152
    s_add_u32 m0, s36, 0
    s_nop 0
    buffer_load_dwordx4 v8, s[8:11], s33 offen offset:0 lds
    buffer_load_dwordx4 v9, s[8:11], s33 offen offset:1024 lds
    buffer_load_dwordx4 v10, s[8:11], s33 offen offset:2048 lds
    buffer_load_dwordx4 v11, s[8:11], s33 offen offset:3072 lds
    s_add_u32 m0, s36, 4096
    s_nop 0
    buffer_load_dwordx4 v12, s[8:11], s33 offen offset:0 lds
    buffer_load_dwordx4 v13, s[8:11], s33 offen offset:1024 lds
    buffer_load_dwordx4 v14, s[8:11], s33 offen offset:2048 lds
    buffer_load_dwordx4 v15, s[8:11], s33 offen offset:3072 lds
    s_waitcnt vmcnt(21)
    s_mov_b32 s84, 0
    buffer_load_dwordx4 v[80:83], v58, s[80:83], s84 offen
    s_add_u32 s84, s84, s85
    buffer_load_dwordx4 v[84:87], v58, s[80:83], s84 offen
    s_add_u32 s84, s84, s85
    buffer_load_dwordx4 v[88:91], v58, s[80:83], s84 offen
    s_add_u32 s84, s84, s85
    buffer_load_dwordx4 v[92:95], v58, s[80:83], s84 offen
    s_add_u32 s84, s84, s85
    s_barrier
    s_waitcnt vmcnt(16)
    s_mov_b32 s41, 0
L_l_chkG:
    v_xor_b32 v4, v106, v96
    v_xor_b32 v5, v107, v97
    v_or_b32 v4, v4, v5
    v_xor_b32 v5, v30, v96
    v_or_b32 v4, v4, v5
    v_xor_b32 v5, v31, v97
    v_or_b32 v4, v4, v5
    v_xor_b32 v5, v34, v96
    v_or_b32 v4, v4, v5
    v_xor_b32 v5, v35, v97
    v_or_b32 v4, v4, v5
    v_xor_b32 v5, v38, v96
    v_or_b32 v4, v4, v5
    v_xor_b32 v5, v39, v97
    v_or_b32 v4, v4, v5
    v_xor_b32 v5, v42, v96
    v_or_b32 v4, v4, v5
    v_xor_b32 v5, v43, v97
    v_or_b32 v4, v4, v5
    v_cmp_ne_u32 vcc, 0, v4
    s_nop 0
    s_cmp_eq_u64 vcc, 0
    s_cbranch_scc1 L_l_gotG
    s_add_u32 s41, s41, 1
    s_cmp_ge_u32 s41, 65536
    s_cbranch_scc1 L_l_gotG
    s_sleep 4
    buffer_load_dwordx4 v[104:107], v98, s[20:23], s86 offen sc1
    buffer_load_dwordx4 v[28:31], v99, s[20:23], s87 offen offset:0 sc1
    buffer_load_dwordx4 v[32:35], v99, s[20:23], s87 offen offset:1024 sc1
    buffer_load_dwordx4 v[36:39], v99, s[20:23], s87 offen offset:2048 sc1
    buffer_load_dwordx4 v[40:43], v99, s[20:23], s87 offen offset:3072 sc1
    s_waitcnt vmcnt(0)
    s_branch L_l_chkG
L_l_gotG:
    s_lshl_b32 s40, s31, 8
    v_lshlrev_b32 v4, 2, v1
    v_add_u32 v4, s40, v4
    v_add_u32 v4, 49152, v4
    ds_write_b32 v4, v104
    ds_write_b32 v4, v105 offset:1024
    v_add_f32 v28, v28, v32
    v_add_f32 v29, v29, v33
    v_add_f32 v28, v28, v36
    v_add_f32 v29, v29, v37
    v_add_f32 v28, v28, v40
    v_add_f32 v29, v29, v41
    v_mov_b32 v4, v28
    v_mov_b32 v5, v29
    s_nop 0
    v_permlane16_swap_b32 v28, v4
    v_permlane16_swap_b32 v29, v5
    v_add_f32 v28, v28, v4
    v_add_f32 v29, v29, v5
    v_mov_b32 v4, v28
    v_mov_b32 v5, v29
    s_nop 0
    v_permlane32_swap_b32 v28, v4
    v_permlane32_swap_b32 v29, v5
    v_add_f32 v28, v28, v4
    v_add_f32 v29, v29, v5
    s_lshl_b32 s40, s31, 7
    v_and_b32 v4, 15, v1
    v_lshlrev_b32 v4, 3, v4
    v_add_u32 v4, s40, v4
    v_add_u32 v4, 51200, v4
    ds_write_b64 v4, v[28:29]
    s_waitcnt vmcnt(4)
    s_waitcnt lgkmcnt(0)
    s_barrier
    s_waitcnt vmcnt(0)
    s_lshl_b32 s93, s31, 12
    s_add_u32 s93, s93, 147456
    v_lshlrev_b32 v60, 4, v1
    v_add_u32 v61, s93, v60
    s_cmp_eq_u32 s46, 1
    s_cbranch_scc1 L_rl_a_pG
    s_cmp_eq_u32 s46, 0
    s_cbranch_scc0 L_rl_a_nG
    ds_write_b128 v61, v[64:67] offset:0
    ds_write_b128 v61, v[68:71] offset:1024
    ds_write_b128 v61, v[72:75] offset:2048
    ds_write_b128 v61, v[76:79] offset:3072
    v_lshrrev_b32 v62, 4, v1
    v_lshlrev_b32 v62, 2, v62
    v_and_b32 v63, 15, v1
    v_lshrrev_b32 v63, 2, v63
    v_add_u32 v62, v62, v63
    v_lshlrev_b32 v62, 7, v62
    v_and_b32 v63, 3, v1
    v_lshlrev_b32 v63, 3, v63
    v_add_u32 v62, v62, v63
    v_add_u32 v62, s93, v62
    ds_read_b64_tr_b16 v[80:81], v62 offset:0
    ds_read_b64_tr_b16 v[82:83], v62 offset:2048
    ds_read_b64_tr_b16 v[84:85], v62 offset:32
    ds_read_b64_tr_b16 v[86:87], v62 offset:2080
    ds_read_b64_tr_b16 v[88:89], v62 offset:64
    ds_read_b64_tr_b16 v[90:91], v62 offset:2112
    ds_read_b64_tr_b16 v[92:93], v62 offset:96
    ds_read_b64_tr_b16 v[94:95], v62 offset:2144
    s_branch L_rl_a_eG
L_rl_a_nG:
    s_branch L_rl_a_eG
L_rl_a_pG:
    v_lshlrev_b32 v62, 6, v1
    v_add_u32 v62, s93, v62
    ds_write_b128 v61, v[64:67] offset:0
    ds_write_b128 v61, v[68:71] offset:1024
    ds_write_b128 v61, v[72:75] offset:2048
    ds_write_b128 v61, v[76:79] offset:3072
    ds_read_b128 v[64:67], v62 offset:0
    ds_read_b128 v[68:71], v62 offset:16
    ds_read_b128 v[72:75], v62 offset:32
    ds_read_b128 v[76:79], v62 offset:48
    ds_write_b128 v61, v[80:83] offset:0
    ds_write_b128 v61, v[84:87] offset:1024
    ds_write_b128 v61, v[88:91] offset:2048
    ds_write_b128 v61, v[92:95] offset:3072
    ds_read_b128 v[80:83], v62 offset:0
    ds_read_b128 v[84:87], v62 offset:16
    ds_read_b128 v[88:91], v62 offset:32
    ds_read_b128 v[92:95], v62 offset:48
L_rl_a_eG:
    s_cmp_eq_u32 s46, 1
    s_cbranch_scc1 L_rl_b_pG
    s_branch L_rl_b_eG
L_rl_b_pG:
    v_lshlrev_b32 v62, 2, v1
    v_add_u32 v62, s93, v62
    s_mov_b32 s90, 0x05040100
    s_mov_b32 s91, 0x07060302
    s_lshl_b32 s92, s62, 8
    s_lshl_b32 s41, s63, 13
    s_add_u32 s92, s92, s41
    s_add_u32 s92, s92, 13631488
    v_lshrrev_b32 v63, 4, v1
    v_lshlrev_b32 v63, 13, v63
    v_and_b32 v124, 15, v1
    v_lshlrev_b32 v124, 4, v124
    v_add_u32 v63, v63, v124
    s_waitcnt lgkmcnt(0)
    v_perm_b32 v120, v80, v64, s90
    ds_write_b32 v62, v120 offset:0
    v_perm_b32 v121, v80, v64, s91
    ds_write_b32 v62, v121 offset:256
    v_perm_b32 v122, v81, v65, s90
    ds_write_b32 v62, v122 offset:512
    v_perm_b32 v123, v81, v65, s91
    ds_write_b32 v62, v123 offset:768
    v_perm_b32 v120, v82, v66, s90
    ds_write_b32 v62, v120 offset:1024
    v_perm_b32 v121, v82, v66, s91
    ds_write_b32 v62, v121 offset:1280
    v_perm_b32 v122, v83, v67, s90
    ds_write_b32 v62, v122 offset:1536
    v_perm_b32 v123, v83, v67, s91
    ds_write_b32 v62, v123 offset:1792
    v_perm_b32 v120, v84, v68, s90
    ds_write_b32 v62, v120 offset:2048
    v_perm_b32 v121, v84, v68, s91
    ds_write_b32 v62, v121 offset:2304
    v_perm_b32 v122, v85, v69, s90
    ds_write_b32 v62, v122 offset:2560
    v_perm_b32 v123, v85, v69, s91
    ds_write_b32 v62, v123 offset:2816
    v_perm_b32 v120, v86, v70, s90
    ds_write_b32 v62, v120 offset:3072
    v_perm_b32 v121, v86, v70, s91
    ds_write_b32 v62, v121 offset:3328
    v_perm_b32 v122, v87, v71, s90
    ds_write_b32 v62, v122 offset:3584
    v_perm_b32 v123, v87, v71, s91
    ds_write_b32 v62, v123 offset:3840
    ds_read_b128 v[64:67], v61 offset:0
    ds_read_b128 v[68:71], v61 offset:1024
    ds_read_b128 v[80:83], v61 offset:2048
    ds_read_b128 v[84:87], v61 offset:3072
L_rl_b_eG:
    s_cmp_eq_u32 s46, 1
    s_cbranch_scc1 L_rl_c_pG
    s_cmp_eq_u32 s46, 0
    s_cbranch_scc0 L_rl_c_nG
    s_lshl_b32 s40, s63, 2
    s_mul_i32 s40, s40, 54
    s_add_u32 s40, s40, s62
    s_lshl_b32 s40, s40, 10
    s_add_u32 s40, s40, 16777216
    s_waitcnt lgkmcnt(0)
    buffer_store_dwordx4 v[80:83], v60, s[20:23], s40 offen sc1
    s_add_u32 s40, s40, 55296
    buffer_store_dwordx4 v[84:87], v60, s[20:23], s40 offen sc1
    s_add_u32 s40, s40, 55296
    buffer_store_dwordx4 v[88:91], v60, s[20:23], s40 offen sc1
    s_add_u32 s40, s40, 55296
    buffer_store_dwordx4 v[92:95], v60, s[20:23], s40 offen sc1
    s_add_u32 s40, s40, 55296
    s_branch L_rl_c_eG
L_rl_c_nG:
    v_mov_b32 v125, 0x7f000000
    buffer_store_dword v125, v125, s[20:23], 0 offen
    buffer_store_dword v125, v125, s[20:23], 0 offen
    buffer_store_dword v125, v125, s[20:23], 0 offen
    buffer_store_dword v125, v125, s[20:23], 0 offen
    s_branch L_rl_c_eG
L_rl_c_pG:
    s_waitcnt lgkmcnt(0)
    buffer_store_dwordx4 v[64:67], v63, s[20:23], s92 offen sc1
    s_add_u32 s92, s92, 32768
    buffer_store_dwordx4 v[68:71], v63, s[20:23], s92 offen sc1
    s_add_u32 s92, s92, 32768
    buffer_store_dwordx4 v[80:83], v63, s[20:23], s92 offen sc1
    s_add_u32 s92, s92, 32768
    buffer_store_dwordx4 v[84:87], v63, s[20:23], s92 offen sc1
    s_add_u32 s92, s92, 32768
    v_perm_b32 v120, v88, v72, s90
    ds_write_b32 v62, v120 offset:0
    v_perm_b32 v121, v88, v72, s91
    ds_write_b32 v62, v121 offset:256
    v_perm_b32 v122, v89, v73, s90
    ds_write_b32 v62, v122 offset:512
    v_perm_b32 v123, v89, v73, s91
    ds_write_b32 v62, v123 offset:768
    v_perm_b32 v120, v90, v74, s90
    ds_write_b32 v62, v120 offset:1024
    v_perm_b32 v121, v90, v74, s91
    ds_write_b32 v62, v121 offset:1280
    v_perm_b32 v122, v91, v75, s90
    ds_write_b32 v62, v122 offset:1536
    v_perm_b32 v123, v91, v75, s91
    ds_write_b32 v62, v123 offset:1792
    v_perm_b32 v120, v92, v76, s90
    ds_write_b32 v62, v120 offset:2048
    v_perm_b32 v121, v92, v76, s91
    ds_write_b32 v62, v121 offset:2304
    v_perm_b32 v122, v93, v77, s90
    ds_write_b32 v62, v122 offset:2560
    v_perm_b32 v123, v93, v77, s91
    ds_write_b32 v62, v123 offset:2816
    v_perm_b32 v120, v94, v78, s90
    ds_write_b32 v62, v120 offset:3072
    v_perm_b32 v121, v94, v78, s91
    ds_write_b32 v62, v121 offset:3328
    v_perm_b32 v122, v95, v79, s90
    ds_write_b32 v62, v122 offset:3584
    v_perm_b32 v123, v95, v79, s91
    ds_write_b32 v62, v123 offset:3840
    ds_read_b128 v[72:75], v61 offset:0
    ds_read_b128 v[76:79], v61 offset:1024
    ds_read_b128 v[88:91], v61 offset:2048
    ds_read_b128 v[92:95], v61 offset:3072
L_rl_c_eG:
    s_cmp_eq_u32 s46, 1
    s_cbranch_scc1 L_rl_d_pG
    v_mov_b32 v125, 0x7f000000
    buffer_store_dword v125, v125, s[20:23], 0 offen
    buffer_store_dword v125, v125, s[20:23], 0 offen
    buffer_store_dword v125, v125, s[20:23], 0 offen
    buffer_store_dword v125, v125, s[20:23], 0 offen
    s_branch L_rl_d_eG
L_rl_d_pG:
    s_waitcnt lgkmcnt(0)
    buffer_store_dwordx4 v[72:75], v63, s[20:23], s92 offen sc1
    s_add_u32 s92, s92, 32768
    buffer_store_dwordx4 v[76:79], v63, s[20:23], s92 offen sc1
    s_add_u32 s92, s92, 32768
    buffer_store_dwordx4 v[88:91], v63, s[20:23], s92 offen sc1
    s_add_u32 s92, s92, 32768
    buffer_store_dwordx4 v[92:95], v63, s[20:23], s92 offen sc1
    s_add_u32 s92, s92, 32768
L_rl_d_eG:
    s_endpgm
L_k1_load_dft:
    s_sub_u32 s31, s28, 4
    s_sub_u32 s40, s30, 27
    s_lshl_b32 s40, s40, 7
    s_lshl_b32 s41, s31, 5
    s_add_u32 s40, s40, s41
    v_add_u32 v4, s40, v2
    v_mul_u32_u24 v4, 1280, v4
    v_lshrrev_b32 v5, 1, v2
    v_xor_b32 v5, v5, v3
    v_xor_b32 v6, 4, v5
    v_lshlrev_b32 v5, 4, v5
    v_lshlrev_b32 v6, 4, v6
    v_add_u32 v16, v4, v5
    v_add_u32 v17, v4, v6
    v_add_u32 v17, 9216, v17
    v_add_u32 v18, v4, v5
    v_add_u32 v18, 18432, v18
    v_add_u32 v19, v4, v6
    v_add_u32 v19, 27648, v19
    s_lshl_b32 s36, s31, 13
    s_lshl_b32 s37, s31, 12
    s_add_u32 s37, s37, 32768
    s_lshr_b32 s88, s29, 1
    s_and_b32 s88, s88, 1
    s_lshl_b32 s88, s88, 10
    s_and_b32 s41, s29, 1
    s_lshl_b32 s41, s41, 8
    s_add_u32 s88, s88, s41
    s_lshr_b32 s41, s29, 2
    s_lshl_b32 s41, s41, 5
    s_add_u32 s88, s88, s41
    s_lshl_b32 s41, s31, 3
    s_add_u32 s40, s88, s41
    v_lshrrev_b32 v4, 2, v2
    v_lshlrev_b32 v4, 3, v4
    v_and_b32 v5, 3, v2
    v_add_u32 v4, v4, v5
    v_lshlrev_b32 v4, 6, v4
    v_add_u32 v4, s40, v4
    v_mul_u32_u24 v4, 1280, v4
    v_bfe_u32 v5, v2, 1, 1
    v_xor_b32 v5, v5, v3
    v_lshlrev_b32 v6, 4, v5
    v_add_u32 v8, v4, v6
    v_xor_b32 v6, 2, v5
    v_lshlrev_b32 v6, 4, v6
    v_add_u32 v6, 256, v6
    v_add_u32 v9, v4, v6
    v_xor_b32 v6, 4, v5
    v_lshlrev_b32 v6, 4, v6
    v_add_u32 v6, 512, v6
    v_add_u32 v10, v4, v6
    v_xor_b32 v6, 6, v5
    v_lshlrev_b32 v6, 4, v6
    v_add_u32 v6, 768, v6
    v_add_u32 v11, v4, v6
    v_lshlrev_b32 v6, 4, v5
    v_add_u32 v6, 5120, v6
    v_add_u32 v12, v4, v6
    v_xor_b32 v6, 2, v5
    v_lshlrev_b32 v6, 4, v6
    v_add_u32 v6, 5376, v6
    v_add_u32 v13, v4, v6
    v_xor_b32 v6, 4, v5
    v_lshlrev_b32 v6, 4, v6
    v_add_u32 v6, 5632, v6
    v_add_u32 v14, v4, v6
    v_xor_b32 v6, 6, v5
    v_lshlrev_b32 v6, 4, v6
    v_add_u32 v6, 5888, v6
    v_add_u32 v15, v4, v6
    s_waitcnt lgkmcnt(0)
    s_mov_b32 s8, s4
    s_mov_b32 s9, s5
    s_mov_b32 s10, 2621440
    s_mov_b32 s11, 0x00020000
    s_cmp_ge_u32 s30, 27
    s_cselect_b32 s12, s68, s64
    s_cselect_b32 s13, s69, s65
    s_mov_b32 s14, 2211840
    s_cselect_b32 s14, 819200, s14
    s_mov_b32 s15, 0x00020000
    s_sub_u32 s16, s66, 2048
    s_subb_u32 s17, s67, 0
    s_mov_b32 s18, 2213888
    s_mov_b32 s19, 0x00020000
    s_mov_b32 s20, s6
    s_mov_b32 s21, s7
    s_mov_b32 s22, 25165824
    s_mov_b32 s23, 0x00020000
    s_mov_b32 s58, s66
    s_mov_b32 s59, s67
    v_mov_b32 v59, 0
    s_cmp_eq_u32 s2, 0
    s_cselect_b32 s89, 1, 0
    s_cmp_eq_u32 s31, 0
    s_cselect_b32 s89, s89, 0
    s_cmp_eq_u32 s89, 1
    s_cbranch_scc0 L_l_nreqD
    s_mov_b32 s40, 19922952
    buffer_load_dwordx2 v[60:61], v59, s[20:23], s40 offen sc1
L_l_nreqD:
    s_mov_b32 s34, 0
    s_add_u32 m0, s37, 0
    s_nop 0
    buffer_load_dwordx4 v16, s[12:15], s34 offen offset:0 lds
    buffer_load_dwordx4 v17, s[12:15], s34 offen offset:1024 lds
    buffer_load_dwordx4 v18, s[12:15], s34 offen offset:2048 lds
    buffer_load_dwordx4 v19, s[12:15], s34 offen offset:3072 lds
    s_mov_b32 s33, 0
    s_add_u32 m0, s36, 0
    s_nop 0
    buffer_load_dwordx4 v8, s[8:11], s33 offen offset:0 lds
    buffer_load_dwordx4 v9, s[8:11], s33 offen offset:1024 lds
    buffer_load_dwordx4 v10, s[8:11], s33 offen offset:2048 lds
    buffer_load_dwordx4 v11, s[8:11], s33 offen offset:3072 lds
    s_add_u32 m0, s36, 4096
    s_nop 0
    buffer_load_dwordx4 v12, s[8:11], s33 offen offset:0 lds
    buffer_load_dwordx4 v13, s[8:11], s33 offen offset:1024 lds
    buffer_load_dwordx4 v14, s[8:11], s33 offen offset:2048 lds
    buffer_load_dwordx4 v15, s[8:11], s33 offen offset:3072 lds
    s_mov_b32 s34, 128
    s_add_u32 m0, s37, 49152
    s_nop 0
    buffer_load_dwordx4 v16, s[12:15], s34 offen offset:0 lds
    buffer_load_dwordx4 v17, s[12:15], s34 offen offset:1024 lds
    buffer_load_dwordx4 v18, s[12:15], s34 offen offset:2048 lds
    buffer_load_dwordx4 v19, s[12:15], s34 offen offset:3072 lds
    s_mov_b32 s33, 128
    s_add_u32 m0, s36, 49152
    s_nop 0
    buffer_load_dwordx4 v8, s[8:11], s33 offen offset:0 lds
    buffer_load_dwordx4 v9, s[8:11], s33 offen offset:1024 lds
    buffer_load_dwordx4 v10, s[8:11], s33 offen offset:2048 lds
    buffer_load_dwordx4 v11, s[8:11], s33 offen offset:3072 lds
    s_add_u32 m0, s36, 53248
    s_nop 0
    buffer_load_dwordx4 v12, s[8:11], s33 offen offset:0 lds
    buffer_load_dwordx4 v13, s[8:11], s33 offen offset:1024 lds
    buffer_load_dwordx4 v14, s[8:11], s33 offen offset:2048 lds
    buffer_load_dwordx4 v15, s[8:11], s33 offen offset:3072 lds
    s_waitcnt vmcnt(12)
    s_barrier
    s_mov_b32 s34, 256
    s_add_u32 m0, s37, 98304
    s_nop 0
    buffer_load_dwordx4 v16, s[12:15], s34 offen offset:0 lds
    v_lshrrev_b32 v20, 5, v1
    s_lshl_b32 s40, s31, 1
    buffer_load_dwordx4 v17, s[12:15], s34 offen offset:1024 lds
    v_add_u32 v20, s40, v20
    v_lshrrev_b32 v5, 2, v20
    buffer_load_dwordx4 v18, s[12:15], s34 offen offset:2048 lds
    v_lshlrev_b32 v5, 3, v5
    v_and_b32 v6, 3, v20
    buffer_load_dwordx4 v19, s[12:15], s34 offen offset:3072 lds
    v_add_u32 v5, v5, v6
    v_lshlrev_b32 v5, 6, v5
    s_mov_b32 s33, 256
    s_add_u32 m0, s36, 98304
    s_nop 0
    buffer_load_dwordx4 v8, s[8:11], s33 offen offset:0 lds
    s_add_u32 s40, s88, s30
    v_add_u32 v5, s40, v5
    buffer_load_dwordx4 v9, s[8:11], s33 offen offset:1024 lds
    v_mul_u32_u24 v5, 1280, v5
    v_and_b32 v6, 31, v1
    buffer_load_dwordx4 v10, s[8:11], s33 offen offset:2048 lds
    v_lshlrev_b32 v6, 3, v6
    v_add_u32 v56, v5, v6
    buffer_load_dwordx4 v11, s[8:11], s33 offen offset:3072 lds
    s_mov_b32 s24, s50
    s_mov_b32 s25, s51
    s_mov_b32 s26, 256
    s_mov_b32 s27, 0x00020000
    s_cmp_eq_u32 s89, 1
    s_cbranch_scc0 L_l_notagD
    v_add_co_u32 v60, vcc, 1, v60
    s_nop 1
    v_addc_co_u32 v61, vcc, 0, v61, vcc
    v_or_b32 v62, v60, v61
    v_cmp_eq_u32 vcc, 0, v62
    s_nop 1
    v_cndmask_b32 v60, v60, 1, vcc
    v_cmp_eq_u32 vcc, 0, v1
    v_mov_b32 v63, 0x7f000000
    s_nop 0
    v_cndmask_b32 v62, v63, v59, vcc
    buffer_store_dwordx2 v[60:61], v62, s[24:27], 0 offen sc1
    v_lshlrev_b32 v62, 7, v1
    v_add_u32 v62, 20512768, v62
    buffer_store_dword v59, v62, s[20:23], 0 offen
    v_lshlrev_b32 v62, 7, v1
    v_add_u32 v62, 20520960, v62
    buffer_store_dword v59, v62, s[20:23], 0 offen
L_l_notagD:
    s_add_u32 m0, s36, 102400
    s_nop 0
    buffer_load_dwordx4 v12, s[8:11], s33 offen offset:0 lds
    buffer_load_dwordx4 v13, s[8:11], s33 offen offset:1024 lds
    buffer_load_dwordx4 v14, s[8:11], s33 offen offset:2048 lds
    buffer_load_dwordx4 v15, s[8:11], s33 offen offset:3072 lds
    s_waitcnt vmcnt(12)
    buffer_load_dwordx2 v[24:25], v56, s[8:11], 0 offen offset:0
    buffer_load_dwordx2 v[26:27], v56, s[8:11], 0 offen offset:256
    buffer_load_dwordx2 v[28:29], v56, s[8:11], 0 offen offset:512
    buffer_load_dwordx2 v[30:31], v56, s[8:11], 0 offen offset:768
    buffer_load_dwordx2 v[32:33], v56, s[8:11], 0 offen offset:1024
    s_barrier
    s_mov_b32 s34, 384
    s_add_u32 m0, s37, 0
    s_nop 0
    buffer_load_dwordx4 v16, s[12:15], s34 offen offset:0 lds
    buffer_load_dwordx4 v17, s[12:15], s34 offen offset:1024 lds
    buffer_load_dwordx4 v18, s[12:15], s34 offen offset:2048 lds
    buffer_load_dwordx4 v19, s[12:15], s34 offen offset:3072 lds
    s_mov_b32 s33, 384
    s_add_u32 m0, s36, 0
    s_nop 0
    buffer_load_dwordx4 v8, s[8:11], s33 offen offset:0 lds
    buffer_load_dwordx4 v9, s[8:11], s33 offen offset:1024 lds
    buffer_load_dwordx4 v10, s[8:11], s33 offen offset:2048 lds
    buffer_load_dwordx4 v11, s[8:11], s33 offen offset:3072 lds
    s_add_u32 m0, s36, 4096
    s_nop 0
    buffer_load_dwordx4 v12, s[8:11], s33 offen offset:0 lds
    buffer_load_dwordx4 v13, s[8:11], s33 offen offset:1024 lds
    buffer_load_dwordx4 v14, s[8:11], s33 offen offset:2048 lds
    buffer_load_dwordx4 v15, s[8:11], s33 offen offset:3072 lds
    s_waitcnt vmcnt(17)
    s_barrier
    s_mov_b32 s34, 512
    s_add_u32 m0, s37, 49152
    s_nop 0
    buffer_load_dwordx4 v16, s[12:15], s34 offen offset:0 lds
    s_cmp_eq_u32 s31, 3
    s_cbranch_scc1 L_l_wp3D
    s_cmp_eq_u32 s31, 2
    s_cbranch_scc1 L_l_v2D
    s_lshl_b32 s40, s2, 1
    s_add_u32 s40, s40, s31
    s_branch L_l_wdD
L_l_v2D:
    s_cmp_lt_u32 s2, 96
    s_cbranch_scc1 L_l_wp2D
    s_add_u32 s40, s2, 416
L_l_wdD:
    s_cmp_lt_u32 s40, 540
    s_cselect_b32 s46, 0, 2
    s_cselect_b32 s42, 2211840, 0
    s_mul_i32 s62, s40, 6554
    s_lshr_b32 s62, s62, 16
    s_mul_i32 s41, s62, 10
    s_sub_u32 s63, s40, s41
    s_mov_b32 s76, s56
    s_mov_b32 s77, s57
    s_mov_b32 s78, s42
    s_mov_b32 s79, 0x00020000
    s_mov_b32 s80, s56
    s_mov_b32 s81, s57
    s_mov_b32 s82, 0
    s_mov_b32 s83, 0x00020000
    s_lshl_b32 s40, s62, 5
    v_add_u32 v58, s40, v2
    v_mul_u32_u24 v58, 1280, v58
    s_lshl_b32 s40, s63, 7
    v_add_u32 v58, s40, v58
    v_lshlrev_b32 v62, 4, v3
    v_add_u32 v58, v58, v62
    s_mov_b32 s85, 10240
    s_branch L_l_rl_setD
L_l_wp2D:
    s_add_u32 s40, s2, 256
    s_branch L_l_wpD
L_l_wp3D:
    s_mov_b32 s40, s2
L_l_wpD:
    s_mov_b32 s46, 1
    s_mul_i32 s62, s40, 5958
    s_lshr_b32 s62, s62, 16
    s_mul_i32 s41, s62, 11
    s_sub_u32 s63, s40, s41
    s_lshl_b32 s63, s63, 5
    s_min_u32 s63, s63, 289
    s_and_b32 s40, s62, 1
    s_lshl_b32 s40, s40, 4
    s_lshr_b32 s41, s62, 4
    s_lshl_b32 s41, s41, 5
    s_add_u32 s40, s40, s41
    s_lshr_b32 s41, s62, 2
    s_and_b32 s41, s41, 3
    s_lshl_b32 s41, s41, 9
    s_add_u32 s40, s40, s41
    s_lshr_b32 s41, s62, 1
    s_and_b32 s41, s41, 1
    s_lshl_b32 s41, s41, 8
    s_add_u32 s40, s40, s41
    v_lshrrev_b32 v58, 4, v1
    v_bfe_u32 v62, v1, 2, 2
    v_lshlrev_b32 v62, 6, v62
    v_add_u32 v58, v58, v62
    v_add_u32 v58, s40, v58
    v_mul_u32_u24 v58, 642, v58
    s_lshl_b32 s40, s63, 1
    v_add_u32 v58, s40, v58
    v_and_b32 v62, 3, v1
    v_lshlrev_b32 v62, 4, v62
    v_add_u32 v58, v58, v62
    s_mov_b32 s76, s52
    s_mov_b32 s77, s53
    s_mov_b32 s78, 1314816
    s_mov_b32 s79, 0x00020000
    s_mov_b32 s80, s54
    s_mov_b32 s81, s55
    s_mov_b32 s82, 1314816
    s_mov_b32 s83, 0x00020000
    s_mov_b32 s85, 2568
L_l_rl_setD:
    s_mov_b32 s84, 0
    buffer_load_dwordx4 v17, s[12:15], s34 offen offset:1024 lds
    buffer_load_dwordx4 v18, s[12:15], s34 offen offset:2048 lds
    buffer_load_dwordx4 v19, s[12:15], s34 offen offset:3072 lds
    s_mov_b32 s33, 512
    s_add_u32 m0, s36, 49152
    s_nop 0
    buffer_load_dwordx4 v8, s[8:11], s33 offen offset:0 lds
    buffer_load_dwordx4 v9, s[8:11], s33 offen offset:1024 lds
    buffer_load_dwordx4 v10, s[8:11], s33 offen offset:2048 lds
    buffer_load_dwordx4 v11, s[8:11], s33 offen offset:3072 lds
    s_add_u32 m0, s36, 53248
    s_nop 0
    buffer_load_dwordx4 v12, s[8:11], s33 offen offset:0 lds
    buffer_load_dwordx4 v13, s[8:11], s33 offen offset:1024 lds
    buffer_load_dwordx4 v14, s[8:11], s33 offen offset:2048 lds
    buffer_load_dwordx4 v15, s[8:11], s33 offen offset:3072 lds
    s_waitcnt vmcnt(12)
    buffer_load_dwordx2 v[96:97], v59, s[24:27], 0 offen sc1
    s_barrier
    s_mov_b32 s34, 640
    s_add_u32 m0, s37, 98304
    s_nop 0
    buffer_load_dwordx4 v16, s[12:15], s34 offen offset:0 lds
    s_waitcnt vmcnt(26)
    v_mov_b32 v21, 0
    v_mov_b32 v22, 0
    v_lshlrev_b32 v4, 16, v24
    v_and_b32 v5, 0xffff0000, v24
    v_add_f32 v21, v21, v4
    v_add_f32 v22, v22, v5
    v_lshlrev_b32 v4, 16, v25
    v_and_b32 v5, 0xffff0000, v25
    v_add_f32 v21, v21, v4
    v_add_f32 v22, v22, v5
    buffer_load_dwordx4 v17, s[12:15], s34 offen offset:1024 lds
    v_lshlrev_b32 v4, 16, v26
    v_and_b32 v5, 0xffff0000, v26
    v_add_f32 v21, v21, v4
    v_add_f32 v22, v22, v5
    v_lshlrev_b32 v4, 16, v27
    v_and_b32 v5, 0xffff0000, v27
    v_add_f32 v21, v21, v4
    v_add_f32 v22, v22, v5
    v_lshlrev_b32 v4, 16, v28
    v_and_b32 v5, 0xffff0000, v28
    v_add_f32 v21, v21, v4
    buffer_load_dwordx4 v18, s[12:15], s34 offen offset:2048 lds
    v_add_f32 v22, v22, v5
    v_lshlrev_b32 v4, 16, v29
    v_and_b32 v5, 0xffff0000, v29
    v_add_f32 v21, v21, v4
    v_add_f32 v22, v22, v5
    v_lshlrev_b32 v4, 16, v30
    v_and_b32 v5, 0xffff0000, v30
    v_add_f32 v21, v21, v4
    v_add_f32 v22, v22, v5
    v_lshlrev_b32 v4, 16, v31
    v_and_b32 v5, 0xffff0000, v31
    buffer_load_dwordx4 v19, s[12:15], s34 offen offset:3072 lds
    v_add_f32 v21, v21, v4
    v_add_f32 v22, v22, v5
    v_lshlrev_b32 v4, 16, v32
    v_and_b32 v5, 0xffff0000, v32
    v_add_f32 v21, v21, v4
    v_add_f32 v22, v22, v5
    v_lshlrev_b32 v4, 16, v33
    v_and_b32 v5, 0xffff0000, v33
    v_add_f32 v21, v21, v4
    v_add_f32 v22, v22, v5
    v_add_f32 v21, v21, v22
    s_mov_b32 s33, 640
    s_add_u32 m0, s36, 98304
    s_nop 0
    buffer_load_dwordx4 v8, s[8:11], s33 offen offset:0 lds
    v_add_f32_dpp v21, v21, v21 quad_perm:[1,0,3,2] row_mask:0xf bank_mask:0xf
    s_nop 1
    v_add_f32_dpp v21, v21, v21 quad_perm:[2,3,0,1] row_mask:0xf bank_mask:0xf
    s_nop 1
    v_add_f32_dpp v21, v21, v21 row_half_mirror row_mask:0xf bank_mask:0xf
    s_nop 1
    v_add_f32_dpp v21, v21, v21 row_ror:8 row_mask:0xf bank_mask:0xf
    v_mov_b32 v4, v21
    s_nop 1
    v_permlane16_swap_b32 v21, v4
    v_add_f32 v21, v21, v4
    v_mul_f32 v100, 0x3acccccd, v21
    v_mov_b32 v21, 0
    v_mov_b32 v23, 0
    v_lshlrev_b32 v4, 16, v24
    buffer_load_dwordx4 v9, s[8:11], s33 offen offset:1024 lds
    v_and_b32 v5, 0xffff0000, v24
    v_sub_f32 v4, v4, v100
    v_sub_f32 v5, v5, v100
    v_fmac_f32 v21, v4, v4
    v_fmac_f32 v23, v5, v5
    v_lshlrev_b32 v4, 16, v25
    v_and_b32 v5, 0xffff0000, v25
    v_sub_f32 v4, v4, v100
    v_sub_f32 v5, v5, v100
    v_fmac_f32 v21, v4, v4
    v_fmac_f32 v23, v5, v5
    buffer_load_dwordx4 v10, s[8:11], s33 offen offset:2048 lds
    v_lshlrev_b32 v4, 16, v26
    v_and_b32 v5, 0xffff0000, v26
    v_sub_f32 v4, v4, v100
    v_sub_f32 v5, v5, v100
    v_fmac_f32 v21, v4, v4
    v_fmac_f32 v23, v5, v5
    v_lshlrev_b32 v4, 16, v27
    v_and_b32 v5, 0xffff0000, v27
    v_sub_f32 v4, v4, v100
    v_sub_f32 v5, v5, v100
    v_fmac_f32 v21, v4, v4
    buffer_load_dwordx4 v11, s[8:11], s33 offen offset:3072 lds
    v_fmac_f32 v23, v5, v5
    v_lshlrev_b32 v4, 16, v28
    v_and_b32 v5, 0xffff0000, v28
    v_sub_f32 v4, v4, v100
    v_sub_f32 v5, v5, v100
    v_fmac_f32 v21, v4, v4
    v_fmac_f32 v23, v5, v5
    v_lshlrev_b32 v4, 16, v29
    v_and_b32 v5, 0xffff0000, v29
    v_sub_f32 v4, v4, v100
    v_sub_f32 v5, v5, v100
    s_add_u32 m0, s36, 102400
    s_nop 0
    buffer_load_dwordx4 v12, s[8:11], s33 offen offset:0 lds
    v_fmac_f32 v21, v4, v4
    v_fmac_f32 v23, v5, v5
    v_lshlrev_b32 v4, 16, v30
    v_and_b32 v5, 0xffff0000, v30
    v_sub_f32 v4, v4, v100
    v_sub_f32 v5, v5, v100
    v_fmac_f32 v21, v4, v4
    v_fmac_f32 v23, v5, v5
    v_lshlrev_b32 v4, 16, v31
    v_and_b32 v5, 0xffff0000, v31
    v_sub_f32 v4, v4, v100
    buffer_load_dwordx4 v13, s[8:11], s33 offen offset:1024 lds
    v_sub_f32 v5, v5, v100
    v_fmac_f32 v21, v4, v4
    v_fmac_f32 v23, v5, v5
    v_lshlrev_b32 v4, 16, v32
    v_and_b32 v5, 0xffff0000, v32
    v_sub_f32 v4, v4, v100
    v_sub_f32 v5, v5, v100
    v_fmac_f32 v21, v4, v4
    v_fmac_f32 v23, v5, v5
    v_lshlrev_b32 v4, 16, v33
    v_and_b32 v5, 0xffff0000, v33
    buffer_load_dwordx4 v14, s[8:11], s33 offen offset:2048 lds
    v_sub_f32 v4, v4, v100
    v_sub_f32 v5, v5, v100
    v_fmac_f32 v21, v4, v4
    v_fmac_f32 v23, v5, v5
    v_add_f32 v21, v21, v23
    s_nop 1
    v_add_f32_dpp v21, v21, v21 quad_perm:[1,0,3,2] row_mask:0xf bank_mask:0xf
    s_nop 1
    v_add_f32_dpp v21, v21, v21 quad_perm:[2,3,0,1] row_mask:0xf bank_mask:0xf
    s_nop 1
    v_add_f32_dpp v21, v21, v21 row_half_mirror row_mask:0xf bank_mask:0xf
    s_nop 1
    v_add_f32_dpp v21, v21, v21 row_ror:8 row_mask:0xf bank_mask:0xf
    v_mov_b32 v4, v21
    s_nop 1
    v_permlane16_swap_b32 v21, v4
    buffer_load_dwordx4 v15, s[8:11], s33 offen offset:3072 lds
    v_add_f32 v21, v21, v4
    v_mov_b32 v101, 0x3727c5ac
    v_fmac_f32 v101, 0x3acccccd, v21
    v_rsq_f32 v101, v101
    s_waitcnt vmcnt(13)
    s_barrier
    s_mov_b32 s34, 768
    s_add_u32 m0, s37, 0
    s_nop 0
    buffer_load_dwordx4 v16, s[12:15], s34 offen offset:0 lds
    buffer_load_dwordx4 v17, s[12:15], s34 offen offset:1024 lds
    buffer_load_dwordx4 v18, s[12:15], s34 offen offset:2048 lds
    buffer_load_dwordx4 v19, s[12:15], s34 offen offset:3072 lds
    s_mov_b32 s33, 768
    s_add_u32 m0, s36, 0
    s_nop 0
    buffer_load_dwordx4 v8, s[8:11], s33 offen offset:0 lds
    buffer_load_dwordx4 v9, s[8:11], s33 offen offset:1024 lds
    buffer_load_dwordx4 v10, s[8:11], s33 offen offset:2048 lds
    buffer_load_dwordx4 v11, s[8:11], s33 offen offset:3072 lds
    s_add_u32 m0, s36, 4096
    s_nop 0
    buffer_load_dwordx4 v12, s[8:11], s33 offen offset:0 lds
    buffer_load_dwordx4 v13, s[8:11], s33 offen offset:1024 lds
    buffer_load_dwordx4 v14, s[8:11], s33 offen offset:2048 lds
    buffer_load_dwordx4 v15, s[8:11], s33 offen offset:3072 lds
    s_waitcnt vmcnt(12)
    s_barrier
    s_mov_b32 s34, 896
    s_add_u32 m0, s37, 49152
    s_nop 0
    buffer_load_dwordx4 v16, s[12:15], s34 offen offset:0 lds
    s_waitcnt vmcnt(25)
    s_mov_b32 s41, 0
L_l_tagD:
    v_readfirstlane_b32 s60, v96
    v_readfirstlane_b32 s61, v97
    s_nop 0
    s_or_b32 s68, s60, s61
    s_cmp_lg_u32 s68, 0
    s_cbranch_scc1 L_l_taggedD
    s_add_u32 s41, s41, 1
    s_cmp_ge_u32 s41, 65536
    s_cbranch_scc1 L_l_taggedD
    s_sleep 2
    buffer_load_dwordx2 v[96:97], v59, s[24:27], 0 offen sc1
    s_waitcnt vmcnt(0)
    s_branch L_l_tagD
L_l_taggedD:
    s_lshl_b32 s40, s29, 8
    buffer_load_dwordx4 v17, s[12:15], s34 offen offset:1024 lds
    s_lshl_b32 s41, s30, 3
    s_add_u32 s40, s40, s41
    buffer_load_dwordx4 v18, s[12:15], s34 offen offset:2048 lds
    v_add_u32 v4, s40, v20
    v_lshlrev_b32 v4, 4, v4
    buffer_load_dwordx4 v19, s[12:15], s34 offen offset:3072 lds
    v_add_u32 v4, 19922944, v4
    v_and_b32 v5, 31, v1
    s_mov_b32 s33, 896
    s_add_u32 m0, s36, 49152
    s_nop 0
    buffer_load_dwordx4 v8, s[8:11], s33 offen offset:0 lds
    v_cmp_eq_u32 vcc, 0, v5
    v_mov_b32 v21, 0x7f000000
    buffer_load_dwordx4 v9, s[8:11], s33 offen offset:1024 lds
    v_cndmask_b32 v4, v21, v4, vcc
    v_mov_b32 v102, v96
    buffer_load_dwordx4 v10, s[8:11], s33 offen offset:2048 lds
    v_mov_b32 v103, v97
    buffer_store_dwordx4 v[100:103], v4, s[20:23], 0 offen sc1
    buffer_load_dwordx4 v11, s[8:11], s33 offen offset:3072 lds
    s_add_u32 m0, s36, 53248
    s_nop 0
    buffer_load_dwordx4 v12, s[8:11], s33 offen offset:0 lds
    buffer_load_dwordx4 v13, s[8:11], s33 offen offset:1024 lds
    buffer_load_dwordx4 v14, s[8:11], s33 offen offset:2048 lds
    buffer_load_dwordx4 v15, s[8:11], s33 offen offset:3072 lds
    s_waitcnt vmcnt(13)
    s_barrier
    s_mov_b32 s34, 1024
    s_add_u32 m0, s37, 98304
    s_nop 0
    buffer_load_dwordx4 v16, s[12:15], s34 offen offset:0 lds
    s_lshl_b32 s40, s29, 8
    buffer_load_dwordx4 v17, s[12:15], s34 offen offset:1024 lds
    s_lshl_b32 s41, s31, 6
    buffer_load_dwordx4 v18, s[12:15], s34 offen offset:2048 lds
    s_add_u32 s40, s40, s41
    buffer_load_dwordx4 v19, s[12:15], s34 offen offset:3072 lds
    s_lshl_b32 s40, s40, 4
    s_mov_b32 s33, 1024
    s_add_u32 m0, s36, 98304
    s_nop 0
    buffer_load_dwordx4 v8, s[8:11], s33 offen offset:0 lds
    s_add_u32 s86, s40, 19922944
    buffer_load_dwordx4 v9, s[8:11], s33 offen offset:1024 lds
    v_lshlrev_b32 v98, 4, v1
    buffer_load_dwordx4 v10, s[8:11], s33 offen offset:2048 lds
    buffer_load_dwordx4 v11, s[8:11], s33 offen offset:3072 lds
    s_add_u32 m0, s36, 102400
    s_nop 0
    buffer_load_dwordx4 v12, s[8:11], s33 offen offset:0 lds
    buffer_load_dwordx4 v13, s[8:11], s33 offen offset:1024 lds
    buffer_load_dwordx4 v14, s[8:11], s33 offen offset:2048 lds
    buffer_load_dwordx4 v15, s[8:11], s33 offen offset:3072 lds
    s_waitcnt vmcnt(12)
    buffer_load_dwordx4 v[64:67], v58, s[76:79], s84 offen
    s_add_u32 s84, s84, s85
    buffer_load_dwordx4 v[68:71], v58, s[76:79], s84 offen
    s_add_u32 s84, s84, s85
    buffer_load_dwordx4 v[72:75], v58, s[76:79], s84 offen
    s_add_u32 s84, s84, s85
    buffer_load_dwordx4 v[76:79], v58, s[76:79], s84 offen
    s_add_u32 s84, s84, s85
    buffer_load_dwordx4 v[104:107], v98, s[20:23], s86 offen sc1
    s_barrier
    s_mov_b32 s34, 1152
    s_add_u32 m0, s37, 0
    s_nop 0
    buffer_load_dwordx4 v16, s[12:15], s34 offen offset:0 lds
    buffer_load_dwordx4 v17, s[12:15], s34 offen offset:1024 lds
    buffer_load_dwordx4 v18, s[12:15], s34 offen offset:2048 lds
    buffer_load_dwordx4 v19, s[12:15], s34 offen offset:3072 lds
    s_mov_b32 s33, 1152
    s_add_u32 m0, s36, 0
    s_nop 0
    buffer_load_dwordx4 v8, s[8:11], s33 offen offset:0 lds
    buffer_load_dwordx4 v9, s[8:11], s33 offen offset:1024 lds
    buffer_load_dwordx4 v10, s[8:11], s33 offen offset:2048 lds
    buffer_load_dwordx4 v11, s[8:11], s33 offen offset:3072 lds
    s_add_u32 m0, s36, 4096
    s_nop 0
    buffer_load_dwordx4 v12, s[8:11], s33 offen offset:0 lds
    buffer_load_dwordx4 v13, s[8:11], s33 offen offset:1024 lds
    buffer_load_dwordx4 v14, s[8:11], s33 offen offset:2048 lds
    buffer_load_dwordx4 v15, s[8:11], s33 offen offset:3072 lds
    s_waitcnt vmcnt(17)
    s_mov_b32 s84, 0
    buffer_load_dwordx4 v[80:83], v58, s[80:83], s84 offen
    s_add_u32 s84, s84, s85
    buffer_load_dwordx4 v[84:87], v58, s[80:83], s84 offen
    s_add_u32 s84, s84, s85
    buffer_load_dwordx4 v[88:91], v58, s[80:83], s84 offen
    s_add_u32 s84, s84, s85
    buffer_load_dwordx4 v[92:95], v58, s[80:83], s84 offen
    s_add_u32 s84, s84, s85
    s_barrier
    s_waitcnt vmcnt(16)
    s_mov_b32 s41, 0
L_l_chkD:
    v_xor_b32 v4, v106, v96
    v_xor_b32 v5, v107, v97
    v_or_b32 v4, v4, v5
    v_cmp_ne_u32 vcc, 0, v4
    s_nop 0
    s_cmp_eq_u64 vcc, 0
    s_cbranch_scc1 L_l_gotD
    s_add_u32 s41, s41, 1
    s_cmp_ge_u32 s41, 65536
    s_cbranch_scc1 L_l_gotD
    s_sleep 4
    buffer_load_dwordx4 v[104:107], v98, s[20:23], s86 offen sc1
    s_waitcnt vmcnt(0)
    s_branch L_l_chkD
L_l_gotD:
    s_lshl_b32 s40, s31, 8
    v_lshlrev_b32 v4, 2, v1
    v_add_u32 v4, s40, v4
    v_add_u32 v4, 49152, v4
    ds_write_b32 v4, v104
    ds_write_b32 v4, v105 offset:1024
    s_waitcnt vmcnt(4)
    s_waitcnt lgkmcnt(0)
    s_barrier
    s_waitcnt vmcnt(0)
    s_lshl_b32 s93, s31, 12
    s_add_u32 s93, s93, 147456
    v_lshlrev_b32 v60, 4, v1
    v_add_u32 v61, s93, v60
    s_cmp_eq_u32 s46, 1
    s_cbranch_scc1 L_rl_a_pD
    s_cmp_eq_u32 s46, 0
    s_cbranch_scc0 L_rl_a_nD
    ds_write_b128 v61, v[64:67] offset:0
    ds_write_b128 v61, v[68:71] offset:1024
    ds_write_b128 v61, v[72:75] offset:2048
    ds_write_b128 v61, v[76:79] offset:3072
    v_lshrrev_b32 v62, 4, v1
    v_lshlrev_b32 v62, 2, v62
    v_and_b32 v63, 15, v1
    v_lshrrev_b32 v63, 2, v63
    v_add_u32 v62, v62, v63
    v_lshlrev_b32 v62, 7, v62
    v_and_b32 v63, 3, v1
    v_lshlrev_b32 v63, 3, v63
    v_add_u32 v62, v62, v63
    v_add_u32 v62, s93, v62
    ds_read_b64_tr_b16 v[80:81], v62 offset:0
    ds_read_b64_tr_b16 v[82:83], v62 offset:2048
    ds_read_b64_tr_b16 v[84:85], v62 offset:32
    ds_read_b64_tr_b16 v[86:87], v62 offset:2080
    ds_read_b64_tr_b16 v[88:89], v62 offset:64
    ds_read_b64_tr_b16 v[90:91], v62 offset:2112
    ds_read_b64_tr_b16 v[92:93], v62 offset:96
    ds_read_b64_tr_b16 v[94:95], v62 offset:2144
    s_branch L_rl_a_eD
L_rl_a_nD:
    s_branch L_rl_a_eD
L_rl_a_pD:
    v_lshlrev_b32 v62, 6, v1
    v_add_u32 v62, s93, v62
    ds_write_b128 v61, v[64:67] offset:0
    ds_write_b128 v61, v[68:71] offset:1024
    ds_write_b128 v61, v[72:75] offset:2048
    ds_write_b128 v61, v[76:79] offset:3072
    ds_read_b128 v[64:67], v62 offset:0
    ds_read_b128 v[68:71], v62 offset:16
    ds_read_b128 v[72:75], v62 offset:32
    ds_read_b128 v[76:79], v62 offset:48
    ds_write_b128 v61, v[80:83] offset:0
    ds_write_b128 v61, v[84:87] offset:1024
    ds_write_b128 v61, v[88:91] offset:2048
    ds_write_b128 v61, v[92:95] offset:3072
    ds_read_b128 v[80:83], v62 offset:0
    ds_read_b128 v[84:87], v62 offset:16
    ds_read_b128 v[88:91], v62 offset:32
    ds_read_b128 v[92:95], v62 offset:48
L_rl_a_eD:
    s_cmp_eq_u32 s46, 1
    s_cbranch_scc1 L_rl_b_pD
    s_branch L_rl_b_eD
L_rl_b_pD:
    v_lshlrev_b32 v62, 2, v1
    v_add_u32 v62, s93, v62
    s_mov_b32 s90, 0x05040100
    s_mov_b32 s91, 0x07060302
    s_lshl_b32 s92, s62, 8
    s_lshl_b32 s41, s63, 13
    s_add_u32 s92, s92, s41
    s_add_u32 s92, s92, 13631488
    v_lshrrev_b32 v63, 4, v1
    v_lshlrev_b32 v63, 13, v63
    v_and_b32 v124, 15, v1
    v_lshlrev_b32 v124, 4, v124
    v_add_u32 v63, v63, v124
    s_waitcnt lgkmcnt(0)
    v_perm_b32 v120, v80, v64, s90
    ds_write_b32 v62, v120 offset:0
    v_perm_b32 v121, v80, v64, s91
    ds_write_b32 v62, v121 offset:256
    v_perm_b32 v122, v81, v65, s90
    ds_write_b32 v62, v122 offset:512
    v_perm_b32 v123, v81, v65, s91
    ds_write_b32 v62, v123 offset:768
    v_perm_b32 v120, v82, v66, s90
    ds_write_b32 v62, v120 offset:1024
    v_perm_b32 v121, v82, v66, s91
    ds_write_b32 v62, v121 offset:1280
    v_perm_b32 v122, v83, v67, s90
    ds_write_b32 v62, v122 offset:1536
    v_perm_b32 v123, v83, v67, s91
    ds_write_b32 v62, v123 offset:1792
    v_perm_b32 v120, v84, v68, s90
    ds_write_b32 v62, v120 offset:2048
    v_perm_b32 v121, v84, v68, s91
    ds_write_b32 v62, v121 offset:2304
    v_perm_b32 v122, v85, v69, s90
    ds_write_b32 v62, v122 offset:2560
    v_perm_b32 v123, v85, v69, s91
    ds_write_b32 v62, v123 offset:2816
    v_perm_b32 v120, v86, v70, s90
    ds_write_b32 v62, v120 offset:3072
    v_perm_b32 v121, v86, v70, s91
    ds_write_b32 v62, v121 offset:3328
    v_perm_b32 v122, v87, v71, s90
    ds_write_b32 v62, v122 offset:3584
    v_perm_b32 v123, v87, v71, s91
    ds_write_b32 v62, v123 offset:3840
    ds_read_b128 v[64:67], v61 offset:0
    ds_read_b128 v[68:71], v61 offset:1024
    ds_read_b128 v[80:83], v61 offset:2048
    ds_read_b128 v[84:87], v61 offset:3072
L_rl_b_eD:
    s_cmp_eq_u32 s46, 1
    s_cbranch_scc1 L_rl_c_pD
    s_cmp_eq_u32 s46, 0
    s_cbranch_scc0 L_rl_c_nD
    s_lshl_b32 s40, s63, 2
    s_mul_i32 s40, s40, 54
    s_add_u32 s40, s40, s62
    s_lshl_b32 s40, s40, 10
    s_add_u32 s40, s40, 16777216
    s_waitcnt lgkmcnt(0)
    buffer_store_dwordx4 v[80:83], v60, s[20:23], s40 offen sc1
    s_add_u32 s40, s40, 55296
    buffer_store_dwordx4 v[84:87], v60, s[20:23], s40 offen sc1
    s_add_u32 s40, s40, 55296
    buffer_store_dwordx4 v[88:91], v60, s[20:23], s40 offen sc1
    s_add_u32 s40, s40, 55296
    buffer_store_dwordx4 v[92:95], v60, s[20:23], s40 offen sc1
    s_add_u32 s40, s40, 55296
    s_branch L_rl_c_eD
L_rl_c_nD:
    v_mov_b32 v125, 0x7f000000
    buffer_store_dword v125, v125, s[20:23], 0 offen
    buffer_store_dword v125, v125, s[20:23], 0 offen
    buffer_store_dword v125, v125, s[20:23], 0 offen
    buffer_store_dword v125, v125, s[20:23], 0 offen
    s_branch L_rl_c_eD
L_rl_c_pD:
    s_waitcnt lgkmcnt(0)
    buffer_store_dwordx4 v[64:67], v63, s[20:23], s92 offen sc1
    s_add_u32 s92, s92, 32768
    buffer_store_dwordx4 v[68:71], v63, s[20:23], s92 offen sc1
    s_add_u32 s92, s92, 32768
    buffer_store_dwordx4 v[80:83], v63, s[20:23], s92 offen sc1
    s_add_u32 s92, s92, 32768
    buffer_store_dwordx4 v[84:87], v63, s[20:23], s92 offen sc1
    s_add_u32 s92, s92, 32768
    v_perm_b32 v120, v88, v72, s90
    ds_write_b32 v62, v120 offset:0
    v_perm_b32 v121, v88, v72, s91
    ds_write_b32 v62, v121 offset:256
    v_perm_b32 v122, v89, v73, s90
    ds_write_b32 v62, v122 offset:512
    v_perm_b32 v123, v89, v73, s91
    ds_write_b32 v62, v123 offset:768
    v_perm_b32 v120, v90, v74, s90
    ds_write_b32 v62, v120 offset:1024
    v_perm_b32 v121, v90, v74, s91
    ds_write_b32 v62, v121 offset:1280
    v_perm_b32 v122, v91, v75, s90
    ds_write_b32 v62, v122 offset:1536
    v_perm_b32 v123, v91, v75, s91
    ds_write_b32 v62, v123 offset:1792
    v_perm_b32 v120, v92, v76, s90
    ds_write_b32 v62, v120 offset:2048
    v_perm_b32 v121, v92, v76, s91
    ds_write_b32 v62, v121 offset:2304
    v_perm_b32 v122, v93, v77, s90
    ds_write_b32 v62, v122 offset:2560
    v_perm_b32 v123, v93, v77, s91
    ds_write_b32 v62, v123 offset:2816
    v_perm_b32 v120, v94, v78, s90
    ds_write_b32 v62, v120 offset:3072
    v_perm_b32 v121, v94, v78, s91
    ds_write_b32 v62, v121 offset:3328
    v_perm_b32 v122, v95, v79, s90
    ds_write_b32 v62, v122 offset:3584
    v_perm_b32 v123, v95, v79, s91
    ds_write_b32 v62, v123 offset:3840
    ds_read_b128 v[72:75], v61 offset:0
    ds_read_b128 v[76:79], v61 offset:1024
    ds_read_b128 v[88:91], v61 offset:2048
    ds_read_b128 v[92:95], v61 offset:3072
L_rl_c_eD:
    s_cmp_eq_u32 s46, 1
    s_cbranch_scc1 L_rl_d_pD
    v_mov_b32 v125, 0x7f000000
    buffer_store_dword v125, v125, s[20:23], 0 offen
    buffer_store_dword v125, v125, s[20:23], 0 offen
    buffer_store_dword v125, v125, s[20:23], 0 offen
    buffer_store_dword v125, v125, s[20:23], 0 offen
    s_branch L_rl_d_eD
L_rl_d_pD:
    s_waitcnt lgkmcnt(0)
    buffer_store_dwordx4 v[72:75], v63, s[20:23], s92 offen sc1
    s_add_u32 s92, s92, 32768
    buffer_store_dwordx4 v[76:79], v63, s[20:23], s92 offen sc1
    s_add_u32 s92, s92, 32768
    buffer_store_dwordx4 v[88:91], v63, s[20:23], s92 offen sc1
    s_add_u32 s92, s92, 32768
    buffer_store_dwordx4 v[92:95], v63, s[20:23], s92 offen sc1
    s_add_u32 s92, s92, 32768
L_rl_d_eD:
    s_endpgm
L_k1_mfma:
    s_cmp_ge_u32 s30, 27
    s_cbranch_scc1 L_k1_dft
    v_and_b32 v4, 15, v1
    v_lshrrev_b32 v5, 4, v1
    s_lshl_b32 s36, s28, 13
    v_lshrrev_b32 v6, 1, v4
    v_lshlrev_b32 v7, 7, v4
    v_add_u32 v7, s36, v7
    v_or_b32 v14, 0, v5
    v_xor_b32 v14, v14, v6
    v_lshlrev_b32 v14, 4, v14
    v_add_u32 v8, v7, v14
    v_or_b32 v14, 4, v5
    v_xor_b32 v14, v14, v6
    v_lshlrev_b32 v14, 4, v14
    v_add_u32 v9, v7, v14
    v_lshrrev_b32 v14, 5, v1
    v_lshlrev_b32 v14, 12, v14
    v_and_b32 v15, 1, v5
    v_lshlrev_b32 v16, 3, v15
    v_lshrrev_b32 v17, 2, v4
    v_add_u32 v16, v16, v17
    v_lshlrev_b32 v16, 7, v16
    v_add_u32 v14, v14, v16
    v_and_b32 v16, 3, v1
    v_lshlrev_b32 v16, 3, v16
    v_add_u32 v14, v14, v16
    v_add_u32 v14, 32768, v14
    v_lshrrev_b32 v17, 1, v17
    v_lshlrev_b32 v15, 1, v15
    v_or_b32 v15, v15, v17
    v_xor_b32 v16, 0, v15
    v_lshlrev_b32 v16, 5, v16
    v_add_u32 v10, v14, v16
    v_xor_b32 v16, 1, v15
    v_lshlrev_b32 v16, 5, v16
    v_add_u32 v11, v14, v16
    v_xor_b32 v16, 2, v15
    v_lshlrev_b32 v16, 5, v16
    v_add_u32 v12, v14, v16
    v_xor_b32 v16, 3, v15
    v_lshlrev_b32 v16, 5, v16
    v_add_u32 v13, v14, v16
    v_mov_b32 v128, 0
    v_mov_b32 v129, 0
    v_mov_b32 v130, 0
    v_mov_b32 v131, 0
    v_mov_b32 v132, 0
    v_mov_b32 v133, 0
    v_mov_b32 v134, 0
    v_mov_b32 v135, 0
    v_mov_b32 v136, 0
    v_mov_b32 v137, 0
    v_mov_b32 v138, 0
    v_mov_b32 v139, 0
    v_mov_b32 v140, 0
    v_mov_b32 v141, 0
    v_mov_b32 v142, 0
    v_mov_b32 v143, 0
    v_mov_b32 v144, 0
    v_mov_b32 v145, 0
    v_mov_b32 v146, 0
    v_mov_b32 v147, 0
    v_mov_b32 v148, 0
    v_mov_b32 v149, 0
    v_mov_b32 v150, 0
    v_mov_b32 v151, 0
    v_mov_b32 v152, 0
    v_mov_b32 v153, 0
    v_mov_b32 v154, 0
    v_mov_b32 v155, 0
    v_mov_b32 v156, 0
    v_mov_b32 v157, 0
    v_mov_b32 v158, 0
    v_mov_b32 v159, 0
    v_mov_b32 v160, 0
    v_mov_b32 v161, 0
    v_mov_b32 v162, 0
    v_mov_b32 v163, 0
    v_mov_b32 v164, 0
    v_mov_b32 v165, 0
    v_mov_b32 v166, 0
    v_mov_b32 v167, 0
    v_mov_b32 v168, 0
    v_mov_b32 v169, 0
    v_mov_b32 v170, 0
    v_mov_b32 v171, 0
    v_mov_b32 v172, 0
    v_mov_b32 v173, 0
    v_mov_b32 v174, 0
    v_mov_b32 v175, 0
    v_mov_b32 v176, 0
    v_mov_b32 v177, 0
    v_mov_b32 v178, 0
    v_mov_b32 v179, 0
    v_mov_b32 v180, 0
    v_mov_b32 v181, 0
    v_mov_b32 v182, 0
    v_mov_b32 v183, 0
    v_mov_b32 v184, 0
    v_mov_b32 v185, 0
    v_mov_b32 v186, 0
    v_mov_b32 v187, 0
    v_mov_b32 v188, 0
    v_mov_b32 v189, 0
    v_mov_b32 v190, 0
    v_mov_b32 v191, 0
    v_mov_b32 v192, 0
    v_mov_b32 v193, 0
    v_mov_b32 v194, 0
    v_mov_b32 v195, 0
    v_mov_b32 v196, 0
    v_mov_b32 v197, 0
    v_mov_b32 v198, 0
    v_mov_b32 v199, 0
    v_mov_b32 v200, 0
    v_mov_b32 v201, 0
    v_mov_b32 v202, 0
    v_mov_b32 v203, 0
    v_mov_b32 v204, 0
    v_mov_b32 v205, 0
    v_mov_b32 v206, 0
    v_mov_b32 v207, 0
    v_mov_b32 v208, 0
    v_mov_b32 v209, 0
    v_mov_b32 v210, 0
    v_mov_b32 v211, 0
    v_mov_b32 v212, 0
    v_mov_b32 v213, 0
    v_mov_b32 v214, 0
    v_mov_b32 v215, 0
    v_mov_b32 v216, 0
    v_mov_b32 v217, 0
    v_mov_b32 v218, 0
    v_mov_b32 v219, 0
    v_mov_b32 v220, 0
    v_mov_b32 v221, 0
    v_mov_b32 v222, 0
    v_mov_b32 v223, 0
    v_mov_b32 v224, 0
    v_mov_b32 v225, 0
    v_mov_b32 v226, 0
    v_mov_b32 v227, 0
    v_mov_b32 v228, 0
    v_mov_b32 v229, 0
    v_mov_b32 v230, 0
    v_mov_b32 v231, 0
    v_mov_b32 v232, 0
    v_mov_b32 v233, 0
    v_mov_b32 v234, 0
    v_mov_b32 v235, 0
    v_mov_b32 v236, 0
    v_mov_b32 v237, 0
    v_mov_b32 v238, 0
    v_mov_b32 v239, 0
    v_mov_b32 v240, 0
    v_mov_b32 v241, 0
    v_mov_b32 v242, 0
    v_mov_b32 v243, 0
    v_mov_b32 v244, 0
    v_mov_b32 v245, 0
    v_mov_b32 v246, 0
    v_mov_b32 v247, 0
    v_mov_b32 v248, 0
    v_mov_b32 v249, 0
    v_mov_b32 v250, 0
    v_mov_b32 v251, 0
    v_mov_b32 v252, 0
    v_mov_b32 v253, 0
    v_mov_b32 v254, 0
    v_mov_b32 v255, 0
    v_mov_b32 v32, 0
    v_mov_b32 v33, 0
    v_mov_b32 v34, 0
    v_mov_b32 v35, 0
    v_mov_b32 v36, 0
    v_mov_b32 v37, 0
    v_mov_b32 v38, 0
    v_mov_b32 v39, 0
    v_mov_b32 v40, 0
    v_mov_b32 v41, 0
    v_mov_b32 v42, 0
    v_mov_b32 v43, 0
    v_mov_b32 v44, 0
    v_mov_b32 v45, 0
    v_mov_b32 v46, 0
    v_mov_b32 v47, 0
    v_mov_b32 v48, 0
    v_mov_b32 v49, 0
    v_mov_b32 v50, 0
    v_mov_b32 v51, 0
    v_mov_b32 v52, 0
    v_mov_b32 v53, 0
    v_mov_b32 v54, 0
    v_mov_b32 v55, 0
    v_mov_b32 v56, 0
    v_mov_b32 v57, 0
    v_mov_b32 v58, 0
    v_mov_b32 v59, 0
    v_mov_b32 v60, 0
    v_mov_b32 v61, 0
    v_mov_b32 v62, 0
    v_mov_b32 v63, 0
    v_mov_b32 v64, 0
    v_mov_b32 v65, 0
    v_mov_b32 v66, 0
    v_mov_b32 v67, 0
    v_mov_b32 v68, 0
    v_mov_b32 v69, 0
    v_mov_b32 v70, 0
    v_mov_b32 v71, 0
    v_mov_b32 v72, 0
    v_mov_b32 v73, 0
    v_mov_b32 v74, 0
    v_mov_b32 v75, 0
    v_mov_b32 v76, 0
    v_mov_b32 v77, 0
    v_mov_b32 v78, 0
    v_mov_b32 v79, 0
    s_mov_b32 s35, 0
    s_mov_b32 s39, 0
    s_mov_b32 s74, 4294868992
    s_mov_b32 s75, 49152
    s_waitcnt lgkmcnt(0)
    s_mov_b32 s8, s4
    s_mov_b32 s9, s5
    s_mov_b32 s10, 2621440
    s_mov_b32 s11, 0x00020000
    s_cmp_ge_u32 s30, 27
    s_cselect_b32 s12, s68, s64
    s_cselect_b32 s13, s69, s65
    s_mov_b32 s14, 2211840
    s_cselect_b32 s14, 819200, s14
    s_mov_b32 s15, 0x00020000
    s_sub_u32 s16, s66, 2048
    s_subb_u32 s17, s67, 0
    s_mov_b32 s18, 2213888
    s_mov_b32 s19, 0x00020000
    s_mov_b32 s20, s6
    s_mov_b32 s21, s7
    s_mov_b32 s22, 25165824
    s_mov_b32 s23, 0x00020000
    s_mov_b32 s58, s66
    s_mov_b32 s59, s67
    v_lshlrev_b32 v24, 20, v1
    s_cmp_eq_u32 s28, 0
    s_cbranch_scc0 L_pt1G
    v_cmp_gt_u32 vcc, 20, v1
    v_mov_b32 v25, 0x7f000000
    s_nop 0
    v_cndmask_b32 v24, v25, v24, vcc
    buffer_load_dword v20, v24, s[20:23], 0 offen
    s_branch L_pteG
L_pt1G:
    s_cmp_eq_u32 s28, 1
    s_cbranch_scc0 L_pt2G
    s_mov_b32 s76, s56
    s_mov_b32 s77, s57
    s_mov_b32 s78, 2211840
    s_mov_b32 s79, 0x00020000
    buffer_load_dword v20, v24, s[76:79], 0 offen
    s_load_dwordx2 s[80:81], s[0:1], 56
    s_waitcnt lgkmcnt(0)
    s_mov_b32 s76, s80
    s_mov_b32 s77, s81
    s_mov_b32 s78, 2621440
    s_mov_b32 s79, 0x00020000
    buffer_load_dword v21, v24, s[76:79], 0 offen
    s_branch L_pteG
L_pt2G:
    s_cmp_eq_u32 s28, 2
    s_cbranch_scc0 L_pt3G
    s_mov_b32 s76, s52
    s_mov_b32 s77, s53
    s_mov_b32 s78, 1314816
    s_mov_b32 s79, 0x00020000
    buffer_load_dword v20, v24, s[76:79], 0 offen
    s_mov_b32 s76, s54
    s_mov_b32 s77, s55
    s_mov_b32 s78, 1314816
    s_mov_b32 s79, 0x00020000
    buffer_load_dword v21, v24, s[76:79], 0 offen
    s_branch L_pteG
L_pt3G:
    s_getpc_b64 s[80:81]
    s_add_u32 s80, s80, gf_table@rel32@lo+4
    s_addc_u32 s81, s81, gf_table@rel32@hi+12
    s_mov_b32 s76, s80
    s_mov_b32 s77, s81
    s_mov_b32 s78, 819200
    s_mov_b32 s79, 0x00020000
    buffer_load_dword v20, v24, s[76:79], 0 offen
    s_mov_b32 s76, s50
    s_mov_b32 s77, s51
    s_mov_b32 s78, 256
    s_mov_b32 s79, 0x00020000
    buffer_load_dword v21, v24, s[76:79], 0 offen offset:128
L_pteG:
L_loopG:
    s_waitcnt lgkmcnt(0)
    s_barrier
    v_mfma_f32_16x16x32_bf16 v[128:131], v[48:51], v[32:35], v[128:131]
    ds_read_b128 v[80:83], v8 offset:0
    ds_read_b128 v[84:87], v8 offset:2048
    v_mfma_f32_16x16x32_bf16 v[144:147], v[52:55], v[32:35], v[144:147]
    ds_read_b128 v[88:91], v8 offset:4096
    ds_read_b128 v[92:95], v8 offset:6144
    v_mfma_f32_16x16x32_bf16 v[160:163], v[56:59], v[32:35], v[160:163]
    ds_read_b64_tr_b16 v[96:97], v10 offset:0
    ds_read_b64_tr_b16 v[98:99], v10 offset:512
    v_mfma_f32_16x16x32_bf16 v[176:179], v[60:63], v[32:35], v[176:179]
    ds_read_b64_tr_b16 v[100:101], v11 offset:0
    ds_read_b64_tr_b16 v[102:103], v11 offset:512
    v_mfma_f32_16x16x32_bf16 v[192:195], v[64:67], v[32:35], v[192:195]
    ds_read_b64_tr_b16 v[104:105], v12 offset:0
    ds_read_b64_tr_b16 v[106:107], v12 offset:512
    v_mfma_f32_16x16x32_bf16 v[208:211], v[68:71], v[32:35], v[208:211]
    ds_read_b64_tr_b16 v[108:109], v13 offset:0
    ds_read_b64_tr_b16 v[110:111], v13 offset:512
    v_mfma_f32_16x16x32_bf16 v[224:227], v[72:75], v[32:35], v[224:227]
    ds_read_b64_tr_b16 v[112:113], v10 offset:2048
    v_mfma_f32_16x16x32_bf16 v[240:243], v[76:79], v[32:35], v[240:243]
    ds_read_b64_tr_b16 v[114:115], v10 offset:2560
    v_mfma_f32_16x16x32_bf16 v[132:135], v[48:51], v[36:39], v[132:135]
    ds_read_b64_tr_b16 v[116:117], v11 offset:2048
    v_mfma_f32_16x16x32_bf16 v[148:151], v[52:55], v[36:39], v[148:151]
    ds_read_b64_tr_b16 v[118:119], v11 offset:2560
    v_mfma_f32_16x16x32_bf16 v[164:167], v[56:59], v[36:39], v[164:167]
    ds_read_b64_tr_b16 v[120:121], v12 offset:2048
    v_mfma_f32_16x16x32_bf16 v[180:183], v[60:63], v[36:39], v[180:183]
    ds_read_b64_tr_b16 v[122:123], v12 offset:2560
    v_mfma_f32_16x16x32_bf16 v[196:199], v[64:67], v[36:39], v[196:199]
    ds_read_b64_tr_b16 v[124:125], v13 offset:2048
    v_mfma_f32_16x16x32_bf16 v[212:215], v[68:71], v[36:39], v[212:215]
    ds_read_b64_tr_b16 v[126:127], v13 offset:2560
    v_mfma_f32_16x16x32_bf16 v[228:231], v[72:75], v[36:39], v[228:231]
    v_mfma_f32_16x16x32_bf16 v[244:247], v[76:79], v[36:39], v[244:247]
    v_mfma_f32_16x16x32_bf16 v[136:139], v[48:51], v[40:43], v[136:139]
    v_mfma_f32_16x16x32_bf16 v[152:155], v[52:55], v[40:43], v[152:155]
    v_mfma_f32_16x16x32_bf16 v[168:171], v[56:59], v[40:43], v[168:171]
    v_mfma_f32_16x16x32_bf16 v[184:187], v[60:63], v[40:43], v[184:187]
    v_mfma_f32_16x16x32_bf16 v[200:203], v[64:67], v[40:43], v[200:203]
    v_mfma_f32_16x16x32_bf16 v[216:219], v[68:71], v[40:43], v[216:219]
    v_mfma_f32_16x16x32_bf16 v[232:235], v[72:75], v[40:43], v[232:235]
    v_mfma_f32_16x16x32_bf16 v[248:251], v[76:79], v[40:43], v[248:251]
    v_mfma_f32_16x16x32_bf16 v[140:143], v[48:51], v[44:47], v[140:143]
    v_mfma_f32_16x16x32_bf16 v[156:159], v[52:55], v[44:47], v[156:159]
    v_mfma_f32_16x16x32_bf16 v[172:175], v[56:59], v[44:47], v[172:175]
    v_mfma_f32_16x16x32_bf16 v[188:191], v[60:63], v[44:47], v[188:191]
    v_mfma_f32_16x16x32_bf16 v[204:207], v[64:67], v[44:47], v[204:207]
    v_mfma_f32_16x16x32_bf16 v[220:223], v[68:71], v[44:47], v[220:223]
    v_mfma_f32_16x16x32_bf16 v[236:239], v[72:75], v[44:47], v[236:239]
    v_mfma_f32_16x16x32_bf16 v[252:255], v[76:79], v[44:47], v[252:255]
    s_waitcnt lgkmcnt(0)
L_loopBG:
    v_mfma_f32_16x16x32_bf16 v[128:131], v[96:99], v[80:83], v[128:131]
    ds_read_b128 v[32:35], v9 offset:0
    ds_read_b128 v[36:39], v9 offset:2048
    v_mfma_f32_16x16x32_bf16 v[144:147], v[100:103], v[80:83], v[144:147]
    ds_read_b128 v[40:43], v9 offset:4096
    ds_read_b128 v[44:47], v9 offset:6144
    v_mfma_f32_16x16x32_bf16 v[160:163], v[104:107], v[80:83], v[160:163]
    ds_read_b64_tr_b16 v[48:49], v10 offset:8192
    ds_read_b64_tr_b16 v[50:51], v10 offset:8704
    v_mfma_f32_16x16x32_bf16 v[176:179], v[108:111], v[80:83], v[176:179]
    ds_read_b64_tr_b16 v[52:53], v11 offset:8192
    ds_read_b64_tr_b16 v[54:55], v11 offset:8704
    v_mfma_f32_16x16x32_bf16 v[192:195], v[112:115], v[80:83], v[192:195]
    ds_read_b64_tr_b16 v[56:57], v12 offset:8192
    ds_read_b64_tr_b16 v[58:59], v12 offset:8704
    v_mfma_f32_16x16x32_bf16 v[208:211], v[116:119], v[80:83], v[208:211]
    ds_read_b64_tr_b16 v[60:61], v13 offset:8192
    ds_read_b64_tr_b16 v[62:63], v13 offset:8704
    v_mfma_f32_16x16x32_bf16 v[224:227], v[120:123], v[80:83], v[224:227]
    ds_read_b64_tr_b16 v[64:65], v10 offset:10240
    v_mfma_f32_16x16x32_bf16 v[240:243], v[124:127], v[80:83], v[240:243]
    ds_read_b64_tr_b16 v[66:67], v10 offset:10752
    v_mfma_f32_16x16x32_bf16 v[132:135], v[96:99], v[84:87], v[132:135]
    ds_read_b64_tr_b16 v[68:69], v11 offset:10240
    v_mfma_f32_16x16x32_bf16 v[148:151], v[100:103], v[84:87], v[148:151]
    ds_read_b64_tr_b16 v[70:71], v11 offset:10752
    v_mfma_f32_16x16x32_bf16 v[164:167], v[104:107], v[84:87], v[164:167]
    ds_read_b64_tr_b16 v[72:73], v12 offset:10240
    v_mfma_f32_16x16x32_bf16 v[180:183], v[108:111], v[84:87], v[180:183]
    ds_read_b64_tr_b16 v[74:75], v12 offset:10752
    v_mfma_f32_16x16x32_bf16 v[196:199], v[112:115], v[84:87], v[196:199]
    ds_read_b64_tr_b16 v[76:77], v13 offset:10240
    v_mfma_f32_16x16x32_bf16 v[212:215], v[116:119], v[84:87], v[212:215]
    ds_read_b64_tr_b16 v[78:79], v13 offset:10752
    v_mfma_f32_16x16x32_bf16 v[228:231], v[120:123], v[84:87], v[228:231]
    s_add_u32 s39, s39, 49152
    v_mfma_f32_16x16x32_bf16 v[244:247], v[124:127], v[84:87], v[244:247]
    s_cmp_eq_u32 s39, 147456
    v_mfma_f32_16x16x32_bf16 v[136:139], v[96:99], v[88:91], v[136:139]
    s_cselect_b32 s38, s74, s75
    v_mfma_f32_16x16x32_bf16 v[152:155], v[100:103], v[88:91], v[152:155]
    s_cselect_b32 s39, 0, s39
    v_mfma_f32_16x16x32_bf16 v[168:171], v[104:107], v[88:91], v[168:171]
    v_add_u32 v8, s38, v8
    v_mfma_f32_16x16x32_bf16 v[184:187], v[108:111], v[88:91], v[184:187]
    v_add_u32 v9, s38, v9
    v_mfma_f32_16x16x32_bf16 v[200:203], v[112:115], v[88:91], v[200:203]
    v_add_u32 v10, s38, v10
    v_mfma_f32_16x16x32_bf16 v[216:219], v[116:119], v[88:91], v[216:219]
    v_add_u32 v11, s38, v11
    v_mfma_f32_16x16x32_bf16 v[232:235], v[120:123], v[88:91], v[232:235]
    v_add_u32 v12, s38, v12
    v_mfma_f32_16x16x32_bf16 v[248:251], v[124:127], v[88:91], v[248:251]
    v_add_u32 v13, s38, v13
    v_mfma_f32_16x16x32_bf16 v[140:143], v[96:99], v[92:95], v[140:143]
    s_add_u32 s35, s35, 1
    v_mfma_f32_16x16x32_bf16 v[156:159], v[100:103], v[92:95], v[156:159]
    v_mfma_f32_16x16x32_bf16 v[172:175], v[104:107], v[92:95], v[172:175]
    v_mfma_f32_16x16x32_bf16 v[188:191], v[108:111], v[92:95], v[188:191]
    v_mfma_f32_16x16x32_bf16 v[204:207], v[112:115], v[92:95], v[204:207]
    v_mfma_f32_16x16x32_bf16 v[220:223], v[116:119], v[92:95], v[220:223]
    v_mfma_f32_16x16x32_bf16 v[236:239], v[120:123], v[92:95], v[236:239]
    v_mfma_f32_16x16x32_bf16 v[252:255], v[124:127], v[92:95], v[252:255]
    s_cmp_lt_u32 s35, 10
    s_cbranch_scc1 L_loopG
    s_waitcnt lgkmcnt(0)
    v_mfma_f32_16x16x32_bf16 v[128:131], v[48:51], v[32:35], v[128:131]
    s_lshl_b32 s40, s28, 8
    v_mfma_f32_16x16x32_bf16 v[144:147], v[52:55], v[32:35], v[144:147]
    v_lshlrev_b32 v6, 2, v4
    v_mfma_f32_16x16x32_bf16 v[160:163], v[56:59], v[32:35], v[160:163]
    v_add_u32 v6, s40, v6
    v_mfma_f32_16x16x32_bf16 v[176:179], v[60:63], v[32:35], v[176:179]
    v_add_u32 v6, 49152, v6
    v_mfma_f32_16x16x32_bf16 v[192:195], v[64:67], v[32:35], v[192:195]
    ds_read_b32 v80, v6 offset:0
    v_mfma_f32_16x16x32_bf16 v[208:211], v[68:71], v[32:35], v[208:211]
    ds_read_b32 v81, v6 offset:1024
    v_mfma_f32_16x16x32_bf16 v[224:227], v[72:75], v[32:35], v[224:227]
    ds_read_b32 v82, v6 offset:64
    v_mfma_f32_16x16x32_bf16 v[240:243], v[76:79], v[32:35], v[240:243]
    ds_read_b32 v83, v6 offset:1088
    v_mfma_f32_16x16x32_bf16 v[132:135], v[48:51], v[36:39], v[132:135]
    ds_read_b32 v84, v6 offset:128
    v_mfma_f32_16x16x32_bf16 v[148:151], v[52:55], v[36:39], v[148:151]
    ds_read_b32 v85, v6 offset:1152
    v_mfma_f32_16x16x32_bf16 v[164:167], v[56:59], v[36:39], v[164:167]
    ds_read_b32 v86, v6 offset:192
    v_mfma_f32_16x16x32_bf16 v[180:183], v[60:63], v[36:39], v[180:183]
    ds_read_b32 v87, v6 offset:1216
    v_mfma_f32_16x16x32_bf16 v[196:199], v[64:67], v[36:39], v[196:199]
    v_lshlrev_b32 v7, 4, v5
    v_mfma_f32_16x16x32_bf16 v[212:215], v[68:71], v[36:39], v[212:215]
    v_add_u32 v7, 51200, v7
    v_mfma_f32_16x16x32_bf16 v[228:231], v[72:75], v[36:39], v[228:231]
    ds_read_b128 v[88:91], v7 offset:0
    v_mfma_f32_16x16x32_bf16 v[244:247], v[76:79], v[36:39], v[244:247]
    ds_read_b128 v[92:95], v7 offset:64
    v_mfma_f32_16x16x32_bf16 v[136:139], v[48:51], v[40:43], v[136:139]
    ds_read_b128 v[96:99], v7 offset:128
    v_mfma_f32_16x16x32_bf16 v[152:155], v[52:55], v[40:43], v[152:155]
    ds_read_b128 v[100:103], v7 offset:192
    v_mfma_f32_16x16x32_bf16 v[168:171], v[56:59], v[40:43], v[168:171]
    ds_read_b128 v[104:107], v7 offset:256
    v_mfma_f32_16x16x32_bf16 v[184:187], v[60:63], v[40:43], v[184:187]
    ds_read_b128 v[108:111], v7 offset:320
    v_mfma_f32_16x16x32_bf16 v[200:203], v[64:67], v[40:43], v[200:203]
    ds_read_b128 v[112:115], v7 offset:384
    v_mfma_f32_16x16x32_bf16 v[216:219], v[68:71], v[40:43], v[216:219]
    ds_read_b128 v[116:119], v7 offset:448
    v_mfma_f32_16x16x32_bf16 v[232:235], v[72:75], v[40:43], v[232:235]
    s_lshl_b32 s40, s29, 4
    v_mfma_f32_16x16x32_bf16 v[248:251], v[76:79], v[40:43], v[248:251]
    s_lshl_b32 s41, s28, 2
    v_mfma_f32_16x16x32_bf16 v[140:143], v[48:51], v[44:47], v[140:143]
    s_add_u32 s40, s40, s41
    v_mfma_f32_16x16x32_bf16 v[156:159], v[52:55], v[44:47], v[156:159]
    s_mul_i32 s40, s40, 74
    v_mfma_f32_16x16x32_bf16 v[172:175], v[56:59], v[44:47], v[172:175]
    s_lshl_b32 s41, s30, 1
    v_mfma_f32_16x16x32_bf16 v[188:191], v[60:63], v[44:47], v[188:191]
    s_add_u32 s40, s40, s41
    v_mfma_f32_16x16x32_bf16 v[204:207], v[64:67], v[44:47], v[204:207]
    s_lshl_b32 s40, s40, 10
    v_mfma_f32_16x16x32_bf16 v[220:223], v[68:71], v[44:47], v[220:223]
    s_add_u32 s40, s40, 0
    v_mfma_f32_16x16x32_bf16 v[236:239], v[72:75], v[44:47], v[236:239]
    v_lshlrev_b32 v6, 4, v1
    v_mfma_f32_16x16x32_bf16 v[252:255], v[76:79], v[44:47], v[252:255]
    s_waitcnt lgkmcnt(0)
    v_mul_f32 v81, v81, v81
    v_mul_f32 v83, v83, v83
    v_mul_f32 v85, v85, v85
    v_mul_f32 v87, v87, v87
    v_pk_fma_f32 v[128:129], v[88:89], v[80:81], v[128:129] op_sel_hi:[1,0,1] neg_lo:[0,1,0] neg_hi:[0,1,0]
    v_pk_fma_f32 v[192:193], v[104:105], v[80:81], v[192:193] op_sel_hi:[1,0,1] neg_lo:[0,1,0] neg_hi:[0,1,0]
    v_pk_fma_f32 v[130:131], v[90:91], v[80:81], v[130:131] op_sel_hi:[1,0,1] neg_lo:[0,1,0] neg_hi:[0,1,0]
    v_pk_fma_f32 v[194:195], v[106:107], v[80:81], v[194:195] op_sel_hi:[1,0,1] neg_lo:[0,1,0] neg_hi:[0,1,0]
    v_pk_mul_f32 v[128:129], v[128:129], v[192:193]
    v_pk_mul_f32 v[130:131], v[130:131], v[194:195]
    v_pk_mul_f32 v[128:129], v[128:129], v[80:81] op_sel:[0,1] op_sel_hi:[1,1]
    v_pk_mul_f32 v[130:131], v[130:131], v[80:81] op_sel:[0,1] op_sel_hi:[1,1]
    v_cvt_pk_bf16_f32 v192, v128, v129
    v_cvt_pk_bf16_f32 v193, v130, v131
    v_pk_fma_f32 v[144:145], v[92:93], v[80:81], v[144:145] op_sel_hi:[1,0,1] neg_lo:[0,1,0] neg_hi:[0,1,0]
    v_pk_fma_f32 v[208:209], v[108:109], v[80:81], v[208:209] op_sel_hi:[1,0,1] neg_lo:[0,1,0] neg_hi:[0,1,0]
    v_pk_fma_f32 v[146:147], v[94:95], v[80:81], v[146:147] op_sel_hi:[1,0,1] neg_lo:[0,1,0] neg_hi:[0,1,0]
    v_pk_fma_f32 v[210:211], v[110:111], v[80:81], v[210:211] op_sel_hi:[1,0,1] neg_lo:[0,1,0] neg_hi:[0,1,0]
    v_pk_mul_f32 v[144:145], v[144:145], v[208:209]
    v_pk_mul_f32 v[146:147], v[146:147], v[210:211]
    v_pk_mul_f32 v[144:145], v[144:145], v[80:81] op_sel:[0,1] op_sel_hi:[1,1]
    v_pk_mul_f32 v[146:147], v[146:147], v[80:81] op_sel:[0,1] op_sel_hi:[1,1]
    v_cvt_pk_bf16_f32 v194, v144, v145
    v_cvt_pk_bf16_f32 v195, v146, v147
    s_add_u32 s41, s40, 0
    buffer_store_dwordx4 v[192:195], v6, s[20:23], s41 offen sc1
    v_pk_fma_f32 v[160:161], v[96:97], v[80:81], v[160:161] op_sel_hi:[1,0,1] neg_lo:[0,1,0] neg_hi:[0,1,0]
    v_pk_fma_f32 v[224:225], v[112:113], v[80:81], v[224:225] op_sel_hi:[1,0,1] neg_lo:[0,1,0] neg_hi:[0,1,0]
    v_pk_fma_f32 v[162:163], v[98:99], v[80:81], v[162:163] op_sel_hi:[1,0,1] neg_lo:[0,1,0] neg_hi:[0,1,0]
    v_pk_fma_f32 v[226:227], v[114:115], v[80:81], v[226:227] op_sel_hi:[1,0,1] neg_lo:[0,1,0] neg_hi:[0,1,0]
    v_pk_mul_f32 v[160:161], v[160:161], v[224:225]
    v_pk_mul_f32 v[162:163], v[162:163], v[226:227]
    v_pk_mul_f32 v[160:161], v[160:161], v[80:81] op_sel:[0,1] op_sel_hi:[1,1]
    v_pk_mul_f32 v[162:163], v[162:163], v[80:81] op_sel:[0,1] op_sel_hi:[1,1]
    v_cvt_pk_bf16_f32 v224, v160, v161
    v_cvt_pk_bf16_f32 v225, v162, v163
    v_pk_fma_f32 v[176:177], v[100:101], v[80:81], v[176:177] op_sel_hi:[1,0,1] neg_lo:[0,1,0] neg_hi:[0,1,0]
    v_pk_fma_f32 v[240:241], v[116:117], v[80:81], v[240:241] op_sel_hi:[1,0,1] neg_lo:[0,1,0] neg_hi:[0,1,0]
    v_pk_fma_f32 v[178:179], v[102:103], v[80:81], v[178:179] op_sel_hi:[1,0,1] neg_lo:[0,1,0] neg_hi:[0,1,0]
    v_pk_fma_f32 v[242:243], v[118:119], v[80:81], v[242:243] op_sel_hi:[1,0,1] neg_lo:[0,1,0] neg_hi:[0,1,0]
    v_pk_mul_f32 v[176:177], v[176:177], v[240:241]
    v_pk_mul_f32 v[178:179], v[178:179], v[242:243]
    v_pk_mul_f32 v[176:177], v[176:177], v[80:81] op_sel:[0,1] op_sel_hi:[1,1]
    v_pk_mul_f32 v[178:179], v[178:179], v[80:81] op_sel:[0,1] op_sel_hi:[1,1]
    v_cvt_pk_bf16_f32 v226, v176, v177
    v_cvt_pk_bf16_f32 v227, v178, v179
    s_add_u32 s41, s40, 1024
    buffer_store_dwordx4 v[224:227], v6, s[20:23], s41 offen sc1
    v_pk_fma_f32 v[132:133], v[88:89], v[82:83], v[132:133] op_sel_hi:[1,0,1] neg_lo:[0,1,0] neg_hi:[0,1,0]
    v_pk_fma_f32 v[196:197], v[104:105], v[82:83], v[196:197] op_sel_hi:[1,0,1] neg_lo:[0,1,0] neg_hi:[0,1,0]
    v_pk_fma_f32 v[134:135], v[90:91], v[82:83], v[134:135] op_sel_hi:[1,0,1] neg_lo:[0,1,0] neg_hi:[0,1,0]
    v_pk_fma_f32 v[198:199], v[106:107], v[82:83], v[198:199] op_sel_hi:[1,0,1] neg_lo:[0,1,0] neg_hi:[0,1,0]
    v_pk_mul_f32 v[132:133], v[132:133], v[196:197]
    v_pk_mul_f32 v[134:135], v[134:135], v[198:199]
    v_pk_mul_f32 v[132:133], v[132:133], v[82:83] op_sel:[0,1] op_sel_hi:[1,1]
    v_pk_mul_f32 v[134:135], v[134:135], v[82:83] op_sel:[0,1] op_sel_hi:[1,1]
    v_cvt_pk_bf16_f32 v196, v132, v133
    v_cvt_pk_bf16_f32 v197, v134, v135
    v_pk_fma_f32 v[148:149], v[92:93], v[82:83], v[148:149] op_sel_hi:[1,0,1] neg_lo:[0,1,0] neg_hi:[0,1,0]
    v_pk_fma_f32 v[212:213], v[108:109], v[82:83], v[212:213] op_sel_hi:[1,0,1] neg_lo:[0,1,0] neg_hi:[0,1,0]
    v_pk_fma_f32 v[150:151], v[94:95], v[82:83], v[150:151] op_sel_hi:[1,0,1] neg_lo:[0,1,0] neg_hi:[0,1,0]
    v_pk_fma_f32 v[214:215], v[110:111], v[82:83], v[214:215] op_sel_hi:[1,0,1] neg_lo:[0,1,0] neg_hi:[0,1,0]
    v_pk_mul_f32 v[148:149], v[148:149], v[212:213]
    v_pk_mul_f32 v[150:151], v[150:151], v[214:215]
    v_pk_mul_f32 v[148:149], v[148:149], v[82:83] op_sel:[0,1] op_sel_hi:[1,1]
    v_pk_mul_f32 v[150:151], v[150:151], v[82:83] op_sel:[0,1] op_sel_hi:[1,1]
    v_cvt_pk_bf16_f32 v198, v148, v149
    v_cvt_pk_bf16_f32 v199, v150, v151
    s_add_u32 s41, s40, 75776
    buffer_store_dwordx4 v[196:199], v6, s[20:23], s41 offen sc1
    v_pk_fma_f32 v[164:165], v[96:97], v[82:83], v[164:165] op_sel_hi:[1,0,1] neg_lo:[0,1,0] neg_hi:[0,1,0]
    v_pk_fma_f32 v[228:229], v[112:113], v[82:83], v[228:229] op_sel_hi:[1,0,1] neg_lo:[0,1,0] neg_hi:[0,1,0]
    v_pk_fma_f32 v[166:167], v[98:99], v[82:83], v[166:167] op_sel_hi:[1,0,1] neg_lo:[0,1,0] neg_hi:[0,1,0]
    v_pk_fma_f32 v[230:231], v[114:115], v[82:83], v[230:231] op_sel_hi:[1,0,1] neg_lo:[0,1,0] neg_hi:[0,1,0]
    v_pk_mul_f32 v[164:165], v[164:165], v[228:229]
    v_pk_mul_f32 v[166:167], v[166:167], v[230:231]
    v_pk_mul_f32 v[164:165], v[164:165], v[82:83] op_sel:[0,1] op_sel_hi:[1,1]
    v_pk_mul_f32 v[166:167], v[166:167], v[82:83] op_sel:[0,1] op_sel_hi:[1,1]
    v_cvt_pk_bf16_f32 v228, v164, v165
    v_cvt_pk_bf16_f32 v229, v166, v167
    v_pk_fma_f32 v[180:181], v[100:101], v[82:83], v[180:181] op_sel_hi:[1,0,1] neg_lo:[0,1,0] neg_hi:[0,1,0]
    v_pk_fma_f32 v[244:245], v[116:117], v[82:83], v[244:245] op_sel_hi:[1,0,1] neg_lo:[0,1,0] neg_hi:[0,1,0]
    v_pk_fma_f32 v[182:183], v[102:103], v[82:83], v[182:183] op_sel_hi:[1,0,1] neg_lo:[0,1,0] neg_hi:[0,1,0]
    v_pk_fma_f32 v[246:247], v[118:119], v[82:83], v[246:247] op_sel_hi:[1,0,1] neg_lo:[0,1,0] neg_hi:[0,1,0]
    v_pk_mul_f32 v[180:181], v[180:181], v[244:245]
    v_pk_mul_f32 v[182:183], v[182:183], v[246:247]
    v_pk_mul_f32 v[180:181], v[180:181], v[82:83] op_sel:[0,1] op_sel_hi:[1,1]
    v_pk_mul_f32 v[182:183], v[182:183], v[82:83] op_sel:[0,1] op_sel_hi:[1,1]
    v_cvt_pk_bf16_f32 v230, v180, v181
    v_cvt_pk_bf16_f32 v231, v182, v183
    s_add_u32 s41, s40, 76800
    buffer_store_dwordx4 v[228:231], v6, s[20:23], s41 offen sc1
    v_pk_fma_f32 v[136:137], v[88:89], v[84:85], v[136:137] op_sel_hi:[1,0,1] neg_lo:[0,1,0] neg_hi:[0,1,0]
    v_pk_fma_f32 v[200:201], v[104:105], v[84:85], v[200:201] op_sel_hi:[1,0,1] neg_lo:[0,1,0] neg_hi:[0,1,0]
    v_pk_fma_f32 v[138:139], v[90:91], v[84:85], v[138:139] op_sel_hi:[1,0,1] neg_lo:[0,1,0] neg_hi:[0,1,0]
    v_pk_fma_f32 v[202:203], v[106:107], v[84:85], v[202:203] op_sel_hi:[1,0,1] neg_lo:[0,1,0] neg_hi:[0,1,0]
    v_pk_mul_f32 v[136:137], v[136:137], v[200:201]
    v_pk_mul_f32 v[138:139], v[138:139], v[202:203]
    v_pk_mul_f32 v[136:137], v[136:137], v[84:85] op_sel:[0,1] op_sel_hi:[1,1]
    v_pk_mul_f32 v[138:139], v[138:139], v[84:85] op_sel:[0,1] op_sel_hi:[1,1]
    v_cvt_pk_bf16_f32 v200, v136, v137
    v_cvt_pk_bf16_f32 v201, v138, v139
    v_pk_fma_f32 v[152:153], v[92:93], v[84:85], v[152:153] op_sel_hi:[1,0,1] neg_lo:[0,1,0] neg_hi:[0,1,0]
    v_pk_fma_f32 v[216:217], v[108:109], v[84:85], v[216:217] op_sel_hi:[1,0,1] neg_lo:[0,1,0] neg_hi:[0,1,0]
    v_pk_fma_f32 v[154:155], v[94:95], v[84:85], v[154:155] op_sel_hi:[1,0,1] neg_lo:[0,1,0] neg_hi:[0,1,0]
    v_pk_fma_f32 v[218:219], v[110:111], v[84:85], v[218:219] op_sel_hi:[1,0,1] neg_lo:[0,1,0] neg_hi:[0,1,0]
    v_pk_mul_f32 v[152:153], v[152:153], v[216:217]
    v_pk_mul_f32 v[154:155], v[154:155], v[218:219]
    v_pk_mul_f32 v[152:153], v[152:153], v[84:85] op_sel:[0,1] op_sel_hi:[1,1]
    v_pk_mul_f32 v[154:155], v[154:155], v[84:85] op_sel:[0,1] op_sel_hi:[1,1]
    v_cvt_pk_bf16_f32 v202, v152, v153
    v_cvt_pk_bf16_f32 v203, v154, v155
    s_add_u32 s41, s40, 151552
    buffer_store_dwordx4 v[200:203], v6, s[20:23], s41 offen sc1
    v_pk_fma_f32 v[168:169], v[96:97], v[84:85], v[168:169] op_sel_hi:[1,0,1] neg_lo:[0,1,0] neg_hi:[0,1,0]
    v_pk_fma_f32 v[232:233], v[112:113], v[84:85], v[232:233] op_sel_hi:[1,0,1] neg_lo:[0,1,0] neg_hi:[0,1,0]
    v_pk_fma_f32 v[170:171], v[98:99], v[84:85], v[170:171] op_sel_hi:[1,0,1] neg_lo:[0,1,0] neg_hi:[0,1,0]
    v_pk_fma_f32 v[234:235], v[114:115], v[84:85], v[234:235] op_sel_hi:[1,0,1] neg_lo:[0,1,0] neg_hi:[0,1,0]
    v_pk_mul_f32 v[168:169], v[168:169], v[232:233]
    v_pk_mul_f32 v[170:171], v[170:171], v[234:235]
    v_pk_mul_f32 v[168:169], v[168:169], v[84:85] op_sel:[0,1] op_sel_hi:[1,1]
    v_pk_mul_f32 v[170:171], v[170:171], v[84:85] op_sel:[0,1] op_sel_hi:[1,1]
    v_cvt_pk_bf16_f32 v232, v168, v169
    v_cvt_pk_bf16_f32 v233, v170, v171
    v_pk_fma_f32 v[184:185], v[100:101], v[84:85], v[184:185] op_sel_hi:[1,0,1] neg_lo:[0,1,0] neg_hi:[0,1,0]
    v_pk_fma_f32 v[248:249], v[116:117], v[84:85], v[248:249] op_sel_hi:[1,0,1] neg_lo:[0,1,0] neg_hi:[0,1,0]
    v_pk_fma_f32 v[186:187], v[102:103], v[84:85], v[186:187] op_sel_hi:[1,0,1] neg_lo:[0,1,0] neg_hi:[0,1,0]
    v_pk_fma_f32 v[250:251], v[118:119], v[84:85], v[250:251] op_sel_hi:[1,0,1] neg_lo:[0,1,0] neg_hi:[0,1,0]
    v_pk_mul_f32 v[184:185], v[184:185], v[248:249]
    v_pk_mul_f32 v[186:187], v[186:187], v[250:251]
    v_pk_mul_f32 v[184:185], v[184:185], v[84:85] op_sel:[0,1] op_sel_hi:[1,1]
    v_pk_mul_f32 v[186:187], v[186:187], v[84:85] op_sel:[0,1] op_sel_hi:[1,1]
    v_cvt_pk_bf16_f32 v234, v184, v185
    v_cvt_pk_bf16_f32 v235, v186, v187
    s_add_u32 s41, s40, 152576
    buffer_store_dwordx4 v[232:235], v6, s[20:23], s41 offen sc1
    v_pk_fma_f32 v[140:141], v[88:89], v[86:87], v[140:141] op_sel_hi:[1,0,1] neg_lo:[0,1,0] neg_hi:[0,1,0]
    v_pk_fma_f32 v[204:205], v[104:105], v[86:87], v[204:205] op_sel_hi:[1,0,1] neg_lo:[0,1,0] neg_hi:[0,1,0]
    v_pk_fma_f32 v[142:143], v[90:91], v[86:87], v[142:143] op_sel_hi:[1,0,1] neg_lo:[0,1,0] neg_hi:[0,1,0]
    v_pk_fma_f32 v[206:207], v[106:107], v[86:87], v[206:207] op_sel_hi:[1,0,1] neg_lo:[0,1,0] neg_hi:[0,1,0]
    v_pk_mul_f32 v[140:141], v[140:141], v[204:205]
    v_pk_mul_f32 v[142:143], v[142:143], v[206:207]
    v_pk_mul_f32 v[140:141], v[140:141], v[86:87] op_sel:[0,1] op_sel_hi:[1,1]
    v_pk_mul_f32 v[142:143], v[142:143], v[86:87] op_sel:[0,1] op_sel_hi:[1,1]
    v_cvt_pk_bf16_f32 v204, v140, v141
    v_cvt_pk_bf16_f32 v205, v142, v143
    v_pk_fma_f32 v[156:157], v[92:93], v[86:87], v[156:157] op_sel_hi:[1,0,1] neg_lo:[0,1,0] neg_hi:[0,1,0]
    v_pk_fma_f32 v[220:221], v[108:109], v[86:87], v[220:221] op_sel_hi:[1,0,1] neg_lo:[0,1,0] neg_hi:[0,1,0]
    v_pk_fma_f32 v[158:159], v[94:95], v[86:87], v[158:159] op_sel_hi:[1,0,1] neg_lo:[0,1,0] neg_hi:[0,1,0]
    v_pk_fma_f32 v[222:223], v[110:111], v[86:87], v[222:223] op_sel_hi:[1,0,1] neg_lo:[0,1,0] neg_hi:[0,1,0]
    v_pk_mul_f32 v[156:157], v[156:157], v[220:221]
    v_pk_mul_f32 v[158:159], v[158:159], v[222:223]
    v_pk_mul_f32 v[156:157], v[156:157], v[86:87] op_sel:[0,1] op_sel_hi:[1,1]
    v_pk_mul_f32 v[158:159], v[158:159], v[86:87] op_sel:[0,1] op_sel_hi:[1,1]
    v_cvt_pk_bf16_f32 v206, v156, v157
    v_cvt_pk_bf16_f32 v207, v158, v159
    s_add_u32 s41, s40, 227328
    buffer_store_dwordx4 v[204:207], v6, s[20:23], s41 offen sc1
    v_pk_fma_f32 v[172:173], v[96:97], v[86:87], v[172:173] op_sel_hi:[1,0,1] neg_lo:[0,1,0] neg_hi:[0,1,0]
    v_pk_fma_f32 v[236:237], v[112:113], v[86:87], v[236:237] op_sel_hi:[1,0,1] neg_lo:[0,1,0] neg_hi:[0,1,0]
    v_pk_fma_f32 v[174:175], v[98:99], v[86:87], v[174:175] op_sel_hi:[1,0,1] neg_lo:[0,1,0] neg_hi:[0,1,0]
    v_pk_fma_f32 v[238:239], v[114:115], v[86:87], v[238:239] op_sel_hi:[1,0,1] neg_lo:[0,1,0] neg_hi:[0,1,0]
    v_pk_mul_f32 v[172:173], v[172:173], v[236:237]
    v_pk_mul_f32 v[174:175], v[174:175], v[238:239]
    v_pk_mul_f32 v[172:173], v[172:173], v[86:87] op_sel:[0,1] op_sel_hi:[1,1]
    v_pk_mul_f32 v[174:175], v[174:175], v[86:87] op_sel:[0,1] op_sel_hi:[1,1]
    v_cvt_pk_bf16_f32 v236, v172, v173
    v_cvt_pk_bf16_f32 v237, v174, v175
    v_pk_fma_f32 v[188:189], v[100:101], v[86:87], v[188:189] op_sel_hi:[1,0,1] neg_lo:[0,1,0] neg_hi:[0,1,0]
    v_pk_fma_f32 v[252:253], v[116:117], v[86:87], v[252:253] op_sel_hi:[1,0,1] neg_lo:[0,1,0] neg_hi:[0,1,0]
    v_pk_fma_f32 v[190:191], v[102:103], v[86:87], v[190:191] op_sel_hi:[1,0,1] neg_lo:[0,1,0] neg_hi:[0,1,0]
    v_pk_fma_f32 v[254:255], v[118:119], v[86:87], v[254:255] op_sel_hi:[1,0,1] neg_lo:[0,1,0] neg_hi:[0,1,0]
    v_pk_mul_f32 v[188:189], v[188:189], v[252:253]
    v_pk_mul_f32 v[190:191], v[190:191], v[254:255]
    v_pk_mul_f32 v[188:189], v[188:189], v[86:87] op_sel:[0,1] op_sel_hi:[1,1]
    v_pk_mul_f32 v[190:191], v[190:191], v[86:87] op_sel:[0,1] op_sel_hi:[1,1]
    v_cvt_pk_bf16_f32 v238, v188, v189
    v_cvt_pk_bf16_f32 v239, v190, v191
    s_add_u32 s41, s40, 228352
    buffer_store_dwordx4 v[236:239], v6, s[20:23], s41 offen sc1
    s_endpgm
L_k1_dft:
    v_and_b32 v4, 15, v1
    v_lshrrev_b32 v5, 4, v1
    s_lshl_b32 s36, s28, 13
    v_lshrrev_b32 v6, 2, v4
    v_lshlrev_b32 v7, 3, v6
    v_and_b32 v14, 3, v4
    v_or_b32 v7, v7, v14
    v_lshlrev_b32 v7, 7, v7
    v_lshlrev_b32 v6, 1, v6
    v_bfe_u32 v14, v4, 1, 1
    v_or_b32 v6, v6, v14
    v_add_u32 v7, s36, v7
    v_or_b32 v14, 0, v5
    v_xor_b32 v14, v14, v6
    v_lshlrev_b32 v14, 4, v14
    v_add_u32 v8, v7, v14
    v_or_b32 v14, 4, v5
    v_xor_b32 v14, v14, v6
    v_lshlrev_b32 v14, 4, v14
    v_add_u32 v9, v7, v14
    v_lshrrev_b32 v14, 1, v4
    v_lshlrev_b32 v15, 7, v4
    v_add_u32 v15, 32768, v15
    v_or_b32 v16, 0, v5
    v_xor_b32 v16, v16, v14
    v_lshlrev_b32 v16, 4, v16
    v_add_u32 v10, v15, v16
    v_or_b32 v16, 4, v5
    v_xor_b32 v16, v16, v14
    v_lshlrev_b32 v16, 4, v16
    v_add_u32 v11, v15, v16
    v_mov_b32 v128, 0
    v_mov_b32 v129, 0
    v_mov_b32 v130, 0
    v_mov_b32 v131, 0
    v_mov_b32 v132, 0
    v_mov_b32 v133, 0
    v_mov_b32 v134, 0
    v_mov_b32 v135, 0
    v_mov_b32 v136, 0
    v_mov_b32 v137, 0
    v_mov_b32 v138, 0
    v_mov_b32 v139, 0
    v_mov_b32 v140, 0
    v_mov_b32 v141, 0
    v_mov_b32 v142, 0
    v_mov_b32 v143, 0
    v_mov_b32 v144, 0
    v_mov_b32 v145, 0
    v_mov_b32 v146, 0
    v_mov_b32 v147, 0
    v_mov_b32 v148, 0
    v_mov_b32 v149, 0
    v_mov_b32 v150, 0
    v_mov_b32 v151, 0
    v_mov_b32 v152, 0
    v_mov_b32 v153, 0
    v_mov_b32 v154, 0
    v_mov_b32 v155, 0
    v_mov_b32 v156, 0
    v_mov_b32 v157, 0
    v_mov_b32 v158, 0
    v_mov_b32 v159, 0
    v_mov_b32 v160, 0
    v_mov_b32 v161, 0
    v_mov_b32 v162, 0
    v_mov_b32 v163, 0
    v_mov_b32 v164, 0
    v_mov_b32 v165, 0
    v_mov_b32 v166, 0
    v_mov_b32 v167, 0
    v_mov_b32 v168, 0
    v_mov_b32 v169, 0
    v_mov_b32 v170, 0
    v_mov_b32 v171, 0
    v_mov_b32 v172, 0
    v_mov_b32 v173, 0
    v_mov_b32 v174, 0
    v_mov_b32 v175, 0
    v_mov_b32 v176, 0
    v_mov_b32 v177, 0
    v_mov_b32 v178, 0
    v_mov_b32 v179, 0
    v_mov_b32 v180, 0
    v_mov_b32 v181, 0
    v_mov_b32 v182, 0
    v_mov_b32 v183, 0
    v_mov_b32 v184, 0
    v_mov_b32 v185, 0
    v_mov_b32 v186, 0
    v_mov_b32 v187, 0
    v_mov_b32 v188, 0
    v_mov_b32 v189, 0
    v_mov_b32 v190, 0
    v_mov_b32 v191, 0
    v_mov_b32 v192, 0
    v_mov_b32 v193, 0
    v_mov_b32 v194, 0
    v_mov_b32 v195, 0
    v_mov_b32 v196, 0
    v_mov_b32 v197, 0
    v_mov_b32 v198, 0
    v_mov_b32 v199, 0
    v_mov_b32 v200, 0
    v_mov_b32 v201, 0
    v_mov_b32 v202, 0
    v_mov_b32 v203, 0
    v_mov_b32 v204, 0
    v_mov_b32 v205, 0
    v_mov_b32 v206, 0
    v_mov_b32 v207, 0
    v_mov_b32 v208, 0
    v_mov_b32 v209, 0
    v_mov_b32 v210, 0
    v_mov_b32 v211, 0
    v_mov_b32 v212, 0
    v_mov_b32 v213, 0
    v_mov_b32 v214, 0
    v_mov_b32 v215, 0
    v_mov_b32 v216, 0
    v_mov_b32 v217, 0
    v_mov_b32 v218, 0
    v_mov_b32 v219, 0
    v_mov_b32 v220, 0
    v_mov_b32 v221, 0
    v_mov_b32 v222, 0
    v_mov_b32 v223, 0
    v_mov_b32 v224, 0
    v_mov_b32 v225, 0
    v_mov_b32 v226, 0
    v_mov_b32 v227, 0
    v_mov_b32 v228, 0
    v_mov_b32 v229, 0
    v_mov_b32 v230, 0
    v_mov_b32 v231, 0
    v_mov_b32 v232, 0
    v_mov_b32 v233, 0
    v_mov_b32 v234, 0
    v_mov_b32 v235, 0
    v_mov_b32 v236, 0
    v_mov_b32 v237, 0
    v_mov_b32 v238, 0
    v_mov_b32 v239, 0
    v_mov_b32 v240, 0
    v_mov_b32 v241, 0
    v_mov_b32 v242, 0
    v_mov_b32 v243, 0
    v_mov_b32 v244, 0
    v_mov_b32 v245, 0
    v_mov_b32 v246, 0
    v_mov_b32 v247, 0
    v_mov_b32 v248, 0
    v_mov_b32 v249, 0
    v_mov_b32 v250, 0
    v_mov_b32 v251, 0
    v_mov_b32 v252, 0
    v_mov_b32 v253, 0
    v_mov_b32 v254, 0
    v_mov_b32 v255, 0
    v_mov_b32 v32, 0
    v_mov_b32 v33, 0
    v_mov_b32 v34, 0
    v_mov_b32 v35, 0
    v_mov_b32 v36, 0
    v_mov_b32 v37, 0
    v_mov_b32 v38, 0
    v_mov_b32 v39, 0
    v_mov_b32 v40, 0
    v_mov_b32 v41, 0
    v_mov_b32 v42, 0
    v_mov_b32 v43, 0
    v_mov_b32 v44, 0
    v_mov_b32 v45, 0
    v_mov_b32 v46, 0
    v_mov_b32 v47, 0
    v_mov_b32 v48, 0
    v_mov_b32 v49, 0
    v_mov_b32 v50, 0
    v_mov_b32 v51, 0
    v_mov_b32 v52, 0
    v_mov_b32 v53, 0
    v_mov_b32 v54, 0
    v_mov_b32 v55, 0
    v_mov_b32 v56, 0
    v_mov_b32 v57, 0
    v_mov_b32 v58, 0
    v_mov_b32 v59, 0
    v_mov_b32 v60, 0
    v_mov_b32 v61, 0
    v_mov_b32 v62, 0
    v_mov_b32 v63, 0
    v_mov_b32 v64, 0
    v_mov_b32 v65, 0
    v_mov_b32 v66, 0
    v_mov_b32 v67, 0
    v_mov_b32 v68, 0
    v_mov_b32 v69, 0
    v_mov_b32 v70, 0
    v_mov_b32 v71, 0
    v_mov_b32 v72, 0
    v_mov_b32 v73, 0
    v_mov_b32 v74, 0
    v_mov_b32 v75, 0
    v_mov_b32 v76, 0
    v_mov_b32 v77, 0
    v_mov_b32 v78, 0
    v_mov_b32 v79, 0
    s_mov_b32 s35, 0
    s_mov_b32 s39, 0
    s_mov_b32 s74, 4294868992
    s_mov_b32 s75, 49152
    s_waitcnt lgkmcnt(0)
    s_mov_b32 s8, s4
    s_mov_b32 s9, s5
    s_mov_b32 s10, 2621440
    s_mov_b32 s11, 0x00020000
    s_cmp_ge_u32 s30, 27
    s_cselect_b32 s12, s68, s64
    s_cselect_b32 s13, s69, s65
    s_mov_b32 s14, 2211840
    s_cselect_b32 s14, 819200, s14
    s_mov_b32 s15, 0x00020000
    s_sub_u32 s16, s66, 2048
    s_subb_u32 s17, s67, 0
    s_mov_b32 s18, 2213888
    s_mov_b32 s19, 0x00020000
    s_mov_b32 s20, s6
    s_mov_b32 s21, s7
    s_mov_b32 s22, 25165824
    s_mov_b32 s23, 0x00020000
    s_mov_b32 s58, s66
    s_mov_b32 s59, s67
    v_lshlrev_b32 v24, 20, v1
    s_cmp_eq_u32 s28, 0
    s_cbranch_scc0 L_pt1D
    v_cmp_gt_u32 vcc, 20, v1
    v_mov_b32 v25, 0x7f000000
    s_nop 0
    v_cndmask_b32 v24, v25, v24, vcc
    buffer_load_dword v20, v24, s[20:23], 0 offen
    s_branch L_pteD
L_pt1D:
    s_cmp_eq_u32 s28, 1
    s_cbranch_scc0 L_pt2D
    s_mov_b32 s76, s56
    s_mov_b32 s77, s57
    s_mov_b32 s78, 2211840
    s_mov_b32 s79, 0x00020000
    buffer_load_dword v20, v24, s[76:79], 0 offen
    s_load_dwordx2 s[80:81], s[0:1], 56
    s_waitcnt lgkmcnt(0)
    s_mov_b32 s76, s80
    s_mov_b32 s77, s81
    s_mov_b32 s78, 2621440
    s_mov_b32 s79, 0x00020000
    buffer_load_dword v21, v24, s[76:79], 0 offen
    s_branch L_pteD
L_pt2D:
    s_cmp_eq_u32 s28, 2
    s_cbranch_scc0 L_pt3D
    s_mov_b32 s76, s52
    s_mov_b32 s77, s53
    s_mov_b32 s78, 1314816
    s_mov_b32 s79, 0x00020000
    buffer_load_dword v20, v24, s[76:79], 0 offen
    s_mov_b32 s76, s54
    s_mov_b32 s77, s55
    s_mov_b32 s78, 1314816
    s_mov_b32 s79, 0x00020000
    buffer_load_dword v21, v24, s[76:79], 0 offen
    s_branch L_pteD
L_pt3D:
    s_getpc_b64 s[80:81]
    s_add_u32 s80, s80, gf_table@rel32@lo+4
    s_addc_u32 s81, s81, gf_table@rel32@hi+12
    s_mov_b32 s76, s80
    s_mov_b32 s77, s81
    s_mov_b32 s78, 819200
    s_mov_b32 s79, 0x00020000
    buffer_load_dword v20, v24, s[76:79], 0 offen
    s_mov_b32 s76, s50
    s_mov_b32 s77, s51
    s_mov_b32 s78, 256
    s_mov_b32 s79, 0x00020000
    buffer_load_dword v21, v24, s[76:79], 0 offen offset:128
L_pteD:
    s_sub_u32 s40, s30, 27
    s_mul_i32 s40, s40, 163840
    s_and_b32 s41, s29, 3
    s_lshl_b32 s41, s41, 2
    s_add_u32 s41, s41, s28
    s_mul_i32 s41, s41, 10240
    s_add_u32 s40, s40, s41
    v_lshlrev_b32 v24, 4, v1
    buffer_load_dwordx4 v[20:23], v24, s[12:15], s40 offen
    s_add_u32 s40, s40, 1024
    buffer_load_dwordx4 v[20:23], v24, s[12:15], s40 offen
    s_add_u32 s40, s40, 1024
    buffer_load_dwordx4 v[20:23], v24, s[12:15], s40 offen
    s_add_u32 s40, s40, 1024
    buffer_load_dwordx4 v[20:23], v24, s[12:15], s40 offen
    s_add_u32 s40, s40, 1024
    buffer_load_dwordx4 v[20:23], v24, s[12:15], s40 offen
    s_add_u32 s40, s40, 1024
    buffer_load_dwordx4 v[20:23], v24, s[12:15], s40 offen
    s_add_u32 s40, s40, 1024
    buffer_load_dwordx4 v[20:23], v24, s[12:15], s40 offen
    s_add_u32 s40, s40, 1024
    buffer_load_dwordx4 v[20:23], v24, s[12:15], s40 offen
    s_add_u32 s40, s40, 1024
    buffer_load_dwordx4 v[20:23], v24, s[12:15], s40 offen
    s_add_u32 s40, s40, 1024
    buffer_load_dwordx4 v[20:23], v24, s[12:15], s40 offen
    s_add_u32 s40, s40, 1024
L_loopD:
    s_waitcnt lgkmcnt(0)
    s_barrier
    v_mfma_f32_16x16x32_bf16 v[128:131], v[32:35], v[48:51], v[128:131]
    ds_read_b128 v[80:83], v8 offset:0
    ds_read_b128 v[84:87], v8 offset:512
    v_mfma_f32_16x16x32_bf16 v[144:147], v[32:35], v[52:55], v[144:147]
    ds_read_b128 v[88:91], v8 offset:4096
    ds_read_b128 v[92:95], v8 offset:4608
    v_mfma_f32_16x16x32_bf16 v[160:163], v[32:35], v[56:59], v[160:163]
    ds_read_b128 v[96:99], v10 offset:0
    ds_read_b128 v[100:103], v10 offset:2048
    v_mfma_f32_16x16x32_bf16 v[176:179], v[32:35], v[60:63], v[176:179]
    ds_read_b128 v[104:107], v10 offset:4096
    ds_read_b128 v[108:111], v10 offset:6144
    v_mfma_f32_16x16x32_bf16 v[192:195], v[32:35], v[64:67], v[192:195]
    ds_read_b128 v[112:115], v10 offset:8192
    ds_read_b128 v[116:119], v10 offset:10240
    v_mfma_f32_16x16x32_bf16 v[208:211], v[32:35], v[68:71], v[208:211]
    ds_read_b128 v[120:123], v10 offset:12288
    ds_read_b128 v[124:127], v10 offset:14336
    v_mfma_f32_16x16x32_bf16 v[224:227], v[32:35], v[72:75], v[224:227]
    v_mfma_f32_16x16x32_bf16 v[240:243], v[32:35], v[76:79], v[240:243]
    v_mfma_f32_16x16x32_bf16 v[132:135], v[36:39], v[48:51], v[132:135]
    v_mfma_f32_16x16x32_bf16 v[148:151], v[36:39], v[52:55], v[148:151]
    v_mfma_f32_16x16x32_bf16 v[164:167], v[36:39], v[56:59], v[164:167]
    v_mfma_f32_16x16x32_bf16 v[180:183], v[36:39], v[60:63], v[180:183]
    v_mfma_f32_16x16x32_bf16 v[196:199], v[36:39], v[64:67], v[196:199]
    v_mfma_f32_16x16x32_bf16 v[212:215], v[36:39], v[68:71], v[212:215]
    v_mfma_f32_16x16x32_bf16 v[228:231], v[36:39], v[72:75], v[228:231]
    v_mfma_f32_16x16x32_bf16 v[244:247], v[36:39], v[76:79], v[244:247]
    v_mfma_f32_16x16x32_bf16 v[136:139], v[40:43], v[48:51], v[136:139]
    v_mfma_f32_16x16x32_bf16 v[152:155], v[40:43], v[52:55], v[152:155]
    v_mfma_f32_16x16x32_bf16 v[168:171], v[40:43], v[56:59], v[168:171]
    v_mfma_f32_16x16x32_bf16 v[184:187], v[40:43], v[60:63], v[184:187]
    v_mfma_f32_16x16x32_bf16 v[200:203], v[40:43], v[64:67], v[200:203]
    v_mfma_f32_16x16x32_bf16 v[216:219], v[40:43], v[68:71], v[216:219]
    v_mfma_f32_16x16x32_bf16 v[232:235], v[40:43], v[72:75], v[232:235]
    v_mfma_f32_16x16x32_bf16 v[248:251], v[40:43], v[76:79], v[248:251]
    v_mfma_f32_16x16x32_bf16 v[140:143], v[44:47], v[48:51], v[140:143]
    v_mfma_f32_16x16x32_bf16 v[156:159], v[44:47], v[52:55], v[156:159]
    v_mfma_f32_16x16x32_bf16 v[172:175], v[44:47], v[56:59], v[172:175]
    v_mfma_f32_16x16x32_bf16 v[188:191], v[44:47], v[60:63], v[188:191]
    v_mfma_f32_16x16x32_bf16 v[204:207], v[44:47], v[64:67], v[204:207]
    v_mfma_f32_16x16x32_bf16 v[220:223], v[44:47], v[68:71], v[220:223]
    v_mfma_f32_16x16x32_bf16 v[236:239], v[44:47], v[72:75], v[236:239]
    v_mfma_f32_16x16x32_bf16 v[252:255], v[44:47], v[76:79], v[252:255]
    s_waitcnt lgkmcnt(0)
L_loopBD:
    v_mfma_f32_16x16x32_bf16 v[128:131], v[80:83], v[96:99], v[128:131]
    ds_read_b128 v[32:35], v9 offset:0
    ds_read_b128 v[36:39], v9 offset:512
    v_mfma_f32_16x16x32_bf16 v[144:147], v[80:83], v[100:103], v[144:147]
    ds_read_b128 v[40:43], v9 offset:4096
    ds_read_b128 v[44:47], v9 offset:4608
    v_mfma_f32_16x16x32_bf16 v[160:163], v[80:83], v[104:107], v[160:163]
    ds_read_b128 v[48:51], v11 offset:0
    ds_read_b128 v[52:55], v11 offset:2048
    v_mfma_f32_16x16x32_bf16 v[176:179], v[80:83], v[108:111], v[176:179]
    ds_read_b128 v[56:59], v11 offset:4096
    ds_read_b128 v[60:63], v11 offset:6144
    v_mfma_f32_16x16x32_bf16 v[192:195], v[80:83], v[112:115], v[192:195]
    ds_read_b128 v[64:67], v11 offset:8192
    ds_read_b128 v[68:71], v11 offset:10240
    v_mfma_f32_16x16x32_bf16 v[208:211], v[80:83], v[116:119], v[208:211]
    ds_read_b128 v[72:75], v11 offset:12288
    ds_read_b128 v[76:79], v11 offset:14336
    v_mfma_f32_16x16x32_bf16 v[224:227], v[80:83], v[120:123], v[224:227]
    s_add_u32 s39, s39, 49152
    v_mfma_f32_16x16x32_bf16 v[240:243], v[80:83], v[124:127], v[240:243]
    s_cmp_eq_u32 s39, 147456
    v_mfma_f32_16x16x32_bf16 v[132:135], v[84:87], v[96:99], v[132:135]
    s_cselect_b32 s38, s74, s75
    v_mfma_f32_16x16x32_bf16 v[148:151], v[84:87], v[100:103], v[148:151]
    s_cselect_b32 s39, 0, s39
    v_mfma_f32_16x16x32_bf16 v[164:167], v[84:87], v[104:107], v[164:167]
    v_add_u32 v8, s38, v8
    v_mfma_f32_16x16x32_bf16 v[180:183], v[84:87], v[108:111], v[180:183]
    v_add_u32 v9, s38, v9
    v_mfma_f32_16x16x32_bf16 v[196:199], v[84:87], v[112:115], v[196:199]
    v_add_u32 v10, s38, v10
    v_mfma_f32_16x16x32_bf16 v[212:215], v[84:87], v[116:119], v[212:215]
    v_add_u32 v11, s38, v11
    v_mfma_f32_16x16x32_bf16 v[228:231], v[84:87], v[120:123], v[228:231]
    s_add_u32 s35, s35, 1
    v_mfma_f32_16x16x32_bf16 v[244:247], v[84:87], v[124:127], v[244:247]
    v_mfma_f32_16x16x32_bf16 v[136:139], v[88:91], v[96:99], v[136:139]
    v_mfma_f32_16x16x32_bf16 v[152:155], v[88:91], v[100:103], v[152:155]
    v_mfma_f32_16x16x32_bf16 v[168:171], v[88:91], v[104:107], v[168:171]
    v_mfma_f32_16x16x32_bf16 v[184:187], v[88:91], v[108:111], v[184:187]
    v_mfma_f32_16x16x32_bf16 v[200:203], v[88:91], v[112:115], v[200:203]
    v_mfma_f32_16x16x32_bf16 v[216:219], v[88:91], v[116:119], v[216:219]
    v_mfma_f32_16x16x32_bf16 v[232:235], v[88:91], v[120:123], v[232:235]
    v_mfma_f32_16x16x32_bf16 v[248:251], v[88:91], v[124:127], v[248:251]
    v_mfma_f32_16x16x32_bf16 v[140:143], v[92:95], v[96:99], v[140:143]
    v_mfma_f32_16x16x32_bf16 v[156:159], v[92:95], v[100:103], v[156:159]
    v_mfma_f32_16x16x32_bf16 v[172:175], v[92:95], v[104:107], v[172:175]
    v_mfma_f32_16x16x32_bf16 v[188:191], v[92:95], v[108:111], v[188:191]
    v_mfma_f32_16x16x32_bf16 v[204:207], v[92:95], v[112:115], v[204:207]
    v_mfma_f32_16x16x32_bf16 v[220:223], v[92:95], v[116:119], v[220:223]
    v_mfma_f32_16x16x32_bf16 v[236:239], v[92:95], v[120:123], v[236:239]
    v_mfma_f32_16x16x32_bf16 v[252:255], v[92:95], v[124:127], v[252:255]
    s_cmp_lt_u32 s35, 10
    s_cbranch_scc1 L_loopD
    s_waitcnt lgkmcnt(0)
    v_mfma_f32_16x16x32_bf16 v[128:131], v[32:35], v[48:51], v[128:131]
    s_lshl_b32 s40, s28, 8
    v_mfma_f32_16x16x32_bf16 v[144:147], v[32:35], v[52:55], v[144:147]
    v_lshlrev_b32 v6, 5, v5
    v_mfma_f32_16x16x32_bf16 v[160:163], v[32:35], v[56:59], v[160:163]
    v_add_u32 v6, s40, v6
    v_mfma_f32_16x16x32_bf16 v[176:179], v[32:35], v[60:63], v[176:179]
    v_add_u32 v6, 50176, v6
    v_mfma_f32_16x16x32_bf16 v[192:195], v[32:35], v[64:67], v[192:195]
    ds_read_b128 v[80:83], v6 offset:0
    v_mfma_f32_16x16x32_bf16 v[208:211], v[32:35], v[68:71], v[208:211]
    ds_read_b128 v[84:87], v6 offset:16
    v_mfma_f32_16x16x32_bf16 v[224:227], v[32:35], v[72:75], v[224:227]
    ds_read_b128 v[88:91], v6 offset:128
    v_mfma_f32_16x16x32_bf16 v[240:243], v[32:35], v[76:79], v[240:243]
    ds_read_b128 v[92:95], v6 offset:144
    v_mfma_f32_16x16x32_bf16 v[132:135], v[36:39], v[48:51], v[132:135]
    s_sub_u32 s41, s30, 27
    v_mfma_f32_16x16x32_bf16 v[148:151], v[36:39], v[52:55], v[148:151]
    s_lshl_b32 s41, s41, 7
    v_mfma_f32_16x16x32_bf16 v[164:167], v[36:39], v[56:59], v[164:167]
    v_add_u32 v16, s41, v4
    v_mfma_f32_16x16x32_bf16 v[180:183], v[36:39], v[60:63], v[180:183]
    s_lshl_b32 s40, s29, 5
    v_mfma_f32_16x16x32_bf16 v[196:199], v[36:39], v[64:67], v[196:199]
    s_lshl_b32 s42, s28, 3
    v_mfma_f32_16x16x32_bf16 v[212:215], v[36:39], v[68:71], v[212:215]
    s_add_u32 s40, s40, s42
    v_mfma_f32_16x16x32_bf16 v[228:231], v[36:39], v[72:75], v[228:231]
    s_mul_i32 s40, s40, 10240
    v_mfma_f32_16x16x32_bf16 v[244:247], v[36:39], v[76:79], v[244:247]
    s_add_u32 s40, s40, 10485760
    v_mfma_f32_16x16x32_bf16 v[136:139], v[40:43], v[48:51], v[136:139]
    v_mul_u32_u24 v7, 10240, v5
    v_mfma_f32_16x16x32_bf16 v[152:155], v[40:43], v[52:55], v[152:155]
    v_lshlrev_b32 v16, 4, v16
    v_mfma_f32_16x16x32_bf16 v[168:171], v[40:43], v[56:59], v[168:171]
    v_add_u32 v7, v7, v16
    v_mfma_f32_16x16x32_bf16 v[184:187], v[40:43], v[60:63], v[184:187]
    v_mfma_f32_16x16x32_bf16 v[200:203], v[40:43], v[64:67], v[200:203]
    v_mfma_f32_16x16x32_bf16 v[216:219], v[40:43], v[68:71], v[216:219]
    v_mfma_f32_16x16x32_bf16 v[232:235], v[40:43], v[72:75], v[232:235]
    v_mfma_f32_16x16x32_bf16 v[248:251], v[40:43], v[76:79], v[248:251]
    v_mfma_f32_16x16x32_bf16 v[140:143], v[44:47], v[48:51], v[140:143]
    v_mfma_f32_16x16x32_bf16 v[156:159], v[44:47], v[52:55], v[156:159]
    v_mfma_f32_16x16x32_bf16 v[172:175], v[44:47], v[56:59], v[172:175]
    v_mfma_f32_16x16x32_bf16 v[188:191], v[44:47], v[60:63], v[188:191]
    v_mfma_f32_16x16x32_bf16 v[204:207], v[44:47], v[64:67], v[204:207]
    v_mfma_f32_16x16x32_bf16 v[220:223], v[44:47], v[68:71], v[220:223]
    v_mfma_f32_16x16x32_bf16 v[236:239], v[44:47], v[72:75], v[236:239]
    v_mfma_f32_16x16x32_bf16 v[252:255], v[44:47], v[76:79], v[252:255]
    s_waitcnt lgkmcnt(0)
    v_pk_mul_f32 v[128:129], v[128:129], v[80:81]
    v_pk_mul_f32 v[130:131], v[130:131], v[82:83]
    v_cvt_pk_bf16_f32 v32, v128, v129
    v_cvt_pk_bf16_f32 v33, v130, v131
    v_pk_mul_f32 v[132:133], v[132:133], v[84:85]
    v_pk_mul_f32 v[134:135], v[134:135], v[86:87]
    v_cvt_pk_bf16_f32 v34, v132, v133
    v_cvt_pk_bf16_f32 v35, v134, v135
    s_add_u32 s41, s40, 0
    buffer_store_dwordx4 v[32:35], v7, s[20:23], s41 offen sc1
    v_pk_mul_f32 v[144:145], v[144:145], v[80:81]
    v_pk_mul_f32 v[146:147], v[146:147], v[82:83]
    v_cvt_pk_bf16_f32 v36, v144, v145
    v_cvt_pk_bf16_f32 v37, v146, v147
    v_pk_mul_f32 v[148:149], v[148:149], v[84:85]
    v_pk_mul_f32 v[150:151], v[150:151], v[86:87]
    v_cvt_pk_bf16_f32 v38, v148, v149
    v_cvt_pk_bf16_f32 v39, v150, v151
    s_add_u32 s41, s40, 256
    buffer_store_dwordx4 v[36:39], v7, s[20:23], s41 offen sc1
    v_pk_mul_f32 v[160:161], v[160:161], v[80:81]
    v_pk_mul_f32 v[162:163], v[162:163], v[82:83]
    v_cvt_pk_bf16_f32 v40, v160, v161
    v_cvt_pk_bf16_f32 v41, v162, v163
    v_pk_mul_f32 v[164:165], v[164:165], v[84:85]
    v_pk_mul_f32 v[166:167], v[166:167], v[86:87]
    v_cvt_pk_bf16_f32 v42, v164, v165
    v_cvt_pk_bf16_f32 v43, v166, v167
    s_add_u32 s41, s40, 512
    buffer_store_dwordx4 v[40:43], v7, s[20:23], s41 offen sc1
    v_pk_mul_f32 v[176:177], v[176:177], v[80:81]
    v_pk_mul_f32 v[178:179], v[178:179], v[82:83]
    v_cvt_pk_bf16_f32 v44, v176, v177
    v_cvt_pk_bf16_f32 v45, v178, v179
    v_pk_mul_f32 v[180:181], v[180:181], v[84:85]
    v_pk_mul_f32 v[182:183], v[182:183], v[86:87]
    v_cvt_pk_bf16_f32 v46, v180, v181
    v_cvt_pk_bf16_f32 v47, v182, v183
    s_add_u32 s41, s40, 768
    buffer_store_dwordx4 v[44:47], v7, s[20:23], s41 offen sc1
    v_pk_mul_f32 v[192:193], v[192:193], v[80:81]
    v_pk_mul_f32 v[194:195], v[194:195], v[82:83]
    v_cvt_pk_bf16_f32 v48, v192, v193
    v_cvt_pk_bf16_f32 v49, v194, v195
    v_pk_mul_f32 v[196:197], v[196:197], v[84:85]
    v_pk_mul_f32 v[198:199], v[198:199], v[86:87]
    v_cvt_pk_bf16_f32 v50, v196, v197
    v_cvt_pk_bf16_f32 v51, v198, v199
    s_add_u32 s41, s40, 1024
    buffer_store_dwordx4 v[48:51], v7, s[20:23], s41 offen sc1
    v_pk_mul_f32 v[208:209], v[208:209], v[80:81]
    v_pk_mul_f32 v[210:211], v[210:211], v[82:83]
    v_cvt_pk_bf16_f32 v52, v208, v209
    v_cvt_pk_bf16_f32 v53, v210, v211
    v_pk_mul_f32 v[212:213], v[212:213], v[84:85]
    v_pk_mul_f32 v[214:215], v[214:215], v[86:87]
    v_cvt_pk_bf16_f32 v54, v212, v213
    v_cvt_pk_bf16_f32 v55, v214, v215
    s_add_u32 s41, s40, 1280
    buffer_store_dwordx4 v[52:55], v7, s[20:23], s41 offen sc1
    v_pk_mul_f32 v[224:225], v[224:225], v[80:81]
    v_pk_mul_f32 v[226:227], v[226:227], v[82:83]
    v_cvt_pk_bf16_f32 v56, v224, v225
    v_cvt_pk_bf16_f32 v57, v226, v227
    v_pk_mul_f32 v[228:229], v[228:229], v[84:85]
    v_pk_mul_f32 v[230:231], v[230:231], v[86:87]
    v_cvt_pk_bf16_f32 v58, v228, v229
    v_cvt_pk_bf16_f32 v59, v230, v231
    s_add_u32 s41, s40, 1536
    buffer_store_dwordx4 v[56:59], v7, s[20:23], s41 offen sc1
    v_pk_mul_f32 v[240:241], v[240:241], v[80:81]
    v_pk_mul_f32 v[242:243], v[242:243], v[82:83]
    v_cvt_pk_bf16_f32 v60, v240, v241
    v_cvt_pk_bf16_f32 v61, v242, v243
    v_pk_mul_f32 v[244:245], v[244:245], v[84:85]
    v_pk_mul_f32 v[246:247], v[246:247], v[86:87]
    v_cvt_pk_bf16_f32 v62, v244, v245
    v_cvt_pk_bf16_f32 v63, v246, v247
    s_add_u32 s41, s40, 1792
    buffer_store_dwordx4 v[60:63], v7, s[20:23], s41 offen sc1
    v_pk_mul_f32 v[136:137], v[136:137], v[88:89]
    v_pk_mul_f32 v[138:139], v[138:139], v[90:91]
    v_cvt_pk_bf16_f32 v32, v136, v137
    v_cvt_pk_bf16_f32 v33, v138, v139
    v_pk_mul_f32 v[140:141], v[140:141], v[92:93]
    v_pk_mul_f32 v[142:143], v[142:143], v[94:95]
    v_cvt_pk_bf16_f32 v34, v140, v141
    v_cvt_pk_bf16_f32 v35, v142, v143
    s_add_u32 s41, s40, 40960
    buffer_store_dwordx4 v[32:35], v7, s[20:23], s41 offen sc1
    v_pk_mul_f32 v[152:153], v[152:153], v[88:89]
    v_pk_mul_f32 v[154:155], v[154:155], v[90:91]
    v_cvt_pk_bf16_f32 v36, v152, v153
    v_cvt_pk_bf16_f32 v37, v154, v155
    v_pk_mul_f32 v[156:157], v[156:157], v[92:93]
    v_pk_mul_f32 v[158:159], v[158:159], v[94:95]
    v_cvt_pk_bf16_f32 v38, v156, v157
    v_cvt_pk_bf16_f32 v39, v158, v159
    s_add_u32 s41, s40, 41216
    buffer_store_dwordx4 v[36:39], v7, s[20:23], s41 offen sc1
    v_pk_mul_f32 v[168:169], v[168:169], v[88:89]
    v_pk_mul_f32 v[170:171], v[170:171], v[90:91]
    v_cvt_pk_bf16_f32 v40, v168, v169
    v_cvt_pk_bf16_f32 v41, v170, v171
    v_pk_mul_f32 v[172:173], v[172:173], v[92:93]
    v_pk_mul_f32 v[174:175], v[174:175], v[94:95]
    v_cvt_pk_bf16_f32 v42, v172, v173
    v_cvt_pk_bf16_f32 v43, v174, v175
    s_add_u32 s41, s40, 41472
    buffer_store_dwordx4 v[40:43], v7, s[20:23], s41 offen sc1
    v_pk_mul_f32 v[184:185], v[184:185], v[88:89]
    v_pk_mul_f32 v[186:187], v[186:187], v[90:91]
    v_cvt_pk_bf16_f32 v44, v184, v185
    v_cvt_pk_bf16_f32 v45, v186, v187
    v_pk_mul_f32 v[188:189], v[188:189], v[92:93]
    v_pk_mul_f32 v[190:191], v[190:191], v[94:95]
    v_cvt_pk_bf16_f32 v46, v188, v189
    v_cvt_pk_bf16_f32 v47, v190, v191
    s_add_u32 s41, s40, 41728
    buffer_store_dwordx4 v[44:47], v7, s[20:23], s41 offen sc1
    v_pk_mul_f32 v[200:201], v[200:201], v[88:89]
    v_pk_mul_f32 v[202:203], v[202:203], v[90:91]
    v_cvt_pk_bf16_f32 v48, v200, v201
    v_cvt_pk_bf16_f32 v49, v202, v203
    v_pk_mul_f32 v[204:205], v[204:205], v[92:93]
    v_pk_mul_f32 v[206:207], v[206:207], v[94:95]
    v_cvt_pk_bf16_f32 v50, v204, v205
    v_cvt_pk_bf16_f32 v51, v206, v207
    s_add_u32 s41, s40, 41984
    buffer_store_dwordx4 v[48:51], v7, s[20:23], s41 offen sc1
    v_pk_mul_f32 v[216:217], v[216:217], v[88:89]
    v_pk_mul_f32 v[218:219], v[218:219], v[90:91]
    v_cvt_pk_bf16_f32 v52, v216, v217
    v_cvt_pk_bf16_f32 v53, v218, v219
    v_pk_mul_f32 v[220:221], v[220:221], v[92:93]
    v_pk_mul_f32 v[222:223], v[222:223], v[94:95]
    v_cvt_pk_bf16_f32 v54, v220, v221
    v_cvt_pk_bf16_f32 v55, v222, v223
    s_add_u32 s41, s40, 42240
    buffer_store_dwordx4 v[52:55], v7, s[20:23], s41 offen sc1
    v_pk_mul_f32 v[232:233], v[232:233], v[88:89]
    v_pk_mul_f32 v[234:235], v[234:235], v[90:91]
    v_cvt_pk_bf16_f32 v56, v232, v233
    v_cvt_pk_bf16_f32 v57, v234, v235
    v_pk_mul_f32 v[236:237], v[236:237], v[92:93]
    v_pk_mul_f32 v[238:239], v[238:239], v[94:95]
    v_cvt_pk_bf16_f32 v58, v236, v237
    v_cvt_pk_bf16_f32 v59, v238, v239
    s_add_u32 s41, s40, 42496
    buffer_store_dwordx4 v[56:59], v7, s[20:23], s41 offen sc1
    v_pk_mul_f32 v[248:249], v[248:249], v[88:89]
    v_pk_mul_f32 v[250:251], v[250:251], v[90:91]
    v_cvt_pk_bf16_f32 v60, v248, v249
    v_cvt_pk_bf16_f32 v61, v250, v251
    v_pk_mul_f32 v[252:253], v[252:253], v[92:93]
    v_pk_mul_f32 v[254:255], v[254:255], v[94:95]
    v_cvt_pk_bf16_f32 v62, v252, v253
    v_cvt_pk_bf16_f32 v63, v254, v255
    s_add_u32 s41, s40, 42752
    buffer_store_dwordx4 v[60:63], v7, s[20:23], s41 offen sc1
    s_endpgm
L_k1_exit:
    s_endpgm

k1_kernel_end:
.globl k2c_kernel
.p2align 8
.type k2c_kernel,@function
k2c_kernel:
    s_cmp_ge_u32 s2, 256
    s_cbranch_scc1 L_k2_exit
    s_cmp_ge_u32 s2, 80
    s_cbranch_scc1 L_k2_gemm
    s_mov_b32 s60, s2
    s_load_dwordx2 s[6:7], s[0:1], 72
    v_lshrrev_b32 v4, 6, v0
    v_and_b32 v1, 63, v0
    v_readfirstlane_b32 s28, v4
    v_lshrrev_b32 v2, 3, v1
    v_and_b32 v3, 7, v1
    s_mov_b32 s29, s60
    s_mov_b32 s30, s29
    s_lshl_b32 s40, s28, 6
    v_add_u32 v4, s40, v2
    v_mul_u32_u24 v4, 10240, v4
    s_lshl_b32 s40, s30, 7
    s_add_u32 s40, s40, 10485760
    v_add_u32 v4, s40, v4
    v_lshrrev_b32 v5, 1, v2
    v_xor_b32 v5, v5, v3
    v_xor_b32 v6, 4, v5
    v_lshlrev_b32 v5, 4, v5
    v_lshlrev_b32 v6, 4, v6
    v_add_u32 v5, v5, v4
    v_add_u32 v6, v6, v4
    s_lshl_b32 s40, s28, 13
    s_add_u32 s40, s40, 0
    s_waitcnt lgkmcnt(0)
    s_mov_b32 s8, s6
    s_mov_b32 s9, s7
    s_mov_b32 s10, 25165824
    s_mov_b32 s11, 0x00020000
    s_add_u32 m0, s40, 0
    s_mov_b32 s41, 0
    buffer_load_dwordx4 v5, s[8:11], s41 offen offset:0 lds
    s_mov_b32 s41, 80896
    buffer_load_dwordx4 v6, s[8:11], s41 offen offset:1024 lds
    s_mov_b32 s41, 161792
    buffer_load_dwordx4 v5, s[8:11], s41 offen offset:2048 lds
    s_mov_b32 s41, 242688
    buffer_load_dwordx4 v6, s[8:11], s41 offen offset:3072 lds
    s_add_u32 m0, s40, 4096
    s_mov_b32 s41, 327680
    buffer_load_dwordx4 v5, s[8:11], s41 offen offset:0 lds
    s_mov_b32 s41, 408576
    buffer_load_dwordx4 v6, s[8:11], s41 offen offset:1024 lds
    s_mov_b32 s41, 489472
    buffer_load_dwordx4 v5, s[8:11], s41 offen offset:2048 lds
    s_mov_b32 s41, 570368
    buffer_load_dwordx4 v6, s[8:11], s41 offen offset:3072 lds
    s_getpc_b64 s[4:5]
    s_add_u32 s4, s4, fft_table@rel32@lo+4
    s_addc_u32 s5, s5, fft_table@rel32@hi+12
    s_mov_b32 s12, s4
    s_mov_b32 s13, s5
    s_mov_b32 s14, 23040
    s_mov_b32 s15, 0x00020000
    s_lshl_b32 s32, s28, 1
    s_add_u32 s33, s32, 1
    s_lshl_b32 s31, s30, 2
    s_add_u32 s31, s31, s28
    s_cmp_eq_u32 s31, 0
    s_cselect_b32 s34, 0, -1
    s_cselect_b32 s32, 1, s32
    s_cselect_b32 s31, 320, s31
    v_lshlrev_b32 v4, 4, v1
    v_lshlrev_b32 v5, 3, v1
    s_mul_i32 s41, s28, 6144
    s_add_u32 m0, s41, 33792
    s_nop 0
    buffer_load_dwordx4 v4, s[12:15], s41 offen offset:0 lds
    buffer_load_dwordx4 v4, s[12:15], s41 offen offset:1024 lds
    buffer_load_dwordx4 v4, s[12:15], s41 offen offset:2048 lds
    buffer_load_dwordx4 v4, s[12:15], s41 offen offset:3072 lds
    s_add_u32 s41, s41, 4096
    s_add_u32 m0, s41, 33792
    s_nop 0
    buffer_load_dwordx4 v4, s[12:15], s41 offen offset:0 lds
    buffer_load_dwordx4 v4, s[12:15], s41 offen offset:1024 lds
    s_mov_b32 s41, 22528
    buffer_load_dwordx2 v[248:249], v5, s[12:15], s41 offen
    s_lshl_b32 s42, s31, 13
    s_add_u32 s42, s42, 13631488
    buffer_load_dwordx4 v[16:19], v4, s[8:11], s42 offen
    s_add_u32 s42, s42, 1024
    buffer_load_dwordx4 v[20:23], v4, s[8:11], s42 offen
    s_add_u32 s42, s42, 1024
    buffer_load_dwordx4 v[24:27], v4, s[8:11], s42 offen
    s_add_u32 s42, s42, 1024
    buffer_load_dwordx4 v[28:31], v4, s[8:11], s42 offen
    s_add_u32 s42, s42, 1024
    buffer_load_dwordx4 v[32:35], v4, s[8:11], s42 offen
    s_add_u32 s42, s42, 1024
    buffer_load_dwordx4 v[36:39], v4, s[8:11], s42 offen
    s_add_u32 s42, s42, 1024
    buffer_load_dwordx4 v[40:43], v4, s[8:11], s42 offen
    s_add_u32 s42, s42, 1024
    buffer_load_dwordx4 v[44:47], v4, s[8:11], s42 offen
    s_add_u32 s42, s42, 1024
    s_getpc_b64 s[44:45]
    s_add_u32 s44, s44, gf_table@rel32@lo+4
    s_addc_u32 s45, s45, gf_table@rel32@hi+12
    s_mov_b32 s48, s44
    s_mov_b32 s49, s45
    s_mov_b32 s50, 819200
    s_mov_b32 s51, 0x00020000
    s_and_b32 s44, s2, 1
    s_mul_i32 s44, s44, 409600
    s_lshr_b32 s45, s60, 3
    s_lshl_b32 s45, s45, 2
    s_add_u32 s45, s45, s28
    s_mul_i32 s45, s45, 10240
    s_add_u32 s44, s44, s45
    v_lshlrev_b32 v11, 4, v1
    v_mov_b32 v54, v11
    buffer_load_dwordx4 v[10:13], v54, s[48:51], s44 offen
    s_add_u32 s44, s44, 1024
    buffer_load_dwordx4 v[10:13], v54, s[48:51], s44 offen
    s_add_u32 s44, s44, 1024
    buffer_load_dwordx4 v[10:13], v54, s[48:51], s44 offen
    s_add_u32 s44, s44, 1024
    buffer_load_dwordx4 v[10:13], v54, s[48:51], s44 offen
    s_add_u32 s44, s44, 1024
    buffer_load_dwordx4 v[10:13], v54, s[48:51], s44 offen
    s_add_u32 s44, s44, 1024
    buffer_load_dwordx4 v[10:13], v54, s[48:51], s44 offen
    s_add_u32 s44, s44, 1024
    buffer_load_dwordx4 v[10:13], v54, s[48:51], s44 offen
    s_add_u32 s44, s44, 1024
    buffer_load_dwordx4 v[10:13], v54, s[48:51], s44 offen
    s_add_u32 s44, s44, 1024
    buffer_load_dwordx4 v[10:13], v54, s[48:51], s44 offen
    s_add_u32 s44, s44, 1024
    buffer_load_dwordx4 v[10:13], v54, s[48:51], s44 offen
    s_add_u32 s44, s44, 1024
    v_lshrrev_b32 v5, 1, v1
    v_and_b32 v5, 7, v5
    v_lshlrev_b32 v6, 7, v1
    v_add_u32 v6, 0, v6
    v_xor_b32 v7, s32, v5
    v_lshlrev_b32 v7, 4, v7
    v_add_u32 v8, v6, v7
    v_xor_b32 v7, s33, v5
    v_lshlrev_b32 v7, 4, v7
    v_add_u32 v9, v6, v7
    v_lshlrev_b32 v4, 4, v1
    v_add_u32 v4, 33792, v4
    s_waitcnt vmcnt(19)
    s_waitcnt lgkmcnt(0)
    s_barrier
    ds_read_b128 v[128:131], v8 offset:0
    ds_read_b128 v[132:135], v8 offset:8192
    ds_read_b128 v[136:139], v9 offset:0
    ds_read_b128 v[140:143], v9 offset:8192
    ds_read_b128 v[144:147], v8 offset:16384
    ds_read_b128 v[148:151], v8 offset:24576
    ds_read_b128 v[152:155], v9 offset:16384
    ds_read_b128 v[156:159], v9 offset:24576
    ds_read_b128 v[160:163], v4 offset:0
    ds_read_b128 v[164:167], v4 offset:1024
    ds_read_b128 v[168:171], v4 offset:2048
    ds_read_b128 v[172:175], v4 offset:3072
    ds_read_b128 v[176:179], v4 offset:4096
    ds_read_b128 v[180:183], v4 offset:5120
    s_waitcnt lgkmcnt(0)
    ds_read_b128 v[184:187], v4 offset:6144
    ds_read_b128 v[188:191], v4 offset:7168
    ds_read_b128 v[192:195], v4 offset:8192
    ds_read_b128 v[196:199], v4 offset:9216
    ds_read_b128 v[200:203], v4 offset:10240
    ds_read_b128 v[204:207], v4 offset:11264
    ds_read_b128 v[208:211], v4 offset:12288
    ds_read_b128 v[212:215], v4 offset:13312
    ds_read_b128 v[216:219], v4 offset:14336
    ds_read_b128 v[220:223], v4 offset:15360
    ds_read_b128 v[224:227], v4 offset:16384
    ds_read_b128 v[228:231], v4 offset:17408
    ds_read_b128 v[232:235], v4 offset:18432
    ds_read_b128 v[236:239], v4 offset:19456
    ds_read_b128 v[240:243], v4 offset:20480
    ds_read_b128 v[244:247], v4 offset:21504
    v_and_b32 v136, s34, v136
    v_and_b32 v137, s34, v137
    v_and_b32 v138, s34, v138
    v_and_b32 v139, s34, v139
    v_and_b32 v140, s34, v140
    v_and_b32 v141, s34, v141
    v_and_b32 v142, s34, v142
    v_and_b32 v143, s34, v143
    v_and_b32 v152, s34, v152
    v_and_b32 v153, s34, v153
    v_and_b32 v154, s34, v154
    v_and_b32 v155, s34, v155
    v_and_b32 v156, s34, v156
    v_and_b32 v157, s34, v157
    v_and_b32 v158, s34, v158
    v_and_b32 v159, s34, v159
    v_mfma_f32_32x32x16_bf16 v[64:79], v[128:131], v[160:163], 0
    v_mfma_f32_32x32x16_bf16 v[64:79], v[132:135], v[164:167], v[64:79]
    v_mfma_f32_32x32x16_bf16 v[64:79], v[136:139], v[176:179], v[64:79]
    v_mfma_f32_32x32x16_bf16 v[64:79], v[140:143], v[180:183], v[64:79]
    v_mfma_f32_32x32x16_bf16 v[80:95], v[128:131], v[168:171], 0
    v_mfma_f32_32x32x16_bf16 v[80:95], v[132:135], v[172:175], v[80:95]
    v_mfma_f32_32x32x16_bf16 v[80:95], v[136:139], v[160:163], v[80:95]
    v_mfma_f32_32x32x16_bf16 v[80:95], v[140:143], v[164:167], v[80:95]
    v_mfma_f32_32x32x16_bf16 v[96:111], v[144:147], v[160:163], 0
    v_mfma_f32_32x32x16_bf16 v[96:111], v[148:151], v[164:167], v[96:111]
    v_mfma_f32_32x32x16_bf16 v[96:111], v[152:155], v[176:179], v[96:111]
    v_mfma_f32_32x32x16_bf16 v[96:111], v[156:159], v[180:183], v[96:111]
    v_mfma_f32_32x32x16_bf16 v[112:127], v[144:147], v[168:171], 0
    v_mfma_f32_32x32x16_bf16 v[112:127], v[148:151], v[172:175], v[112:127]
    v_mfma_f32_32x32x16_bf16 v[112:127], v[152:155], v[160:163], v[112:127]
    v_mfma_f32_32x32x16_bf16 v[112:127], v[156:159], v[164:167], v[112:127]
    s_waitcnt vmcnt(18) lgkmcnt(0)
    s_waitcnt lgkmcnt(0)
    s_barrier
    s_nop 8
    v_pk_mul_f32 v[48:49], v[112:113], v[248:249] op_sel:[0,1] op_sel_hi:[1,1]
    v_pk_mul_f32 v[50:51], v[96:97], v[248:249] op_sel:[0,1] op_sel_hi:[1,1]
    v_pk_fma_f32 v[52:53], v[96:97], v[248:249], v[48:49] op_sel_hi:[1,0,1] neg_lo:[0,0,1] neg_hi:[0,0,1]
    v_pk_fma_f32 v[54:55], v[112:113], v[248:249], v[50:51] op_sel_hi:[1,0,1]
    v_pk_add_f32 v[96:97], v[64:65], v[52:53] neg_lo:[0,1] neg_hi:[0,1]
    v_pk_add_f32 v[112:113], v[80:81], v[54:55] neg_lo:[0,1] neg_hi:[0,1]
    v_pk_add_f32 v[64:65], v[64:65], v[52:53]
    v_pk_add_f32 v[80:81], v[80:81], v[54:55]
    v_pk_mul_f32 v[48:49], v[80:81], v[200:201]
    v_pk_mul_f32 v[50:51], v[64:65], v[200:201]
    v_pk_fma_f32 v[64:65], v[64:65], v[184:185], v[48:49] neg_lo:[0,0,1] neg_hi:[0,0,1]
    v_pk_fma_f32 v[80:81], v[80:81], v[184:185], v[50:51]
    v_cvt_pk_bf16_f32 v128, v64, v65
    v_cvt_pk_bf16_f32 v136, v80, v81
    v_pk_mul_f32 v[48:49], v[112:113], v[232:233]
    v_pk_mul_f32 v[50:51], v[96:97], v[232:233]
    v_pk_fma_f32 v[96:97], v[96:97], v[216:217], v[48:49] neg_lo:[0,0,1] neg_hi:[0,0,1]
    v_pk_fma_f32 v[112:113], v[112:113], v[216:217], v[50:51]
    v_cvt_pk_bf16_f32 v144, v96, v97
    v_cvt_pk_bf16_f32 v152, v112, v113
    v_pk_mul_f32 v[56:57], v[114:115], v[248:249] op_sel:[0,1] op_sel_hi:[1,1]
    v_pk_mul_f32 v[58:59], v[98:99], v[248:249] op_sel:[0,1] op_sel_hi:[1,1]
    v_pk_fma_f32 v[60:61], v[98:99], v[248:249], v[56:57] op_sel_hi:[1,0,1] neg_lo:[0,0,1] neg_hi:[0,0,1]
    v_pk_fma_f32 v[62:63], v[114:115], v[248:249], v[58:59] op_sel_hi:[1,0,1]
    v_pk_add_f32 v[98:99], v[66:67], v[60:61] neg_lo:[0,1] neg_hi:[0,1]
    v_pk_add_f32 v[114:115], v[82:83], v[62:63] neg_lo:[0,1] neg_hi:[0,1]
    v_pk_add_f32 v[66:67], v[66:67], v[60:61]
    v_pk_add_f32 v[82:83], v[82:83], v[62:63]
    v_pk_mul_f32 v[56:57], v[82:83], v[202:203]
    v_pk_mul_f32 v[58:59], v[66:67], v[202:203]
    v_pk_fma_f32 v[66:67], v[66:67], v[186:187], v[56:57] neg_lo:[0,0,1] neg_hi:[0,0,1]
    v_pk_fma_f32 v[82:83], v[82:83], v[186:187], v[58:59]
    v_cvt_pk_bf16_f32 v129, v66, v67
    v_cvt_pk_bf16_f32 v137, v82, v83
    v_pk_mul_f32 v[56:57], v[114:115], v[234:235]
    v_pk_mul_f32 v[58:59], v[98:99], v[234:235]
    v_pk_fma_f32 v[98:99], v[98:99], v[218:219], v[56:57] neg_lo:[0,0,1] neg_hi:[0,0,1]
    v_pk_fma_f32 v[114:115], v[114:115], v[218:219], v[58:59]
    v_cvt_pk_bf16_f32 v145, v98, v99
    v_cvt_pk_bf16_f32 v153, v114, v115
    v_pk_mul_f32 v[48:49], v[116:117], v[248:249] op_sel:[0,1] op_sel_hi:[1,1]
    v_pk_mul_f32 v[50:51], v[100:101], v[248:249] op_sel:[0,1] op_sel_hi:[1,1]
    v_pk_fma_f32 v[52:53], v[100:101], v[248:249], v[48:49] op_sel_hi:[1,0,1] neg_lo:[0,0,1] neg_hi:[0,0,1]
    v_pk_fma_f32 v[54:55], v[116:117], v[248:249], v[50:51] op_sel_hi:[1,0,1]
    v_pk_add_f32 v[100:101], v[68:69], v[52:53] neg_lo:[0,1] neg_hi:[0,1]
    v_pk_add_f32 v[116:117], v[84:85], v[54:55] neg_lo:[0,1] neg_hi:[0,1]
    v_pk_add_f32 v[68:69], v[68:69], v[52:53]
    v_pk_add_f32 v[84:85], v[84:85], v[54:55]
    v_pk_mul_f32 v[48:49], v[84:85], v[204:205]
    v_pk_mul_f32 v[50:51], v[68:69], v[204:205]
    v_pk_fma_f32 v[68:69], v[68:69], v[188:189], v[48:49] neg_lo:[0,0,1] neg_hi:[0,0,1]
    v_pk_fma_f32 v[84:85], v[84:85], v[188:189], v[50:51]
    v_cvt_pk_bf16_f32 v130, v68, v69
    v_cvt_pk_bf16_f32 v138, v84, v85
    v_pk_mul_f32 v[48:49], v[116:117], v[236:237]
    v_pk_mul_f32 v[50:51], v[100:101], v[236:237]
    v_pk_fma_f32 v[100:101], v[100:101], v[220:221], v[48:49] neg_lo:[0,0,1] neg_hi:[0,0,1]
    v_pk_fma_f32 v[116:117], v[116:117], v[220:221], v[50:51]
    v_cvt_pk_bf16_f32 v146, v100, v101
    v_cvt_pk_bf16_f32 v154, v116, v117
    v_pk_mul_f32 v[56:57], v[118:119], v[248:249] op_sel:[0,1] op_sel_hi:[1,1]
    v_pk_mul_f32 v[58:59], v[102:103], v[248:249] op_sel:[0,1] op_sel_hi:[1,1]
    v_pk_fma_f32 v[60:61], v[102:103], v[248:249], v[56:57] op_sel_hi:[1,0,1] neg_lo:[0,0,1] neg_hi:[0,0,1]
    v_pk_fma_f32 v[62:63], v[118:119], v[248:249], v[58:59] op_sel_hi:[1,0,1]
    v_pk_add_f32 v[102:103], v[70:71], v[60:61] neg_lo:[0,1] neg_hi:[0,1]
    v_pk_add_f32 v[118:119], v[86:87], v[62:63] neg_lo:[0,1] neg_hi:[0,1]
    v_pk_add_f32 v[70:71], v[70:71], v[60:61]
    v_pk_add_f32 v[86:87], v[86:87], v[62:63]
    v_pk_mul_f32 v[56:57], v[86:87], v[206:207]
    v_pk_mul_f32 v[58:59], v[70:71], v[206:207]
    v_pk_fma_f32 v[70:71], v[70:71], v[190:191], v[56:57] neg_lo:[0,0,1] neg_hi:[0,0,1]
    v_pk_fma_f32 v[86:87], v[86:87], v[190:191], v[58:59]
    v_cvt_pk_bf16_f32 v131, v70, v71
    v_cvt_pk_bf16_f32 v139, v86, v87
    v_pk_mul_f32 v[56:57], v[118:119], v[238:239]
    v_pk_mul_f32 v[58:59], v[102:103], v[238:239]
    v_pk_fma_f32 v[102:103], v[102:103], v[222:223], v[56:57] neg_lo:[0,0,1] neg_hi:[0,0,1]
    v_pk_fma_f32 v[118:119], v[118:119], v[222:223], v[58:59]
    v_cvt_pk_bf16_f32 v147, v102, v103
    v_cvt_pk_bf16_f32 v155, v118, v119
    v_pk_mul_f32 v[48:49], v[120:121], v[248:249] op_sel:[0,1] op_sel_hi:[1,1]
    v_pk_mul_f32 v[50:51], v[104:105], v[248:249] op_sel:[0,1] op_sel_hi:[1,1]
    v_pk_fma_f32 v[52:53], v[104:105], v[248:249], v[48:49] op_sel_hi:[1,0,1] neg_lo:[0,0,1] neg_hi:[0,0,1]
    v_pk_fma_f32 v[54:55], v[120:121], v[248:249], v[50:51] op_sel_hi:[1,0,1]
    v_pk_add_f32 v[104:105], v[72:73], v[52:53] neg_lo:[0,1] neg_hi:[0,1]
    v_pk_add_f32 v[120:121], v[88:89], v[54:55] neg_lo:[0,1] neg_hi:[0,1]
    v_pk_add_f32 v[72:73], v[72:73], v[52:53]
    v_pk_add_f32 v[88:89], v[88:89], v[54:55]
    v_pk_mul_f32 v[48:49], v[88:89], v[208:209]
    v_pk_mul_f32 v[50:51], v[72:73], v[208:209]
    v_pk_fma_f32 v[72:73], v[72:73], v[192:193], v[48:49] neg_lo:[0,0,1] neg_hi:[0,0,1]
    v_pk_fma_f32 v[88:89], v[88:89], v[192:193], v[50:51]
    v_cvt_pk_bf16_f32 v132, v72, v73
    v_cvt_pk_bf16_f32 v140, v88, v89
    v_pk_mul_f32 v[48:49], v[120:121], v[240:241]
    v_pk_mul_f32 v[50:51], v[104:105], v[240:241]
    v_pk_fma_f32 v[104:105], v[104:105], v[224:225], v[48:49] neg_lo:[0,0,1] neg_hi:[0,0,1]
    v_pk_fma_f32 v[120:121], v[120:121], v[224:225], v[50:51]
    v_cvt_pk_bf16_f32 v148, v104, v105
    v_cvt_pk_bf16_f32 v156, v120, v121
    v_pk_mul_f32 v[56:57], v[122:123], v[248:249] op_sel:[0,1] op_sel_hi:[1,1]
    v_pk_mul_f32 v[58:59], v[106:107], v[248:249] op_sel:[0,1] op_sel_hi:[1,1]
    v_pk_fma_f32 v[60:61], v[106:107], v[248:249], v[56:57] op_sel_hi:[1,0,1] neg_lo:[0,0,1] neg_hi:[0,0,1]
    v_pk_fma_f32 v[62:63], v[122:123], v[248:249], v[58:59] op_sel_hi:[1,0,1]
    v_pk_add_f32 v[106:107], v[74:75], v[60:61] neg_lo:[0,1] neg_hi:[0,1]
    v_pk_add_f32 v[122:123], v[90:91], v[62:63] neg_lo:[0,1] neg_hi:[0,1]
    v_pk_add_f32 v[74:75], v[74:75], v[60:61]
    v_pk_add_f32 v[90:91], v[90:91], v[62:63]
    v_pk_mul_f32 v[56:57], v[90:91], v[210:211]
    v_pk_mul_f32 v[58:59], v[74:75], v[210:211]
    v_pk_fma_f32 v[74:75], v[74:75], v[194:195], v[56:57] neg_lo:[0,0,1] neg_hi:[0,0,1]
    v_pk_fma_f32 v[90:91], v[90:91], v[194:195], v[58:59]
    v_cvt_pk_bf16_f32 v133, v74, v75
    v_cvt_pk_bf16_f32 v141, v90, v91
    v_pk_mul_f32 v[56:57], v[122:123], v[242:243]
    v_pk_mul_f32 v[58:59], v[106:107], v[242:243]
    v_pk_fma_f32 v[106:107], v[106:107], v[226:227], v[56:57] neg_lo:[0,0,1] neg_hi:[0,0,1]
    v_pk_fma_f32 v[122:123], v[122:123], v[226:227], v[58:59]
    v_cvt_pk_bf16_f32 v149, v106, v107
    v_cvt_pk_bf16_f32 v157, v122, v123
    v_pk_mul_f32 v[48:49], v[124:125], v[248:249] op_sel:[0,1] op_sel_hi:[1,1]
    v_pk_mul_f32 v[50:51], v[108:109], v[248:249] op_sel:[0,1] op_sel_hi:[1,1]
    v_pk_fma_f32 v[52:53], v[108:109], v[248:249], v[48:49] op_sel_hi:[1,0,1] neg_lo:[0,0,1] neg_hi:[0,0,1]
    v_pk_fma_f32 v[54:55], v[124:125], v[248:249], v[50:51] op_sel_hi:[1,0,1]
    v_pk_add_f32 v[108:109], v[76:77], v[52:53] neg_lo:[0,1] neg_hi:[0,1]
    v_pk_add_f32 v[124:125], v[92:93], v[54:55] neg_lo:[0,1] neg_hi:[0,1]
    v_pk_add_f32 v[76:77], v[76:77], v[52:53]
    v_pk_add_f32 v[92:93], v[92:93], v[54:55]
    v_pk_mul_f32 v[48:49], v[92:93], v[212:213]
    v_pk_mul_f32 v[50:51], v[76:77], v[212:213]
    v_pk_fma_f32 v[76:77], v[76:77], v[196:197], v[48:49] neg_lo:[0,0,1] neg_hi:[0,0,1]
    v_pk_fma_f32 v[92:93], v[92:93], v[196:197], v[50:51]
    v_cvt_pk_bf16_f32 v134, v76, v77
    v_cvt_pk_bf16_f32 v142, v92, v93
    v_pk_mul_f32 v[48:49], v[124:125], v[244:245]
    v_pk_mul_f32 v[50:51], v[108:109], v[244:245]
    v_pk_fma_f32 v[108:109], v[108:109], v[228:229], v[48:49] neg_lo:[0,0,1] neg_hi:[0,0,1]
    v_pk_fma_f32 v[124:125], v[124:125], v[228:229], v[50:51]
    v_cvt_pk_bf16_f32 v150, v108, v109
    v_cvt_pk_bf16_f32 v158, v124, v125
    v_pk_mul_f32 v[56:57], v[126:127], v[248:249] op_sel:[0,1] op_sel_hi:[1,1]
    v_pk_mul_f32 v[58:59], v[110:111], v[248:249] op_sel:[0,1] op_sel_hi:[1,1]
    v_pk_fma_f32 v[60:61], v[110:111], v[248:249], v[56:57] op_sel_hi:[1,0,1] neg_lo:[0,0,1] neg_hi:[0,0,1]
    v_pk_fma_f32 v[62:63], v[126:127], v[248:249], v[58:59] op_sel_hi:[1,0,1]
    v_pk_add_f32 v[110:111], v[78:79], v[60:61] neg_lo:[0,1] neg_hi:[0,1]
    v_pk_add_f32 v[126:127], v[94:95], v[62:63] neg_lo:[0,1] neg_hi:[0,1]
    v_pk_add_f32 v[78:79], v[78:79], v[60:61]
    v_pk_add_f32 v[94:95], v[94:95], v[62:63]
    v_pk_mul_f32 v[56:57], v[94:95], v[214:215]
    v_pk_mul_f32 v[58:59], v[78:79], v[214:215]
    v_pk_fma_f32 v[78:79], v[78:79], v[198:199], v[56:57] neg_lo:[0,0,1] neg_hi:[0,0,1]
    v_pk_fma_f32 v[94:95], v[94:95], v[198:199], v[58:59]
    v_cvt_pk_bf16_f32 v135, v78, v79
    v_cvt_pk_bf16_f32 v143, v94, v95
    v_pk_mul_f32 v[56:57], v[126:127], v[246:247]
    v_pk_mul_f32 v[58:59], v[110:111], v[246:247]
    v_pk_fma_f32 v[110:111], v[110:111], v[230:231], v[56:57] neg_lo:[0,0,1] neg_hi:[0,0,1]
    v_pk_fma_f32 v[126:127], v[126:127], v[230:231], v[58:59]
    v_cvt_pk_bf16_f32 v151, v110, v111
    v_cvt_pk_bf16_f32 v159, v126, v127
    v_mfma_f32_32x32x16_bf16 v[64:79], v[160:163], v[128:131], 0
    v_mfma_f32_32x32x16_bf16 v[64:79], v[164:167], v[132:135], v[64:79]
    v_mfma_f32_32x32x16_bf16 v[64:79], v[176:179], v[136:139], v[64:79]
    v_mfma_f32_32x32x16_bf16 v[64:79], v[180:183], v[140:143], v[64:79]
    v_mfma_f32_32x32x16_bf16 v[80:95], v[168:171], v[128:131], 0
    v_mfma_f32_32x32x16_bf16 v[80:95], v[172:175], v[132:135], v[80:95]
    v_mfma_f32_32x32x16_bf16 v[80:95], v[160:163], v[136:139], v[80:95]
    v_mfma_f32_32x32x16_bf16 v[80:95], v[164:167], v[140:143], v[80:95]
    v_mfma_f32_32x32x16_bf16 v[96:111], v[160:163], v[144:147], 0
    v_mfma_f32_32x32x16_bf16 v[96:111], v[164:167], v[148:151], v[96:111]
    v_mfma_f32_32x32x16_bf16 v[96:111], v[176:179], v[152:155], v[96:111]
    v_mfma_f32_32x32x16_bf16 v[96:111], v[180:183], v[156:159], v[96:111]
    v_mfma_f32_32x32x16_bf16 v[112:127], v[168:171], v[144:147], 0
    v_mfma_f32_32x32x16_bf16 v[112:127], v[172:175], v[148:151], v[112:127]
    v_mfma_f32_32x32x16_bf16 v[112:127], v[160:163], v[152:155], v[112:127]
    v_mfma_f32_32x32x16_bf16 v[112:127], v[164:167], v[156:159], v[112:127]
    s_waitcnt vmcnt(10)
    v_lshlrev_b32 v48, 16, v16
    v_lshlrev_b32 v49, 16, v17
    v_and_b32 v50, 0xffff0000, v16
    v_and_b32 v51, 0xffff0000, v17
    v_pk_mul_f32 v[52:53], v[80:81], v[50:51]
    v_pk_mul_f32 v[54:55], v[64:65], v[50:51]
    v_pk_fma_f32 v[64:65], v[64:65], v[48:49], v[52:53] neg_lo:[0,0,1] neg_hi:[0,0,1]
    v_pk_fma_f32 v[80:81], v[80:81], v[48:49], v[54:55]
    v_cvt_pk_bf16_f32 v128, v64, v65
    v_cvt_pk_bf16_f32 v136, v80, v81
    v_lshlrev_b32 v56, 16, v18
    v_lshlrev_b32 v57, 16, v19
    v_and_b32 v58, 0xffff0000, v18
    v_and_b32 v59, 0xffff0000, v19
    v_pk_mul_f32 v[60:61], v[82:83], v[58:59]
    v_pk_mul_f32 v[62:63], v[66:67], v[58:59]
    v_pk_fma_f32 v[66:67], v[66:67], v[56:57], v[60:61] neg_lo:[0,0,1] neg_hi:[0,0,1]
    v_pk_fma_f32 v[82:83], v[82:83], v[56:57], v[62:63]
    v_cvt_pk_bf16_f32 v129, v66, v67
    v_cvt_pk_bf16_f32 v137, v82, v83
    v_lshlrev_b32 v48, 16, v20
    v_lshlrev_b32 v49, 16, v21
    v_and_b32 v50, 0xffff0000, v20
    v_and_b32 v51, 0xffff0000, v21
    v_pk_mul_f32 v[52:53], v[84:85], v[50:51]
    v_pk_mul_f32 v[54:55], v[68:69], v[50:51]
    v_pk_fma_f32 v[68:69], v[68:69], v[48:49], v[52:53] neg_lo:[0,0,1] neg_hi:[0,0,1]
    v_pk_fma_f32 v[84:85], v[84:85], v[48:49], v[54:55]
    v_cvt_pk_bf16_f32 v130, v68, v69
    v_cvt_pk_bf16_f32 v138, v84, v85
    v_lshlrev_b32 v56, 16, v22
    v_lshlrev_b32 v57, 16, v23
    v_and_b32 v58, 0xffff0000, v22
    v_and_b32 v59, 0xffff0000, v23
    v_pk_mul_f32 v[60:61], v[86:87], v[58:59]
    v_pk_mul_f32 v[62:63], v[70:71], v[58:59]
    v_pk_fma_f32 v[70:71], v[70:71], v[56:57], v[60:61] neg_lo:[0,0,1] neg_hi:[0,0,1]
    v_pk_fma_f32 v[86:87], v[86:87], v[56:57], v[62:63]
    v_cvt_pk_bf16_f32 v131, v70, v71
    v_cvt_pk_bf16_f32 v139, v86, v87
    v_lshlrev_b32 v48, 16, v24
    v_lshlrev_b32 v49, 16, v25
    v_and_b32 v50, 0xffff0000, v24
    v_and_b32 v51, 0xffff0000, v25
    v_pk_mul_f32 v[52:53], v[88:89], v[50:51]
    v_pk_mul_f32 v[54:55], v[72:73], v[50:51]
    v_pk_fma_f32 v[72:73], v[72:73], v[48:49], v[52:53] neg_lo:[0,0,1] neg_hi:[0,0,1]
    v_pk_fma_f32 v[88:89], v[88:89], v[48:49], v[54:55]
    v_cvt_pk_bf16_f32 v132, v72, v73
    v_cvt_pk_bf16_f32 v140, v88, v89
    v_lshlrev_b32 v56, 16, v26
    v_lshlrev_b32 v57, 16, v27
    v_and_b32 v58, 0xffff0000, v26
    v_and_b32 v59, 0xffff0000, v27
    v_pk_mul_f32 v[60:61], v[90:91], v[58:59]
    v_pk_mul_f32 v[62:63], v[74:75], v[58:59]
    v_pk_fma_f32 v[74:75], v[74:75], v[56:57], v[60:61] neg_lo:[0,0,1] neg_hi:[0,0,1]
    v_pk_fma_f32 v[90:91], v[90:91], v[56:57], v[62:63]
    v_cvt_pk_bf16_f32 v133, v74, v75
    v_cvt_pk_bf16_f32 v141, v90, v91
    v_lshlrev_b32 v48, 16, v28
    v_lshlrev_b32 v49, 16, v29
    v_and_b32 v50, 0xffff0000, v28
    v_and_b32 v51, 0xffff0000, v29
    v_pk_mul_f32 v[52:53], v[92:93], v[50:51]
    v_pk_mul_f32 v[54:55], v[76:77], v[50:51]
    v_pk_fma_f32 v[76:77], v[76:77], v[48:49], v[52:53] neg_lo:[0,0,1] neg_hi:[0,0,1]
    v_pk_fma_f32 v[92:93], v[92:93], v[48:49], v[54:55]
    v_cvt_pk_bf16_f32 v134, v76, v77
    v_cvt_pk_bf16_f32 v142, v92, v93
    v_lshlrev_b32 v56, 16, v30
    v_lshlrev_b32 v57, 16, v31
    v_and_b32 v58, 0xffff0000, v30
    v_and_b32 v59, 0xffff0000, v31
    v_pk_mul_f32 v[60:61], v[94:95], v[58:59]
    v_pk_mul_f32 v[62:63], v[78:79], v[58:59]
    v_pk_fma_f32 v[78:79], v[78:79], v[56:57], v[60:61] neg_lo:[0,0,1] neg_hi:[0,0,1]
    v_pk_fma_f32 v[94:95], v[94:95], v[56:57], v[62:63]
    v_cvt_pk_bf16_f32 v135, v78, v79
    v_cvt_pk_bf16_f32 v143, v94, v95
    v_lshlrev_b32 v48, 16, v32
    v_lshlrev_b32 v49, 16, v33
    v_and_b32 v50, 0xffff0000, v32
    v_and_b32 v51, 0xffff0000, v33
    v_pk_mul_f32 v[52:53], v[112:113], v[50:51]
    v_pk_mul_f32 v[54:55], v[96:97], v[50:51]
    v_pk_fma_f32 v[96:97], v[96:97], v[48:49], v[52:53] neg_lo:[0,0,1] neg_hi:[0,0,1]
    v_pk_fma_f32 v[112:113], v[112:113], v[48:49], v[54:55]
    v_cvt_pk_bf16_f32 v144, v96, v97
    v_cvt_pk_bf16_f32 v152, v112, v113
    v_lshlrev_b32 v56, 16, v34
    v_lshlrev_b32 v57, 16, v35
    v_and_b32 v58, 0xffff0000, v34
    v_and_b32 v59, 0xffff0000, v35
    v_pk_mul_f32 v[60:61], v[114:115], v[58:59]
    v_pk_mul_f32 v[62:63], v[98:99], v[58:59]
    v_pk_fma_f32 v[98:99], v[98:99], v[56:57], v[60:61] neg_lo:[0,0,1] neg_hi:[0,0,1]
    v_pk_fma_f32 v[114:115], v[114:115], v[56:57], v[62:63]
    v_cvt_pk_bf16_f32 v145, v98, v99
    v_cvt_pk_bf16_f32 v153, v114, v115
    v_lshlrev_b32 v48, 16, v36
    v_lshlrev_b32 v49, 16, v37
    v_and_b32 v50, 0xffff0000, v36
    v_and_b32 v51, 0xffff0000, v37
    v_pk_mul_f32 v[52:53], v[116:117], v[50:51]
    v_pk_mul_f32 v[54:55], v[100:101], v[50:51]
    v_pk_fma_f32 v[100:101], v[100:101], v[48:49], v[52:53] neg_lo:[0,0,1] neg_hi:[0,0,1]
    v_pk_fma_f32 v[116:117], v[116:117], v[48:49], v[54:55]
    v_cvt_pk_bf16_f32 v146, v100, v101
    v_cvt_pk_bf16_f32 v154, v116, v117
    v_lshlrev_b32 v56, 16, v38
    v_lshlrev_b32 v57, 16, v39
    v_and_b32 v58, 0xffff0000, v38
    v_and_b32 v59, 0xffff0000, v39
    v_pk_mul_f32 v[60:61], v[118:119], v[58:59]
    v_pk_mul_f32 v[62:63], v[102:103], v[58:59]
    v_pk_fma_f32 v[102:103], v[102:103], v[56:57], v[60:61] neg_lo:[0,0,1] neg_hi:[0,0,1]
    v_pk_fma_f32 v[118:119], v[118:119], v[56:57], v[62:63]
    v_cvt_pk_bf16_f32 v147, v102, v103
    v_cvt_pk_bf16_f32 v155, v118, v119
    v_lshlrev_b32 v48, 16, v40
    v_lshlrev_b32 v49, 16, v41
    v_and_b32 v50, 0xffff0000, v40
    v_and_b32 v51, 0xffff0000, v41
    v_pk_mul_f32 v[52:53], v[120:121], v[50:51]
    v_pk_mul_f32 v[54:55], v[104:105], v[50:51]
    v_pk_fma_f32 v[104:105], v[104:105], v[48:49], v[52:53] neg_lo:[0,0,1] neg_hi:[0,0,1]
    v_pk_fma_f32 v[120:121], v[120:121], v[48:49], v[54:55]
    v_cvt_pk_bf16_f32 v148, v104, v105
    v_cvt_pk_bf16_f32 v156, v120, v121
    v_lshlrev_b32 v56, 16, v42
    v_lshlrev_b32 v57, 16, v43
    v_and_b32 v58, 0xffff0000, v42
    v_and_b32 v59, 0xffff0000, v43
    v_pk_mul_f32 v[60:61], v[122:123], v[58:59]
    v_pk_mul_f32 v[62:63], v[106:107], v[58:59]
    v_pk_fma_f32 v[106:107], v[106:107], v[56:57], v[60:61] neg_lo:[0,0,1] neg_hi:[0,0,1]
    v_pk_fma_f32 v[122:123], v[122:123], v[56:57], v[62:63]
    v_cvt_pk_bf16_f32 v149, v106, v107
    v_cvt_pk_bf16_f32 v157, v122, v123
    v_lshlrev_b32 v48, 16, v44
    v_lshlrev_b32 v49, 16, v45
    v_and_b32 v50, 0xffff0000, v44
    v_and_b32 v51, 0xffff0000, v45
    v_pk_mul_f32 v[52:53], v[124:125], v[50:51]
    v_pk_mul_f32 v[54:55], v[108:109], v[50:51]
    v_pk_fma_f32 v[108:109], v[108:109], v[48:49], v[52:53] neg_lo:[0,0,1] neg_hi:[0,0,1]
    v_pk_fma_f32 v[124:125], v[124:125], v[48:49], v[54:55]
    v_cvt_pk_bf16_f32 v150, v108, v109
    v_cvt_pk_bf16_f32 v158, v124, v125
    v_lshlrev_b32 v56, 16, v46
    v_lshlrev_b32 v57, 16, v47
    v_and_b32 v58, 0xffff0000, v46
    v_and_b32 v59, 0xffff0000, v47
    v_pk_mul_f32 v[60:61], v[126:127], v[58:59]
    v_pk_mul_f32 v[62:63], v[110:111], v[58:59]
    v_pk_fma_f32 v[110:111], v[110:111], v[56:57], v[60:61] neg_lo:[0,0,1] neg_hi:[0,0,1]
    v_pk_fma_f32 v[126:127], v[126:127], v[56:57], v[62:63]
    v_cvt_pk_bf16_f32 v151, v110, v111
    v_cvt_pk_bf16_f32 v159, v126, v127
    v_mfma_f32_32x32x16_bf16 v[64:79], v[128:131], v[160:163], 0
    v_mfma_f32_32x32x16_bf16 v[64:79], v[132:135], v[164:167], v[64:79]
    v_mfma_f32_32x32x16_bf16 v[64:79], v[136:139], v[168:171], v[64:79]
    v_mfma_f32_32x32x16_bf16 v[64:79], v[140:143], v[172:175], v[64:79]
    v_mfma_f32_32x32x16_bf16 v[80:95], v[128:131], v[176:179], 0
    v_mfma_f32_32x32x16_bf16 v[80:95], v[132:135], v[180:183], v[80:95]
    v_mfma_f32_32x32x16_bf16 v[80:95], v[136:139], v[160:163], v[80:95]
    v_mfma_f32_32x32x16_bf16 v[80:95], v[140:143], v[164:167], v[80:95]
    v_mfma_f32_32x32x16_bf16 v[96:111], v[144:147], v[160:163], 0
    v_mfma_f32_32x32x16_bf16 v[96:111], v[148:151], v[164:167], v[96:111]
    v_mfma_f32_32x32x16_bf16 v[96:111], v[152:155], v[168:171], v[96:111]
    v_mfma_f32_32x32x16_bf16 v[96:111], v[156:159], v[172:175], v[96:111]
    v_mfma_f32_32x32x16_bf16 v[112:127], v[144:147], v[176:179], 0
    v_mfma_f32_32x32x16_bf16 v[112:127], v[148:151], v[180:183], v[112:127]
    v_mfma_f32_32x32x16_bf16 v[112:127], v[152:155], v[160:163], v[112:127]
    v_mfma_f32_32x32x16_bf16 v[112:127], v[156:159], v[164:167], v[112:127]
    s_nop 11
    v_pk_mul_f32 v[48:49], v[112:113], v[248:249] op_sel:[0,1] op_sel_hi:[1,1]
    v_pk_mul_f32 v[50:51], v[96:97], v[248:249] op_sel:[0,1] op_sel_hi:[1,1]
    v_pk_fma_f32 v[52:53], v[96:97], v[248:249], v[48:49] op_sel_hi:[1,0,1]
    v_pk_fma_f32 v[54:55], v[112:113], v[248:249], v[50:51] op_sel_hi:[1,0,1] neg_lo:[0,0,1] neg_hi:[0,0,1]
    v_pk_add_f32 v[96:97], v[64:65], v[52:53] neg_lo:[0,1] neg_hi:[0,1]
    v_pk_add_f32 v[112:113], v[80:81], v[54:55] neg_lo:[0,1] neg_hi:[0,1]
    v_pk_add_f32 v[64:65], v[64:65], v[52:53]
    v_pk_add_f32 v[80:81], v[80:81], v[54:55]
    v_pk_mul_f32 v[48:49], v[80:81], v[200:201]
    v_pk_mul_f32 v[50:51], v[64:65], v[200:201]
    v_pk_fma_f32 v[64:65], v[64:65], v[184:185], v[48:49]
    v_pk_fma_f32 v[80:81], v[80:81], v[184:185], v[50:51] neg_lo:[0,0,1] neg_hi:[0,0,1]
    v_cvt_pk_bf16_f32 v128, v64, v65
    v_cvt_pk_bf16_f32 v136, v80, v81
    v_pk_mul_f32 v[48:49], v[112:113], v[232:233]
    v_pk_mul_f32 v[50:51], v[96:97], v[232:233]
    v_pk_fma_f32 v[96:97], v[96:97], v[216:217], v[48:49]
    v_pk_fma_f32 v[112:113], v[112:113], v[216:217], v[50:51] neg_lo:[0,0,1] neg_hi:[0,0,1]
    v_cvt_pk_bf16_f32 v144, v96, v97
    v_cvt_pk_bf16_f32 v152, v112, v113
    v_pk_mul_f32 v[56:57], v[114:115], v[248:249] op_sel:[0,1] op_sel_hi:[1,1]
    v_pk_mul_f32 v[58:59], v[98:99], v[248:249] op_sel:[0,1] op_sel_hi:[1,1]
    v_pk_fma_f32 v[60:61], v[98:99], v[248:249], v[56:57] op_sel_hi:[1,0,1]
    v_pk_fma_f32 v[62:63], v[114:115], v[248:249], v[58:59] op_sel_hi:[1,0,1] neg_lo:[0,0,1] neg_hi:[0,0,1]
    v_pk_add_f32 v[98:99], v[66:67], v[60:61] neg_lo:[0,1] neg_hi:[0,1]
    v_pk_add_f32 v[114:115], v[82:83], v[62:63] neg_lo:[0,1] neg_hi:[0,1]
    v_pk_add_f32 v[66:67], v[66:67], v[60:61]
    v_pk_add_f32 v[82:83], v[82:83], v[62:63]
    v_pk_mul_f32 v[56:57], v[82:83], v[202:203]
    v_pk_mul_f32 v[58:59], v[66:67], v[202:203]
    v_pk_fma_f32 v[66:67], v[66:67], v[186:187], v[56:57]
    v_pk_fma_f32 v[82:83], v[82:83], v[186:187], v[58:59] neg_lo:[0,0,1] neg_hi:[0,0,1]
    v_cvt_pk_bf16_f32 v129, v66, v67
    v_cvt_pk_bf16_f32 v137, v82, v83
    v_pk_mul_f32 v[56:57], v[114:115], v[234:235]
    v_pk_mul_f32 v[58:59], v[98:99], v[234:235]
    v_pk_fma_f32 v[98:99], v[98:99], v[218:219], v[56:57]
    v_pk_fma_f32 v[114:115], v[114:115], v[218:219], v[58:59] neg_lo:[0,0,1] neg_hi:[0,0,1]
    v_cvt_pk_bf16_f32 v145, v98, v99
    v_cvt_pk_bf16_f32 v153, v114, v115
    v_pk_mul_f32 v[48:49], v[116:117], v[248:249] op_sel:[0,1] op_sel_hi:[1,1]
    v_pk_mul_f32 v[50:51], v[100:101], v[248:249] op_sel:[0,1] op_sel_hi:[1,1]
    v_pk_fma_f32 v[52:53], v[100:101], v[248:249], v[48:49] op_sel_hi:[1,0,1]
    v_pk_fma_f32 v[54:55], v[116:117], v[248:249], v[50:51] op_sel_hi:[1,0,1] neg_lo:[0,0,1] neg_hi:[0,0,1]
    v_pk_add_f32 v[100:101], v[68:69], v[52:53] neg_lo:[0,1] neg_hi:[0,1]
    v_pk_add_f32 v[116:117], v[84:85], v[54:55] neg_lo:[0,1] neg_hi:[0,1]
    v_pk_add_f32 v[68:69], v[68:69], v[52:53]
    v_pk_add_f32 v[84:85], v[84:85], v[54:55]
    v_pk_mul_f32 v[48:49], v[84:85], v[204:205]
    v_pk_mul_f32 v[50:51], v[68:69], v[204:205]
    v_pk_fma_f32 v[68:69], v[68:69], v[188:189], v[48:49]
    v_pk_fma_f32 v[84:85], v[84:85], v[188:189], v[50:51] neg_lo:[0,0,1] neg_hi:[0,0,1]
    v_cvt_pk_bf16_f32 v130, v68, v69
    v_cvt_pk_bf16_f32 v138, v84, v85
    v_pk_mul_f32 v[48:49], v[116:117], v[236:237]
    v_pk_mul_f32 v[50:51], v[100:101], v[236:237]
    v_pk_fma_f32 v[100:101], v[100:101], v[220:221], v[48:49]
    v_pk_fma_f32 v[116:117], v[116:117], v[220:221], v[50:51] neg_lo:[0,0,1] neg_hi:[0,0,1]
    v_cvt_pk_bf16_f32 v146, v100, v101
    v_cvt_pk_bf16_f32 v154, v116, v117
    v_pk_mul_f32 v[56:57], v[118:119], v[248:249] op_sel:[0,1] op_sel_hi:[1,1]
    v_pk_mul_f32 v[58:59], v[102:103], v[248:249] op_sel:[0,1] op_sel_hi:[1,1]
    v_pk_fma_f32 v[60:61], v[102:103], v[248:249], v[56:57] op_sel_hi:[1,0,1]
    v_pk_fma_f32 v[62:63], v[118:119], v[248:249], v[58:59] op_sel_hi:[1,0,1] neg_lo:[0,0,1] neg_hi:[0,0,1]
    v_pk_add_f32 v[102:103], v[70:71], v[60:61] neg_lo:[0,1] neg_hi:[0,1]
    v_pk_add_f32 v[118:119], v[86:87], v[62:63] neg_lo:[0,1] neg_hi:[0,1]
    v_pk_add_f32 v[70:71], v[70:71], v[60:61]
    v_pk_add_f32 v[86:87], v[86:87], v[62:63]
    v_pk_mul_f32 v[56:57], v[86:87], v[206:207]
    v_pk_mul_f32 v[58:59], v[70:71], v[206:207]
    v_pk_fma_f32 v[70:71], v[70:71], v[190:191], v[56:57]
    v_pk_fma_f32 v[86:87], v[86:87], v[190:191], v[58:59] neg_lo:[0,0,1] neg_hi:[0,0,1]
    v_cvt_pk_bf16_f32 v131, v70, v71
    v_cvt_pk_bf16_f32 v139, v86, v87
    v_pk_mul_f32 v[56:57], v[118:119], v[238:239]
    v_pk_mul_f32 v[58:59], v[102:103], v[238:239]
    v_pk_fma_f32 v[102:103], v[102:103], v[222:223], v[56:57]
    v_pk_fma_f32 v[118:119], v[118:119], v[222:223], v[58:59] neg_lo:[0,0,1] neg_hi:[0,0,1]
    v_cvt_pk_bf16_f32 v147, v102, v103
    v_cvt_pk_bf16_f32 v155, v118, v119
    v_pk_mul_f32 v[48:49], v[120:121], v[248:249] op_sel:[0,1] op_sel_hi:[1,1]
    v_pk_mul_f32 v[50:51], v[104:105], v[248:249] op_sel:[0,1] op_sel_hi:[1,1]
    v_pk_fma_f32 v[52:53], v[104:105], v[248:249], v[48:49] op_sel_hi:[1,0,1]
    v_pk_fma_f32 v[54:55], v[120:121], v[248:249], v[50:51] op_sel_hi:[1,0,1] neg_lo:[0,0,1] neg_hi:[0,0,1]
    v_pk_add_f32 v[104:105], v[72:73], v[52:53] neg_lo:[0,1] neg_hi:[0,1]
    v_pk_add_f32 v[120:121], v[88:89], v[54:55] neg_lo:[0,1] neg_hi:[0,1]
    v_pk_add_f32 v[72:73], v[72:73], v[52:53]
    v_pk_add_f32 v[88:89], v[88:89], v[54:55]
    v_pk_mul_f32 v[48:49], v[88:89], v[208:209]
    v_pk_mul_f32 v[50:51], v[72:73], v[208:209]
    v_pk_fma_f32 v[72:73], v[72:73], v[192:193], v[48:49]
    v_pk_fma_f32 v[88:89], v[88:89], v[192:193], v[50:51] neg_lo:[0,0,1] neg_hi:[0,0,1]
    v_cvt_pk_bf16_f32 v132, v72, v73
    v_cvt_pk_bf16_f32 v140, v88, v89
    v_pk_mul_f32 v[48:49], v[120:121], v[240:241]
    v_pk_mul_f32 v[50:51], v[104:105], v[240:241]
    v_pk_fma_f32 v[104:105], v[104:105], v[224:225], v[48:49]
    v_pk_fma_f32 v[120:121], v[120:121], v[224:225], v[50:51] neg_lo:[0,0,1] neg_hi:[0,0,1]
    v_cvt_pk_bf16_f32 v148, v104, v105
    v_cvt_pk_bf16_f32 v156, v120, v121
    v_pk_mul_f32 v[56:57], v[122:123], v[248:249] op_sel:[0,1] op_sel_hi:[1,1]
    v_pk_mul_f32 v[58:59], v[106:107], v[248:249] op_sel:[0,1] op_sel_hi:[1,1]
    v_pk_fma_f32 v[60:61], v[106:107], v[248:249], v[56:57] op_sel_hi:[1,0,1]
    v_pk_fma_f32 v[62:63], v[122:123], v[248:249], v[58:59] op_sel_hi:[1,0,1] neg_lo:[0,0,1] neg_hi:[0,0,1]
    v_pk_add_f32 v[106:107], v[74:75], v[60:61] neg_lo:[0,1] neg_hi:[0,1]
    v_pk_add_f32 v[122:123], v[90:91], v[62:63] neg_lo:[0,1] neg_hi:[0,1]
    v_pk_add_f32 v[74:75], v[74:75], v[60:61]
    v_pk_add_f32 v[90:91], v[90:91], v[62:63]
    v_pk_mul_f32 v[56:57], v[90:91], v[210:211]
    v_pk_mul_f32 v[58:59], v[74:75], v[210:211]
    v_pk_fma_f32 v[74:75], v[74:75], v[194:195], v[56:57]
    v_pk_fma_f32 v[90:91], v[90:91], v[194:195], v[58:59] neg_lo:[0,0,1] neg_hi:[0,0,1]
    v_cvt_pk_bf16_f32 v133, v74, v75
    v_cvt_pk_bf16_f32 v141, v90, v91
    v_pk_mul_f32 v[56:57], v[122:123], v[242:243]
    v_pk_mul_f32 v[58:59], v[106:107], v[242:243]
    v_pk_fma_f32 v[106:107], v[106:107], v[226:227], v[56:57]
    v_pk_fma_f32 v[122:123], v[122:123], v[226:227], v[58:59] neg_lo:[0,0,1] neg_hi:[0,0,1]
    v_cvt_pk_bf16_f32 v149, v106, v107
    v_cvt_pk_bf16_f32 v157, v122, v123
    v_pk_mul_f32 v[48:49], v[124:125], v[248:249] op_sel:[0,1] op_sel_hi:[1,1]
    v_pk_mul_f32 v[50:51], v[108:109], v[248:249] op_sel:[0,1] op_sel_hi:[1,1]
    v_pk_fma_f32 v[52:53], v[108:109], v[248:249], v[48:49] op_sel_hi:[1,0,1]
    v_pk_fma_f32 v[54:55], v[124:125], v[248:249], v[50:51] op_sel_hi:[1,0,1] neg_lo:[0,0,1] neg_hi:[0,0,1]
    v_pk_add_f32 v[108:109], v[76:77], v[52:53] neg_lo:[0,1] neg_hi:[0,1]
    v_pk_add_f32 v[124:125], v[92:93], v[54:55] neg_lo:[0,1] neg_hi:[0,1]
    v_pk_add_f32 v[76:77], v[76:77], v[52:53]
    v_pk_add_f32 v[92:93], v[92:93], v[54:55]
    v_pk_mul_f32 v[48:49], v[92:93], v[212:213]
    v_pk_mul_f32 v[50:51], v[76:77], v[212:213]
    v_pk_fma_f32 v[76:77], v[76:77], v[196:197], v[48:49]
    v_pk_fma_f32 v[92:93], v[92:93], v[196:197], v[50:51] neg_lo:[0,0,1] neg_hi:[0,0,1]
    v_cvt_pk_bf16_f32 v134, v76, v77
    v_cvt_pk_bf16_f32 v142, v92, v93
    v_pk_mul_f32 v[48:49], v[124:125], v[244:245]
    v_pk_mul_f32 v[50:51], v[108:109], v[244:245]
    v_pk_fma_f32 v[108:109], v[108:109], v[228:229], v[48:49]
    v_pk_fma_f32 v[124:125], v[124:125], v[228:229], v[50:51] neg_lo:[0,0,1] neg_hi:[0,0,1]
    v_cvt_pk_bf16_f32 v150, v108, v109
    v_cvt_pk_bf16_f32 v158, v124, v125
    v_pk_mul_f32 v[56:57], v[126:127], v[248:249] op_sel:[0,1] op_sel_hi:[1,1]
    v_pk_mul_f32 v[58:59], v[110:111], v[248:249] op_sel:[0,1] op_sel_hi:[1,1]
    v_pk_fma_f32 v[60:61], v[110:111], v[248:249], v[56:57] op_sel_hi:[1,0,1]
    v_pk_fma_f32 v[62:63], v[126:127], v[248:249], v[58:59] op_sel_hi:[1,0,1] neg_lo:[0,0,1] neg_hi:[0,0,1]
    v_pk_add_f32 v[110:111], v[78:79], v[60:61] neg_lo:[0,1] neg_hi:[0,1]
    v_pk_add_f32 v[126:127], v[94:95], v[62:63] neg_lo:[0,1] neg_hi:[0,1]
    v_pk_add_f32 v[78:79], v[78:79], v[60:61]
    v_pk_add_f32 v[94:95], v[94:95], v[62:63]
    v_pk_mul_f32 v[56:57], v[94:95], v[214:215]
    v_pk_mul_f32 v[58:59], v[78:79], v[214:215]
    v_pk_fma_f32 v[78:79], v[78:79], v[198:199], v[56:57]
    v_pk_fma_f32 v[94:95], v[94:95], v[198:199], v[58:59] neg_lo:[0,0,1] neg_hi:[0,0,1]
    v_cvt_pk_bf16_f32 v135, v78, v79
    v_cvt_pk_bf16_f32 v143, v94, v95
    v_pk_mul_f32 v[56:57], v[126:127], v[246:247]
    v_pk_mul_f32 v[58:59], v[110:111], v[246:247]
    v_pk_fma_f32 v[110:111], v[110:111], v[230:231], v[56:57]
    v_pk_fma_f32 v[126:127], v[126:127], v[230:231], v[58:59] neg_lo:[0,0,1] neg_hi:[0,0,1]
    v_cvt_pk_bf16_f32 v151, v110, v111
    v_cvt_pk_bf16_f32 v159, v126, v127
    s_lshl_b32 s40, s28, 1
    s_mul_i32 s40, s40, 4160
    s_add_u32 s40, s40, 0
    v_lshlrev_b32 v4, 4, v1
    v_add_u32 v4, s40, v4
    v_mfma_f32_32x32x16_bf16 v[64:79], v[160:163], v[128:131], 0
    v_mfma_f32_32x32x16_bf16 v[64:79], v[164:167], v[132:135], v[64:79]
    v_mfma_f32_32x32x16_bf16 v[64:79], v[168:171], v[136:139], v[64:79]
    v_mfma_f32_32x32x16_bf16 v[64:79], v[172:175], v[140:143], v[64:79]
    v_mfma_f32_32x32x16_bf16 v[80:95], v[176:179], v[128:131], 0
    v_mfma_f32_32x32x16_bf16 v[80:95], v[180:183], v[132:135], v[80:95]
    v_mfma_f32_32x32x16_bf16 v[80:95], v[160:163], v[136:139], v[80:95]
    v_mfma_f32_32x32x16_bf16 v[80:95], v[164:167], v[140:143], v[80:95]
    v_mfma_f32_32x32x16_bf16 v[96:111], v[160:163], v[144:147], 0
    v_mfma_f32_32x32x16_bf16 v[96:111], v[164:167], v[148:151], v[96:111]
    v_mfma_f32_32x32x16_bf16 v[96:111], v[168:171], v[152:155], v[96:111]
    v_mfma_f32_32x32x16_bf16 v[96:111], v[172:175], v[156:159], v[96:111]
    s_nop 3
    v_cvt_pk_bf16_f32 v16, v64, v65
    v_cvt_pk_bf16_f32 v17, v66, v67
    v_cvt_pk_bf16_f32 v18, v68, v69
    v_cvt_pk_bf16_f32 v19, v70, v71
    ds_write_b128 v4, v[16:19] offset:0
    v_cvt_pk_bf16_f32 v20, v72, v73
    v_cvt_pk_bf16_f32 v21, v74, v75
    v_cvt_pk_bf16_f32 v22, v76, v77
    v_cvt_pk_bf16_f32 v23, v78, v79
    ds_write_b128 v4, v[20:23] offset:1024
    v_mfma_f32_32x32x16_bf16 v[112:127], v[176:179], v[144:147], 0
    v_mfma_f32_32x32x16_bf16 v[112:127], v[180:183], v[148:151], v[112:127]
    v_mfma_f32_32x32x16_bf16 v[112:127], v[160:163], v[152:155], v[112:127]
    v_mfma_f32_32x32x16_bf16 v[112:127], v[164:167], v[156:159], v[112:127]
    v_cvt_pk_bf16_f32 v24, v80, v81
    v_cvt_pk_bf16_f32 v25, v82, v83
    v_cvt_pk_bf16_f32 v26, v84, v85
    v_cvt_pk_bf16_f32 v27, v86, v87
    ds_write_b128 v4, v[24:27] offset:4160
    v_cvt_pk_bf16_f32 v28, v88, v89
    v_cvt_pk_bf16_f32 v29, v90, v91
    v_cvt_pk_bf16_f32 v30, v92, v93
    v_cvt_pk_bf16_f32 v31, v94, v95
    ds_write_b128 v4, v[28:31] offset:5184
    v_cvt_pk_bf16_f32 v32, v96, v97
    v_cvt_pk_bf16_f32 v33, v98, v99
    v_cvt_pk_bf16_f32 v34, v100, v101
    v_cvt_pk_bf16_f32 v35, v102, v103
    ds_write_b128 v4, v[32:35] offset:2048
    v_cvt_pk_bf16_f32 v36, v104, v105
    v_cvt_pk_bf16_f32 v37, v106, v107
    v_cvt_pk_bf16_f32 v38, v108, v109
    v_cvt_pk_bf16_f32 v39, v110, v111
    ds_write_b128 v4, v[36:39] offset:3072
    v_cvt_pk_bf16_f32 v40, v112, v113
    v_cvt_pk_bf16_f32 v41, v114, v115
    v_cvt_pk_bf16_f32 v42, v116, v117
    v_cvt_pk_bf16_f32 v43, v118, v119
    ds_write_b128 v4, v[40:43] offset:6208
    v_cvt_pk_bf16_f32 v44, v120, v121
    v_cvt_pk_bf16_f32 v45, v122, v123
    v_cvt_pk_bf16_f32 v46, v124, v125
    v_cvt_pk_bf16_f32 v47, v126, v127
    ds_write_b128 v4, v[44:47] offset:7232
    s_waitcnt lgkmcnt(0)
    s_barrier
    v_and_b32 v4, 15, v1
    v_lshrrev_b32 v4, 2, v4
    v_mul_u32_u24 v4, 4160, v4
    v_lshrrev_b32 v5, 4, v1
    v_lshlrev_b32 v6, 5, v5
    v_add_u32 v4, v4, v6
    v_and_b32 v6, 3, v1
    v_lshlrev_b32 v6, 3, v6
    v_add_u32 v4, v4, v6
    s_lshl_b32 s40, s28, 10
    s_add_u32 s40, s40, 0
    v_add_u32 v4, s40, v4
    ds_read_b64_tr_b16 v[64:65], v4 offset:0
    ds_read_b64_tr_b16 v[66:67], v4 offset:16640
    ds_read_b64_tr_b16 v[68:69], v4 offset:128
    ds_read_b64_tr_b16 v[70:71], v4 offset:16768
    ds_read_b64_tr_b16 v[72:73], v4 offset:256
    ds_read_b64_tr_b16 v[74:75], v4 offset:16896
    ds_read_b64_tr_b16 v[76:77], v4 offset:384
    ds_read_b64_tr_b16 v[78:79], v4 offset:17024
    ds_read_b64_tr_b16 v[80:81], v4 offset:512
    ds_read_b64_tr_b16 v[82:83], v4 offset:17152
    ds_read_b64_tr_b16 v[84:85], v4 offset:640
    ds_read_b64_tr_b16 v[86:87], v4 offset:17280
    ds_read_b64_tr_b16 v[88:89], v4 offset:768
    ds_read_b64_tr_b16 v[90:91], v4 offset:17408
    ds_read_b64_tr_b16 v[92:93], v4 offset:896
    ds_read_b64_tr_b16 v[94:95], v4 offset:17536
    v_mul_u32_u24 v5, 75776, v5
    v_and_b32 v6, 15, v1
    v_lshlrev_b32 v6, 4, v6
    v_add_u32 v5, v5, v6
    s_mul_i32 s40, s28, 2424832
    s_lshr_b32 s41, s29, 2
    s_add_u32 s41, s41, 54
    s_lshl_b32 s41, s41, 10
    s_add_u32 s40, s40, s41
    s_and_b32 s41, s29, 3
    s_lshl_b32 s41, s41, 8
    s_add_u32 s40, s40, s41
    s_add_u32 s40, s40, 0
    s_waitcnt lgkmcnt(0)
    buffer_store_dwordx4 v[64:67], v5, s[8:11], s40 offen sc1
    s_add_u32 s40, s40, 303104
    buffer_store_dwordx4 v[68:71], v5, s[8:11], s40 offen sc1
    s_add_u32 s40, s40, 303104
    buffer_store_dwordx4 v[72:75], v5, s[8:11], s40 offen sc1
    s_add_u32 s40, s40, 303104
    buffer_store_dwordx4 v[76:79], v5, s[8:11], s40 offen sc1
    s_add_u32 s40, s40, 303104
    buffer_store_dwordx4 v[80:83], v5, s[8:11], s40 offen sc1
    s_add_u32 s40, s40, 303104
    buffer_store_dwordx4 v[84:87], v5, s[8:11], s40 offen sc1
    s_add_u32 s40, s40, 303104
    buffer_store_dwordx4 v[88:91], v5, s[8:11], s40 offen sc1
    s_add_u32 s40, s40, 303104
    buffer_store_dwordx4 v[92:95], v5, s[8:11], s40 offen sc1
    s_add_u32 s40, s40, 303104
    s_waitcnt vmcnt(0)
    s_barrier
    s_cmp_eq_u32 s28, 0
    s_cbranch_scc0 L_k2_exit
    s_mul_i32 s44, s29, 3277
    s_lshr_b32 s44, s44, 16
    s_lshl_b32 s44, s44, 12
    s_add_u32 s44, s44, 20512768
    v_lshlrev_b32 v4, 7, v1
    v_add_u32 v4, s44, v4
    v_mov_b32 v5, 1
    v_cmp_gt_u32 vcc, 32, v1
    s_nop 0
    s_and_saveexec_b64 s[46:47], vcc
    buffer_atomic_add v5, v4, s[8:11], 0 offen
    s_endpgm
L_k2_gemm:
    s_load_dwordx2 s[4:5], s[0:1], 0
    s_load_dwordx2 s[6:7], s[0:1], 72
    s_load_dwordx2 s[24:25], s[0:1], 56
    s_sub_u32 s33, s2, 80
    v_lshrrev_b32 v2, 6, v0
    v_and_b32 v1, 63, v0
    v_readfirstlane_b32 s28, v2
    s_and_b32 s40, s2, 7
    s_lshr_b32 s41, s33, 3
    s_lshr_b32 s42, s40, 1
    s_mul_i32 s29, s42, 11
    s_add_u32 s29, s29, 1
    s_lshr_b32 s29, s29, 1
    s_lshr_b32 s43, s41, 2
    s_add_u32 s29, s29, s43
    s_and_b32 s30, s40, 1
    s_lshl_b32 s30, s30, 2
    s_and_b32 s43, s41, 3
    s_add_u32 s44, s30, s43
    s_cmp_ge_u32 s42, 2
    s_cselect_b32 s45, 16, 5
    s_and_b32 s46, s42, 1
    s_lshl_b32 s46, s46, 1
    s_add_u32 s46, s46, s30
    s_sub_u32 s47, s41, 20
    s_add_u32 s46, s46, s47
    s_cmp_ge_u32 s41, 20
    s_cselect_b32 s29, s45, s29
    s_cselect_b32 s30, s46, s44
    s_getpc_b64 s[46:47]
    s_add_u32 s46, s46, gf_table@rel32@lo+4
    s_addc_u32 s47, s47, gf_table@rel32@hi+12
    s_mov_b32 s12, s46
    s_mov_b32 s13, s47
    s_mov_b32 s14, 819200
    s_mov_b32 s15, 0x00020000
    v_lshlrev_b32 v21, 4, v1
    s_mul_i32 s40, s29, 454656
    s_add_u32 s40, s40, 0
    v_add_u32 v5, s40, v21
    v_add_u32 v6, 75776, v5
    v_add_u32 v7, 75776, v6
    v_add_u32 v8, 75776, v7
    v_add_u32 v9, 75776, v8
    v_add_u32 v10, 75776, v9
    s_mul_i32 s42, s29, 6
    s_add_u32 s42, s42, 2
    s_cmp_lt_u32 s42, 128
    s_cselect_b32 s42, 0, 0x7f000000
    v_add_u32 v7, s42, v7
    s_mul_i32 s42, s29, 6
    s_add_u32 s42, s42, 3
    s_cmp_lt_u32 s42, 128
    s_cselect_b32 s42, 0, 0x7f000000
    v_add_u32 v8, s42, v8
    s_mul_i32 s42, s29, 6
    s_add_u32 s42, s42, 4
    s_cmp_lt_u32 s42, 128
    s_cselect_b32 s42, 0, 0x7f000000
    v_add_u32 v9, s42, v9
    s_mul_i32 s42, s29, 6
    s_add_u32 s42, s42, 5
    s_cmp_lt_u32 s42, 128
    s_cselect_b32 s42, 0, 0x7f000000
    v_add_u32 v10, s42, v10
    s_mul_i32 s40, s30, 276480
    s_add_u32 s40, s40, 16777216
    v_add_u32 v11, s40, v21
    v_add_u32 v12, 55296, v11
    v_add_u32 v13, 55296, v12
    v_add_u32 v14, 55296, v13
    v_add_u32 v15, 55296, v14
    s_mul_i32 s40, s30, 102400
    v_add_u32 v16, s40, v21
    v_add_u32 v17, 20480, v16
    v_add_u32 v18, 20480, v17
    v_add_u32 v19, 20480, v18
    v_add_u32 v20, 20480, v19
    s_and_b32 s40, s33, 31
    s_lshl_b32 s40, s40, 7
    s_lshl_b32 s41, s28, 12
    s_add_u32 s40, s40, s41
    s_add_u32 s40, s40, 20512768
    v_mov_b32 v0, s40
    s_waitcnt lgkmcnt(0)
    s_mov_b32 s8, s6
    s_mov_b32 s9, s7
    s_mov_b32 s10, 25165824
    s_mov_b32 s11, 0x00020000
    s_mov_b32 s16, s4
    s_mov_b32 s17, s5
    s_mov_b32 s18, 2621440
    s_mov_b32 s19, 0x00020000
    s_mov_b32 s20, s24
    s_mov_b32 s21, s25
    s_mov_b32 s22, 2621440
    s_mov_b32 s23, 0x00020000
    s_mul_i32 s40, s28, 14
    s_cmp_eq_u32 s28, 3
    s_cselect_b32 s41, 1, 0
    s_sub_u32 s40, s40, s41
    s_lshl_b32 s40, s40, 10
    s_mul_i32 s41, s28, 5120
    s_cmp_ge_u32 s28, 2
    s_cbranch_scc1 L_kg_v13
    s_mov_b32 s32, s40
    s_mov_b32 s31, s32
    buffer_load_dwordx4 v[56:59], v11, s[8:11], s32 offen
    buffer_load_dwordx4 v[60:63], v12, s[8:11], s32 offen
    buffer_load_dwordx4 v[64:67], v13, s[8:11], s32 offen
    buffer_load_dwordx4 v[68:71], v14, s[8:11], s32 offen
    buffer_load_dwordx4 v[72:75], v15, s[8:11], s32 offen
    buffer_load_dwordx4 v[32:35], v5, s[8:11], s31 offen
    buffer_load_dwordx4 v[36:39], v6, s[8:11], s31 offen
    buffer_load_dwordx4 v[40:43], v7, s[8:11], s31 offen
    buffer_load_dwordx4 v[44:47], v8, s[8:11], s31 offen
    buffer_load_dwordx4 v[48:51], v9, s[8:11], s31 offen
    buffer_load_dwordx4 v[52:55], v10, s[8:11], s31 offen
    s_add_u32 s32, s32, 1024
    s_mov_b32 s31, s32
    buffer_load_dwordx4 v[100:103], v11, s[8:11], s32 offen
    buffer_load_dwordx4 v[104:107], v12, s[8:11], s32 offen
    buffer_load_dwordx4 v[108:111], v13, s[8:11], s32 offen
    buffer_load_dwordx4 v[112:115], v14, s[8:11], s32 offen
    buffer_load_dwordx4 v[116:119], v15, s[8:11], s32 offen
    buffer_load_dwordx4 v[76:79], v5, s[8:11], s31 offen
    buffer_load_dwordx4 v[80:83], v6, s[8:11], s31 offen
    buffer_load_dwordx4 v[84:87], v7, s[8:11], s31 offen
    buffer_load_dwordx4 v[88:91], v8, s[8:11], s31 offen
    buffer_load_dwordx4 v[92:95], v9, s[8:11], s31 offen
    buffer_load_dwordx4 v[96:99], v10, s[8:11], s31 offen
    s_add_u32 s32, s32, 1024
    s_mov_b32 s31, s32
    buffer_load_dwordx4 v[144:147], v11, s[8:11], s32 offen
    buffer_load_dwordx4 v[148:151], v12, s[8:11], s32 offen
    buffer_load_dwordx4 v[152:155], v13, s[8:11], s32 offen
    buffer_load_dwordx4 v[156:159], v14, s[8:11], s32 offen
    buffer_load_dwordx4 v[160:163], v15, s[8:11], s32 offen
    buffer_load_dwordx4 v[120:123], v5, s[8:11], s31 offen
    buffer_load_dwordx4 v[124:127], v6, s[8:11], s31 offen
    buffer_load_dwordx4 v[128:131], v7, s[8:11], s31 offen
    buffer_load_dwordx4 v[132:135], v8, s[8:11], s31 offen
    buffer_load_dwordx4 v[136:139], v9, s[8:11], s31 offen
    buffer_load_dwordx4 v[140:143], v10, s[8:11], s31 offen
    s_add_u32 s32, s32, 1024
    s_mov_b32 s31, s32
    buffer_load_dwordx4 v[188:191], v11, s[8:11], s32 offen
    buffer_load_dwordx4 v[192:195], v12, s[8:11], s32 offen
    buffer_load_dwordx4 v[196:199], v13, s[8:11], s32 offen
    buffer_load_dwordx4 v[200:203], v14, s[8:11], s32 offen
    buffer_load_dwordx4 v[204:207], v15, s[8:11], s32 offen
    buffer_load_dwordx4 v[164:167], v5, s[8:11], s31 offen
    buffer_load_dwordx4 v[168:171], v6, s[8:11], s31 offen
    buffer_load_dwordx4 v[172:175], v7, s[8:11], s31 offen
    buffer_load_dwordx4 v[176:179], v8, s[8:11], s31 offen
    buffer_load_dwordx4 v[180:183], v9, s[8:11], s31 offen
    buffer_load_dwordx4 v[184:187], v10, s[8:11], s31 offen
    s_add_u32 s32, s32, 1024
    s_mov_b32 s31, s32
    buffer_load_dwordx4 v[232:235], v11, s[8:11], s32 offen
    buffer_load_dwordx4 v[236:239], v12, s[8:11], s32 offen
    buffer_load_dwordx4 v[240:243], v13, s[8:11], s32 offen
    buffer_load_dwordx4 v[244:247], v14, s[8:11], s32 offen
    buffer_load_dwordx4 v[248:251], v15, s[8:11], s32 offen
    buffer_load_dwordx4 v[208:211], v5, s[8:11], s31 offen
    buffer_load_dwordx4 v[212:215], v6, s[8:11], s31 offen
    buffer_load_dwordx4 v[216:219], v7, s[8:11], s31 offen
    buffer_load_dwordx4 v[220:223], v8, s[8:11], s31 offen
    buffer_load_dwordx4 v[224:227], v9, s[8:11], s31 offen
    buffer_load_dwordx4 v[228:231], v10, s[8:11], s31 offen
    s_waitcnt vmcnt(44)
    s_add_u32 s32, s32, 1024
    s_mov_b32 s31, s32
    v_mfma_f32_16x16x32_bf16 a[0:3], v[56:59], v[32:35], 0
    v_mfma_f32_16x16x32_bf16 a[20:23], v[56:59], v[36:39], 0
    v_mfma_f32_16x16x32_bf16 a[40:43], v[56:59], v[40:43], 0
    v_mfma_f32_16x16x32_bf16 a[60:63], v[56:59], v[44:47], 0
    v_mfma_f32_16x16x32_bf16 a[80:83], v[56:59], v[48:51], 0
    v_mfma_f32_16x16x32_bf16 a[100:103], v[56:59], v[52:55], 0
    buffer_load_dwordx4 v[56:59], v11, s[8:11], s32 offen
    v_mfma_f32_16x16x32_bf16 a[4:7], v[60:63], v[32:35], 0
    v_mfma_f32_16x16x32_bf16 a[24:27], v[60:63], v[36:39], 0
    v_mfma_f32_16x16x32_bf16 a[44:47], v[60:63], v[40:43], 0
    v_mfma_f32_16x16x32_bf16 a[64:67], v[60:63], v[44:47], 0
    v_mfma_f32_16x16x32_bf16 a[84:87], v[60:63], v[48:51], 0
    v_mfma_f32_16x16x32_bf16 a[104:107], v[60:63], v[52:55], 0
    buffer_load_dwordx4 v[60:63], v12, s[8:11], s32 offen
    v_mfma_f32_16x16x32_bf16 a[8:11], v[64:67], v[32:35], 0
    v_mfma_f32_16x16x32_bf16 a[28:31], v[64:67], v[36:39], 0
    v_mfma_f32_16x16x32_bf16 a[48:51], v[64:67], v[40:43], 0
    v_mfma_f32_16x16x32_bf16 a[68:71], v[64:67], v[44:47], 0
    v_mfma_f32_16x16x32_bf16 a[88:91], v[64:67], v[48:51], 0
    v_mfma_f32_16x16x32_bf16 a[108:111], v[64:67], v[52:55], 0
    buffer_load_dwordx4 v[64:67], v13, s[8:11], s32 offen
    v_mfma_f32_16x16x32_bf16 a[12:15], v[68:71], v[32:35], 0
    v_mfma_f32_16x16x32_bf16 a[32:35], v[68:71], v[36:39], 0
    v_mfma_f32_16x16x32_bf16 a[52:55], v[68:71], v[40:43], 0
    v_mfma_f32_16x16x32_bf16 a[72:75], v[68:71], v[44:47], 0
    v_mfma_f32_16x16x32_bf16 a[92:95], v[68:71], v[48:51], 0
    v_mfma_f32_16x16x32_bf16 a[112:115], v[68:71], v[52:55], 0
    buffer_load_dwordx4 v[68:71], v14, s[8:11], s32 offen
    v_mfma_f32_16x16x32_bf16 a[16:19], v[72:75], v[32:35], 0
    v_mfma_f32_16x16x32_bf16 a[36:39], v[72:75], v[36:39], 0
    v_mfma_f32_16x16x32_bf16 a[56:59], v[72:75], v[40:43], 0
    v_mfma_f32_16x16x32_bf16 a[76:79], v[72:75], v[44:47], 0
    v_mfma_f32_16x16x32_bf16 a[96:99], v[72:75], v[48:51], 0
    v_mfma_f32_16x16x32_bf16 a[116:119], v[72:75], v[52:55], 0
    buffer_load_dwordx4 v[72:75], v15, s[8:11], s32 offen
    buffer_load_dwordx4 v[32:35], v5, s[8:11], s31 offen
    buffer_load_dwordx4 v[36:39], v6, s[8:11], s31 offen
    buffer_load_dwordx4 v[40:43], v7, s[8:11], s31 offen
    buffer_load_dwordx4 v[44:47], v8, s[8:11], s31 offen
    buffer_load_dwordx4 v[48:51], v9, s[8:11], s31 offen
    buffer_load_dwordx4 v[52:55], v10, s[8:11], s31 offen
    s_waitcnt vmcnt(44)
    s_add_u32 s32, s32, 1024
    s_mov_b32 s31, s32
    v_mfma_f32_16x16x32_bf16 a[0:3], v[100:103], v[76:79], a[0:3]
    v_mfma_f32_16x16x32_bf16 a[20:23], v[100:103], v[80:83], a[20:23]
    v_mfma_f32_16x16x32_bf16 a[40:43], v[100:103], v[84:87], a[40:43]
    v_mfma_f32_16x16x32_bf16 a[60:63], v[100:103], v[88:91], a[60:63]
    v_mfma_f32_16x16x32_bf16 a[80:83], v[100:103], v[92:95], a[80:83]
    v_mfma_f32_16x16x32_bf16 a[100:103], v[100:103], v[96:99], a[100:103]
    buffer_load_dwordx4 v[100:103], v11, s[8:11], s32 offen
    v_mfma_f32_16x16x32_bf16 a[4:7], v[104:107], v[76:79], a[4:7]
    v_mfma_f32_16x16x32_bf16 a[24:27], v[104:107], v[80:83], a[24:27]
    v_mfma_f32_16x16x32_bf16 a[44:47], v[104:107], v[84:87], a[44:47]
    v_mfma_f32_16x16x32_bf16 a[64:67], v[104:107], v[88:91], a[64:67]
    v_mfma_f32_16x16x32_bf16 a[84:87], v[104:107], v[92:95], a[84:87]
    v_mfma_f32_16x16x32_bf16 a[104:107], v[104:107], v[96:99], a[104:107]
    buffer_load_dwordx4 v[104:107], v12, s[8:11], s32 offen
    v_mfma_f32_16x16x32_bf16 a[8:11], v[108:111], v[76:79], a[8:11]
    v_mfma_f32_16x16x32_bf16 a[28:31], v[108:111], v[80:83], a[28:31]
    v_mfma_f32_16x16x32_bf16 a[48:51], v[108:111], v[84:87], a[48:51]
    v_mfma_f32_16x16x32_bf16 a[68:71], v[108:111], v[88:91], a[68:71]
    v_mfma_f32_16x16x32_bf16 a[88:91], v[108:111], v[92:95], a[88:91]
    v_mfma_f32_16x16x32_bf16 a[108:111], v[108:111], v[96:99], a[108:111]
    buffer_load_dwordx4 v[108:111], v13, s[8:11], s32 offen
    v_mfma_f32_16x16x32_bf16 a[12:15], v[112:115], v[76:79], a[12:15]
    v_mfma_f32_16x16x32_bf16 a[32:35], v[112:115], v[80:83], a[32:35]
    v_mfma_f32_16x16x32_bf16 a[52:55], v[112:115], v[84:87], a[52:55]
    v_mfma_f32_16x16x32_bf16 a[72:75], v[112:115], v[88:91], a[72:75]
    v_mfma_f32_16x16x32_bf16 a[92:95], v[112:115], v[92:95], a[92:95]
    v_mfma_f32_16x16x32_bf16 a[112:115], v[112:115], v[96:99], a[112:115]
    buffer_load_dwordx4 v[112:115], v14, s[8:11], s32 offen
    v_mfma_f32_16x16x32_bf16 a[16:19], v[116:119], v[76:79], a[16:19]
    v_mfma_f32_16x16x32_bf16 a[36:39], v[116:119], v[80:83], a[36:39]
    v_mfma_f32_16x16x32_bf16 a[56:59], v[116:119], v[84:87], a[56:59]
    v_mfma_f32_16x16x32_bf16 a[76:79], v[116:119], v[88:91], a[76:79]
    v_mfma_f32_16x16x32_bf16 a[96:99], v[116:119], v[92:95], a[96:99]
    v_mfma_f32_16x16x32_bf16 a[116:119], v[116:119], v[96:99], a[116:119]
    buffer_load_dwordx4 v[116:119], v15, s[8:11], s32 offen
    buffer_load_dwordx4 v[76:79], v5, s[8:11], s31 offen
    buffer_load_dwordx4 v[80:83], v6, s[8:11], s31 offen
    buffer_load_dwordx4 v[84:87], v7, s[8:11], s31 offen
    buffer_load_dwordx4 v[88:91], v8, s[8:11], s31 offen
    buffer_load_dwordx4 v[92:95], v9, s[8:11], s31 offen
    buffer_load_dwordx4 v[96:99], v10, s[8:11], s31 offen
    s_waitcnt vmcnt(44)
    s_add_u32 s32, s32, 1024
    s_mov_b32 s31, s32
    v_mfma_f32_16x16x32_bf16 a[0:3], v[144:147], v[120:123], a[0:3]
    v_mfma_f32_16x16x32_bf16 a[20:23], v[144:147], v[124:127], a[20:23]
    v_mfma_f32_16x16x32_bf16 a[40:43], v[144:147], v[128:131], a[40:43]
    v_mfma_f32_16x16x32_bf16 a[60:63], v[144:147], v[132:135], a[60:63]
    v_mfma_f32_16x16x32_bf16 a[80:83], v[144:147], v[136:139], a[80:83]
    v_mfma_f32_16x16x32_bf16 a[100:103], v[144:147], v[140:143], a[100:103]
    buffer_load_dwordx4 v[144:147], v11, s[8:11], s32 offen
    v_mfma_f32_16x16x32_bf16 a[4:7], v[148:151], v[120:123], a[4:7]
    v_mfma_f32_16x16x32_bf16 a[24:27], v[148:151], v[124:127], a[24:27]
    v_mfma_f32_16x16x32_bf16 a[44:47], v[148:151], v[128:131], a[44:47]
    v_mfma_f32_16x16x32_bf16 a[64:67], v[148:151], v[132:135], a[64:67]
    v_mfma_f32_16x16x32_bf16 a[84:87], v[148:151], v[136:139], a[84:87]
    v_mfma_f32_16x16x32_bf16 a[104:107], v[148:151], v[140:143], a[104:107]
    buffer_load_dwordx4 v[148:151], v12, s[8:11], s32 offen
    v_mfma_f32_16x16x32_bf16 a[8:11], v[152:155], v[120:123], a[8:11]
    v_mfma_f32_16x16x32_bf16 a[28:31], v[152:155], v[124:127], a[28:31]
    v_mfma_f32_16x16x32_bf16 a[48:51], v[152:155], v[128:131], a[48:51]
    v_mfma_f32_16x16x32_bf16 a[68:71], v[152:155], v[132:135], a[68:71]
    v_mfma_f32_16x16x32_bf16 a[88:91], v[152:155], v[136:139], a[88:91]
    v_mfma_f32_16x16x32_bf16 a[108:111], v[152:155], v[140:143], a[108:111]
    buffer_load_dwordx4 v[152:155], v13, s[8:11], s32 offen
    v_mfma_f32_16x16x32_bf16 a[12:15], v[156:159], v[120:123], a[12:15]
    v_mfma_f32_16x16x32_bf16 a[32:35], v[156:159], v[124:127], a[32:35]
    v_mfma_f32_16x16x32_bf16 a[52:55], v[156:159], v[128:131], a[52:55]
    v_mfma_f32_16x16x32_bf16 a[72:75], v[156:159], v[132:135], a[72:75]
    v_mfma_f32_16x16x32_bf16 a[92:95], v[156:159], v[136:139], a[92:95]
    v_mfma_f32_16x16x32_bf16 a[112:115], v[156:159], v[140:143], a[112:115]
    buffer_load_dwordx4 v[156:159], v14, s[8:11], s32 offen
    v_mfma_f32_16x16x32_bf16 a[16:19], v[160:163], v[120:123], a[16:19]
    v_mfma_f32_16x16x32_bf16 a[36:39], v[160:163], v[124:127], a[36:39]
    v_mfma_f32_16x16x32_bf16 a[56:59], v[160:163], v[128:131], a[56:59]
    v_mfma_f32_16x16x32_bf16 a[76:79], v[160:163], v[132:135], a[76:79]
    v_mfma_f32_16x16x32_bf16 a[96:99], v[160:163], v[136:139], a[96:99]
    v_mfma_f32_16x16x32_bf16 a[116:119], v[160:163], v[140:143], a[116:119]
    buffer_load_dwordx4 v[160:163], v15, s[8:11], s32 offen
    buffer_load_dwordx4 v[120:123], v5, s[8:11], s31 offen
    buffer_load_dwordx4 v[124:127], v6, s[8:11], s31 offen
    buffer_load_dwordx4 v[128:131], v7, s[8:11], s31 offen
    buffer_load_dwordx4 v[132:135], v8, s[8:11], s31 offen
    buffer_load_dwordx4 v[136:139], v9, s[8:11], s31 offen
    buffer_load_dwordx4 v[140:143], v10, s[8:11], s31 offen
    s_waitcnt vmcnt(44)
    s_add_u32 s32, s32, 1024
    s_mov_b32 s31, s32
    v_mfma_f32_16x16x32_bf16 a[0:3], v[188:191], v[164:167], a[0:3]
    v_mfma_f32_16x16x32_bf16 a[20:23], v[188:191], v[168:171], a[20:23]
    v_mfma_f32_16x16x32_bf16 a[40:43], v[188:191], v[172:175], a[40:43]
    v_mfma_f32_16x16x32_bf16 a[60:63], v[188:191], v[176:179], a[60:63]
    v_mfma_f32_16x16x32_bf16 a[80:83], v[188:191], v[180:183], a[80:83]
    v_mfma_f32_16x16x32_bf16 a[100:103], v[188:191], v[184:187], a[100:103]
    buffer_load_dwordx4 v[188:191], v11, s[8:11], s32 offen
    v_mfma_f32_16x16x32_bf16 a[4:7], v[192:195], v[164:167], a[4:7]
    v_mfma_f32_16x16x32_bf16 a[24:27], v[192:195], v[168:171], a[24:27]
    v_mfma_f32_16x16x32_bf16 a[44:47], v[192:195], v[172:175], a[44:47]
    v_mfma_f32_16x16x32_bf16 a[64:67], v[192:195], v[176:179], a[64:67]
    v_mfma_f32_16x16x32_bf16 a[84:87], v[192:195], v[180:183], a[84:87]
    v_mfma_f32_16x16x32_bf16 a[104:107], v[192:195], v[184:187], a[104:107]
    buffer_load_dwordx4 v[192:195], v12, s[8:11], s32 offen
    v_mfma_f32_16x16x32_bf16 a[8:11], v[196:199], v[164:167], a[8:11]
    v_mfma_f32_16x16x32_bf16 a[28:31], v[196:199], v[168:171], a[28:31]
    v_mfma_f32_16x16x32_bf16 a[48:51], v[196:199], v[172:175], a[48:51]
    v_mfma_f32_16x16x32_bf16 a[68:71], v[196:199], v[176:179], a[68:71]
    v_mfma_f32_16x16x32_bf16 a[88:91], v[196:199], v[180:183], a[88:91]
    v_mfma_f32_16x16x32_bf16 a[108:111], v[196:199], v[184:187], a[108:111]
    buffer_load_dwordx4 v[196:199], v13, s[8:11], s32 offen
    v_mfma_f32_16x16x32_bf16 a[12:15], v[200:203], v[164:167], a[12:15]
    v_mfma_f32_16x16x32_bf16 a[32:35], v[200:203], v[168:171], a[32:35]
    v_mfma_f32_16x16x32_bf16 a[52:55], v[200:203], v[172:175], a[52:55]
    v_mfma_f32_16x16x32_bf16 a[72:75], v[200:203], v[176:179], a[72:75]
    v_mfma_f32_16x16x32_bf16 a[92:95], v[200:203], v[180:183], a[92:95]
    v_mfma_f32_16x16x32_bf16 a[112:115], v[200:203], v[184:187], a[112:115]
    buffer_load_dwordx4 v[200:203], v14, s[8:11], s32 offen
    v_mfma_f32_16x16x32_bf16 a[16:19], v[204:207], v[164:167], a[16:19]
    v_mfma_f32_16x16x32_bf16 a[36:39], v[204:207], v[168:171], a[36:39]
    v_mfma_f32_16x16x32_bf16 a[56:59], v[204:207], v[172:175], a[56:59]
    v_mfma_f32_16x16x32_bf16 a[76:79], v[204:207], v[176:179], a[76:79]
    v_mfma_f32_16x16x32_bf16 a[96:99], v[204:207], v[180:183], a[96:99]
    v_mfma_f32_16x16x32_bf16 a[116:119], v[204:207], v[184:187], a[116:119]
    buffer_load_dwordx4 v[204:207], v15, s[8:11], s32 offen
    buffer_load_dwordx4 v[164:167], v5, s[8:11], s31 offen
    buffer_load_dwordx4 v[168:171], v6, s[8:11], s31 offen
    buffer_load_dwordx4 v[172:175], v7, s[8:11], s31 offen
    buffer_load_dwordx4 v[176:179], v8, s[8:11], s31 offen
    buffer_load_dwordx4 v[180:183], v9, s[8:11], s31 offen
    buffer_load_dwordx4 v[184:187], v10, s[8:11], s31 offen
    s_waitcnt vmcnt(44)
    s_add_u32 s32, s32, 1024
    s_mov_b32 s31, s32
    v_mfma_f32_16x16x32_bf16 a[0:3], v[232:235], v[208:211], a[0:3]
    v_mfma_f32_16x16x32_bf16 a[20:23], v[232:235], v[212:215], a[20:23]
    v_mfma_f32_16x16x32_bf16 a[40:43], v[232:235], v[216:219], a[40:43]
    v_mfma_f32_16x16x32_bf16 a[60:63], v[232:235], v[220:223], a[60:63]
    v_mfma_f32_16x16x32_bf16 a[80:83], v[232:235], v[224:227], a[80:83]
    v_mfma_f32_16x16x32_bf16 a[100:103], v[232:235], v[228:231], a[100:103]
    buffer_load_dwordx4 v[232:235], v11, s[8:11], s32 offen
    v_mfma_f32_16x16x32_bf16 a[4:7], v[236:239], v[208:211], a[4:7]
    v_mfma_f32_16x16x32_bf16 a[24:27], v[236:239], v[212:215], a[24:27]
    v_mfma_f32_16x16x32_bf16 a[44:47], v[236:239], v[216:219], a[44:47]
    v_mfma_f32_16x16x32_bf16 a[64:67], v[236:239], v[220:223], a[64:67]
    v_mfma_f32_16x16x32_bf16 a[84:87], v[236:239], v[224:227], a[84:87]
    v_mfma_f32_16x16x32_bf16 a[104:107], v[236:239], v[228:231], a[104:107]
    buffer_load_dwordx4 v[236:239], v12, s[8:11], s32 offen
    v_mfma_f32_16x16x32_bf16 a[8:11], v[240:243], v[208:211], a[8:11]
    v_mfma_f32_16x16x32_bf16 a[28:31], v[240:243], v[212:215], a[28:31]
    v_mfma_f32_16x16x32_bf16 a[48:51], v[240:243], v[216:219], a[48:51]
    v_mfma_f32_16x16x32_bf16 a[68:71], v[240:243], v[220:223], a[68:71]
    v_mfma_f32_16x16x32_bf16 a[88:91], v[240:243], v[224:227], a[88:91]
    v_mfma_f32_16x16x32_bf16 a[108:111], v[240:243], v[228:231], a[108:111]
    buffer_load_dwordx4 v[240:243], v13, s[8:11], s32 offen
    v_mfma_f32_16x16x32_bf16 a[12:15], v[244:247], v[208:211], a[12:15]
    v_mfma_f32_16x16x32_bf16 a[32:35], v[244:247], v[212:215], a[32:35]
    v_mfma_f32_16x16x32_bf16 a[52:55], v[244:247], v[216:219], a[52:55]
    v_mfma_f32_16x16x32_bf16 a[72:75], v[244:247], v[220:223], a[72:75]
    v_mfma_f32_16x16x32_bf16 a[92:95], v[244:247], v[224:227], a[92:95]
    v_mfma_f32_16x16x32_bf16 a[112:115], v[244:247], v[228:231], a[112:115]
    buffer_load_dwordx4 v[244:247], v14, s[8:11], s32 offen
    v_mfma_f32_16x16x32_bf16 a[16:19], v[248:251], v[208:211], a[16:19]
    v_mfma_f32_16x16x32_bf16 a[36:39], v[248:251], v[212:215], a[36:39]
    v_mfma_f32_16x16x32_bf16 a[56:59], v[248:251], v[216:219], a[56:59]
    v_mfma_f32_16x16x32_bf16 a[76:79], v[248:251], v[220:223], a[76:79]
    v_mfma_f32_16x16x32_bf16 a[96:99], v[248:251], v[224:227], a[96:99]
    v_mfma_f32_16x16x32_bf16 a[116:119], v[248:251], v[228:231], a[116:119]
    buffer_load_dwordx4 v[248:251], v15, s[8:11], s32 offen
    buffer_load_dwordx4 v[208:211], v5, s[8:11], s31 offen
    buffer_load_dwordx4 v[212:215], v6, s[8:11], s31 offen
    buffer_load_dwordx4 v[216:219], v7, s[8:11], s31 offen
    buffer_load_dwordx4 v[220:223], v8, s[8:11], s31 offen
    buffer_load_dwordx4 v[224:227], v9, s[8:11], s31 offen
    buffer_load_dwordx4 v[228:231], v10, s[8:11], s31 offen
    s_waitcnt vmcnt(44)
    s_add_u32 s32, s32, 1024
    s_mov_b32 s31, s32
    v_mfma_f32_16x16x32_bf16 a[0:3], v[56:59], v[32:35], a[0:3]
    v_mfma_f32_16x16x32_bf16 a[20:23], v[56:59], v[36:39], a[20:23]
    v_mfma_f32_16x16x32_bf16 a[40:43], v[56:59], v[40:43], a[40:43]
    v_mfma_f32_16x16x32_bf16 a[60:63], v[56:59], v[44:47], a[60:63]
    v_mfma_f32_16x16x32_bf16 a[80:83], v[56:59], v[48:51], a[80:83]
    v_mfma_f32_16x16x32_bf16 a[100:103], v[56:59], v[52:55], a[100:103]
    buffer_load_dwordx4 v[56:59], v11, s[8:11], s32 offen
    v_mfma_f32_16x16x32_bf16 a[4:7], v[60:63], v[32:35], a[4:7]
    v_mfma_f32_16x16x32_bf16 a[24:27], v[60:63], v[36:39], a[24:27]
    v_mfma_f32_16x16x32_bf16 a[44:47], v[60:63], v[40:43], a[44:47]
    v_mfma_f32_16x16x32_bf16 a[64:67], v[60:63], v[44:47], a[64:67]
    v_mfma_f32_16x16x32_bf16 a[84:87], v[60:63], v[48:51], a[84:87]
    v_mfma_f32_16x16x32_bf16 a[104:107], v[60:63], v[52:55], a[104:107]
    buffer_load_dwordx4 v[60:63], v12, s[8:11], s32 offen
    v_mfma_f32_16x16x32_bf16 a[8:11], v[64:67], v[32:35], a[8:11]
    v_mfma_f32_16x16x32_bf16 a[28:31], v[64:67], v[36:39], a[28:31]
    v_mfma_f32_16x16x32_bf16 a[48:51], v[64:67], v[40:43], a[48:51]
    v_mfma_f32_16x16x32_bf16 a[68:71], v[64:67], v[44:47], a[68:71]
    v_mfma_f32_16x16x32_bf16 a[88:91], v[64:67], v[48:51], a[88:91]
    v_mfma_f32_16x16x32_bf16 a[108:111], v[64:67], v[52:55], a[108:111]
    buffer_load_dwordx4 v[64:67], v13, s[8:11], s32 offen
    v_mfma_f32_16x16x32_bf16 a[12:15], v[68:71], v[32:35], a[12:15]
    v_mfma_f32_16x16x32_bf16 a[32:35], v[68:71], v[36:39], a[32:35]
    v_mfma_f32_16x16x32_bf16 a[52:55], v[68:71], v[40:43], a[52:55]
    v_mfma_f32_16x16x32_bf16 a[72:75], v[68:71], v[44:47], a[72:75]
    v_mfma_f32_16x16x32_bf16 a[92:95], v[68:71], v[48:51], a[92:95]
    v_mfma_f32_16x16x32_bf16 a[112:115], v[68:71], v[52:55], a[112:115]
    buffer_load_dwordx4 v[68:71], v14, s[8:11], s32 offen
    v_mfma_f32_16x16x32_bf16 a[16:19], v[72:75], v[32:35], a[16:19]
    v_mfma_f32_16x16x32_bf16 a[36:39], v[72:75], v[36:39], a[36:39]
    v_mfma_f32_16x16x32_bf16 a[56:59], v[72:75], v[40:43], a[56:59]
    v_mfma_f32_16x16x32_bf16 a[76:79], v[72:75], v[44:47], a[76:79]
    v_mfma_f32_16x16x32_bf16 a[96:99], v[72:75], v[48:51], a[96:99]
    v_mfma_f32_16x16x32_bf16 a[116:119], v[72:75], v[52:55], a[116:119]
    buffer_load_dwordx4 v[72:75], v15, s[8:11], s32 offen
    buffer_load_dwordx4 v[32:35], v5, s[8:11], s31 offen
    buffer_load_dwordx4 v[36:39], v6, s[8:11], s31 offen
    buffer_load_dwordx4 v[40:43], v7, s[8:11], s31 offen
    buffer_load_dwordx4 v[44:47], v8, s[8:11], s31 offen
    buffer_load_dwordx4 v[48:51], v9, s[8:11], s31 offen
    buffer_load_dwordx4 v[52:55], v10, s[8:11], s31 offen
    s_waitcnt vmcnt(44)
    s_add_u32 s32, s32, 1024
    s_mov_b32 s31, s32
    v_mfma_f32_16x16x32_bf16 a[0:3], v[100:103], v[76:79], a[0:3]
    v_mfma_f32_16x16x32_bf16 a[20:23], v[100:103], v[80:83], a[20:23]
    v_mfma_f32_16x16x32_bf16 a[40:43], v[100:103], v[84:87], a[40:43]
    v_mfma_f32_16x16x32_bf16 a[60:63], v[100:103], v[88:91], a[60:63]
    v_mfma_f32_16x16x32_bf16 a[80:83], v[100:103], v[92:95], a[80:83]
    v_mfma_f32_16x16x32_bf16 a[100:103], v[100:103], v[96:99], a[100:103]
    buffer_load_dwordx4 v[100:103], v11, s[8:11], s32 offen
    v_mfma_f32_16x16x32_bf16 a[4:7], v[104:107], v[76:79], a[4:7]
    v_mfma_f32_16x16x32_bf16 a[24:27], v[104:107], v[80:83], a[24:27]
    v_mfma_f32_16x16x32_bf16 a[44:47], v[104:107], v[84:87], a[44:47]
    v_mfma_f32_16x16x32_bf16 a[64:67], v[104:107], v[88:91], a[64:67]
    v_mfma_f32_16x16x32_bf16 a[84:87], v[104:107], v[92:95], a[84:87]
    v_mfma_f32_16x16x32_bf16 a[104:107], v[104:107], v[96:99], a[104:107]
    buffer_load_dwordx4 v[104:107], v12, s[8:11], s32 offen
    v_mfma_f32_16x16x32_bf16 a[8:11], v[108:111], v[76:79], a[8:11]
    v_mfma_f32_16x16x32_bf16 a[28:31], v[108:111], v[80:83], a[28:31]
    v_mfma_f32_16x16x32_bf16 a[48:51], v[108:111], v[84:87], a[48:51]
    v_mfma_f32_16x16x32_bf16 a[68:71], v[108:111], v[88:91], a[68:71]
    v_mfma_f32_16x16x32_bf16 a[88:91], v[108:111], v[92:95], a[88:91]
    v_mfma_f32_16x16x32_bf16 a[108:111], v[108:111], v[96:99], a[108:111]
    buffer_load_dwordx4 v[108:111], v13, s[8:11], s32 offen
    v_mfma_f32_16x16x32_bf16 a[12:15], v[112:115], v[76:79], a[12:15]
    v_mfma_f32_16x16x32_bf16 a[32:35], v[112:115], v[80:83], a[32:35]
    v_mfma_f32_16x16x32_bf16 a[52:55], v[112:115], v[84:87], a[52:55]
    v_mfma_f32_16x16x32_bf16 a[72:75], v[112:115], v[88:91], a[72:75]
    v_mfma_f32_16x16x32_bf16 a[92:95], v[112:115], v[92:95], a[92:95]
    v_mfma_f32_16x16x32_bf16 a[112:115], v[112:115], v[96:99], a[112:115]
    buffer_load_dwordx4 v[112:115], v14, s[8:11], s32 offen
    v_mfma_f32_16x16x32_bf16 a[16:19], v[116:119], v[76:79], a[16:19]
    v_mfma_f32_16x16x32_bf16 a[36:39], v[116:119], v[80:83], a[36:39]
    v_mfma_f32_16x16x32_bf16 a[56:59], v[116:119], v[84:87], a[56:59]
    v_mfma_f32_16x16x32_bf16 a[76:79], v[116:119], v[88:91], a[76:79]
    v_mfma_f32_16x16x32_bf16 a[96:99], v[116:119], v[92:95], a[96:99]
    v_mfma_f32_16x16x32_bf16 a[116:119], v[116:119], v[96:99], a[116:119]
    buffer_load_dwordx4 v[116:119], v15, s[8:11], s32 offen
    buffer_load_dwordx4 v[76:79], v5, s[8:11], s31 offen
    buffer_load_dwordx4 v[80:83], v6, s[8:11], s31 offen
    buffer_load_dwordx4 v[84:87], v7, s[8:11], s31 offen
    buffer_load_dwordx4 v[88:91], v8, s[8:11], s31 offen
    buffer_load_dwordx4 v[92:95], v9, s[8:11], s31 offen
    buffer_load_dwordx4 v[96:99], v10, s[8:11], s31 offen
    s_waitcnt vmcnt(44)
    s_add_u32 s32, s32, 1024
    s_mov_b32 s31, s32
    v_mfma_f32_16x16x32_bf16 a[0:3], v[144:147], v[120:123], a[0:3]
    v_mfma_f32_16x16x32_bf16 a[20:23], v[144:147], v[124:127], a[20:23]
    v_mfma_f32_16x16x32_bf16 a[40:43], v[144:147], v[128:131], a[40:43]
    v_mfma_f32_16x16x32_bf16 a[60:63], v[144:147], v[132:135], a[60:63]
    v_mfma_f32_16x16x32_bf16 a[80:83], v[144:147], v[136:139], a[80:83]
    v_mfma_f32_16x16x32_bf16 a[100:103], v[144:147], v[140:143], a[100:103]
    buffer_load_dwordx4 v[144:147], v11, s[8:11], s32 offen
    v_mfma_f32_16x16x32_bf16 a[4:7], v[148:151], v[120:123], a[4:7]
    v_mfma_f32_16x16x32_bf16 a[24:27], v[148:151], v[124:127], a[24:27]
    v_mfma_f32_16x16x32_bf16 a[44:47], v[148:151], v[128:131], a[44:47]
    v_mfma_f32_16x16x32_bf16 a[64:67], v[148:151], v[132:135], a[64:67]
    v_mfma_f32_16x16x32_bf16 a[84:87], v[148:151], v[136:139], a[84:87]
    v_mfma_f32_16x16x32_bf16 a[104:107], v[148:151], v[140:143], a[104:107]
    buffer_load_dwordx4 v[148:151], v12, s[8:11], s32 offen
    v_mfma_f32_16x16x32_bf16 a[8:11], v[152:155], v[120:123], a[8:11]
    v_mfma_f32_16x16x32_bf16 a[28:31], v[152:155], v[124:127], a[28:31]
    v_mfma_f32_16x16x32_bf16 a[48:51], v[152:155], v[128:131], a[48:51]
    v_mfma_f32_16x16x32_bf16 a[68:71], v[152:155], v[132:135], a[68:71]
    v_mfma_f32_16x16x32_bf16 a[88:91], v[152:155], v[136:139], a[88:91]
    v_mfma_f32_16x16x32_bf16 a[108:111], v[152:155], v[140:143], a[108:111]
    buffer_load_dwordx4 v[152:155], v13, s[8:11], s32 offen
    v_mfma_f32_16x16x32_bf16 a[12:15], v[156:159], v[120:123], a[12:15]
    v_mfma_f32_16x16x32_bf16 a[32:35], v[156:159], v[124:127], a[32:35]
    v_mfma_f32_16x16x32_bf16 a[52:55], v[156:159], v[128:131], a[52:55]
    v_mfma_f32_16x16x32_bf16 a[72:75], v[156:159], v[132:135], a[72:75]
    v_mfma_f32_16x16x32_bf16 a[92:95], v[156:159], v[136:139], a[92:95]
    v_mfma_f32_16x16x32_bf16 a[112:115], v[156:159], v[140:143], a[112:115]
    buffer_load_dwordx4 v[156:159], v14, s[8:11], s32 offen
    v_mfma_f32_16x16x32_bf16 a[16:19], v[160:163], v[120:123], a[16:19]
    v_mfma_f32_16x16x32_bf16 a[36:39], v[160:163], v[124:127], a[36:39]
    v_mfma_f32_16x16x32_bf16 a[56:59], v[160:163], v[128:131], a[56:59]
    v_mfma_f32_16x16x32_bf16 a[76:79], v[160:163], v[132:135], a[76:79]
    v_mfma_f32_16x16x32_bf16 a[96:99], v[160:163], v[136:139], a[96:99]
    v_mfma_f32_16x16x32_bf16 a[116:119], v[160:163], v[140:143], a[116:119]
    buffer_load_dwordx4 v[160:163], v15, s[8:11], s32 offen
    buffer_load_dwordx4 v[120:123], v5, s[8:11], s31 offen
    buffer_load_dwordx4 v[124:127], v6, s[8:11], s31 offen
    buffer_load_dwordx4 v[128:131], v7, s[8:11], s31 offen
    buffer_load_dwordx4 v[132:135], v8, s[8:11], s31 offen
    buffer_load_dwordx4 v[136:139], v9, s[8:11], s31 offen
    buffer_load_dwordx4 v[140:143], v10, s[8:11], s31 offen
    s_waitcnt vmcnt(44)
    s_add_u32 s32, s32, 1024
    s_mov_b32 s31, s32
    v_mfma_f32_16x16x32_bf16 a[0:3], v[188:191], v[164:167], a[0:3]
    v_mfma_f32_16x16x32_bf16 a[20:23], v[188:191], v[168:171], a[20:23]
    v_mfma_f32_16x16x32_bf16 a[40:43], v[188:191], v[172:175], a[40:43]
    v_mfma_f32_16x16x32_bf16 a[60:63], v[188:191], v[176:179], a[60:63]
    v_mfma_f32_16x16x32_bf16 a[80:83], v[188:191], v[180:183], a[80:83]
    v_mfma_f32_16x16x32_bf16 a[100:103], v[188:191], v[184:187], a[100:103]
    buffer_load_dwordx4 v[188:191], v11, s[8:11], s32 offen
    v_mfma_f32_16x16x32_bf16 a[4:7], v[192:195], v[164:167], a[4:7]
    v_mfma_f32_16x16x32_bf16 a[24:27], v[192:195], v[168:171], a[24:27]
    v_mfma_f32_16x16x32_bf16 a[44:47], v[192:195], v[172:175], a[44:47]
    v_mfma_f32_16x16x32_bf16 a[64:67], v[192:195], v[176:179], a[64:67]
    v_mfma_f32_16x16x32_bf16 a[84:87], v[192:195], v[180:183], a[84:87]
    v_mfma_f32_16x16x32_bf16 a[104:107], v[192:195], v[184:187], a[104:107]
    buffer_load_dwordx4 v[192:195], v12, s[8:11], s32 offen
    v_mfma_f32_16x16x32_bf16 a[8:11], v[196:199], v[164:167], a[8:11]
    v_mfma_f32_16x16x32_bf16 a[28:31], v[196:199], v[168:171], a[28:31]
    v_mfma_f32_16x16x32_bf16 a[48:51], v[196:199], v[172:175], a[48:51]
    v_mfma_f32_16x16x32_bf16 a[68:71], v[196:199], v[176:179], a[68:71]
    v_mfma_f32_16x16x32_bf16 a[88:91], v[196:199], v[180:183], a[88:91]
    v_mfma_f32_16x16x32_bf16 a[108:111], v[196:199], v[184:187], a[108:111]
    buffer_load_dwordx4 v[196:199], v13, s[8:11], s32 offen
    v_mfma_f32_16x16x32_bf16 a[12:15], v[200:203], v[164:167], a[12:15]
    v_mfma_f32_16x16x32_bf16 a[32:35], v[200:203], v[168:171], a[32:35]
    v_mfma_f32_16x16x32_bf16 a[52:55], v[200:203], v[172:175], a[52:55]
    v_mfma_f32_16x16x32_bf16 a[72:75], v[200:203], v[176:179], a[72:75]
    v_mfma_f32_16x16x32_bf16 a[92:95], v[200:203], v[180:183], a[92:95]
    v_mfma_f32_16x16x32_bf16 a[112:115], v[200:203], v[184:187], a[112:115]
    buffer_load_dwordx4 v[200:203], v14, s[8:11], s32 offen
    v_mfma_f32_16x16x32_bf16 a[16:19], v[204:207], v[164:167], a[16:19]
    v_mfma_f32_16x16x32_bf16 a[36:39], v[204:207], v[168:171], a[36:39]
    v_mfma_f32_16x16x32_bf16 a[56:59], v[204:207], v[172:175], a[56:59]
    v_mfma_f32_16x16x32_bf16 a[76:79], v[204:207], v[176:179], a[76:79]
    v_mfma_f32_16x16x32_bf16 a[96:99], v[204:207], v[180:183], a[96:99]
    v_mfma_f32_16x16x32_bf16 a[116:119], v[204:207], v[184:187], a[116:119]
    buffer_load_dwordx4 v[204:207], v15, s[8:11], s32 offen
    buffer_load_dwordx4 v[164:167], v5, s[8:11], s31 offen
    buffer_load_dwordx4 v[168:171], v6, s[8:11], s31 offen
    buffer_load_dwordx4 v[172:175], v7, s[8:11], s31 offen
    buffer_load_dwordx4 v[176:179], v8, s[8:11], s31 offen
    buffer_load_dwordx4 v[180:183], v9, s[8:11], s31 offen
    buffer_load_dwordx4 v[184:187], v10, s[8:11], s31 offen
    s_waitcnt vmcnt(44)
    s_mov_b32 s32, s41
    v_mfma_f32_16x16x32_bf16 a[0:3], v[232:235], v[208:211], a[0:3]
    v_mfma_f32_16x16x32_bf16 a[20:23], v[232:235], v[212:215], a[20:23]
    v_mfma_f32_16x16x32_bf16 a[40:43], v[232:235], v[216:219], a[40:43]
    v_mfma_f32_16x16x32_bf16 a[60:63], v[232:235], v[220:223], a[60:63]
    v_mfma_f32_16x16x32_bf16 a[80:83], v[232:235], v[224:227], a[80:83]
    v_mfma_f32_16x16x32_bf16 a[100:103], v[232:235], v[228:231], a[100:103]
    buffer_load_dwordx4 v[232:235], v16, s[12:15], s32 offen
    v_mfma_f32_16x16x32_bf16 a[4:7], v[236:239], v[208:211], a[4:7]
    v_mfma_f32_16x16x32_bf16 a[24:27], v[236:239], v[212:215], a[24:27]
    v_mfma_f32_16x16x32_bf16 a[44:47], v[236:239], v[216:219], a[44:47]
    v_mfma_f32_16x16x32_bf16 a[64:67], v[236:239], v[220:223], a[64:67]
    v_mfma_f32_16x16x32_bf16 a[84:87], v[236:239], v[224:227], a[84:87]
    v_mfma_f32_16x16x32_bf16 a[104:107], v[236:239], v[228:231], a[104:107]
    buffer_load_dwordx4 v[236:239], v17, s[12:15], s32 offen
    v_mfma_f32_16x16x32_bf16 a[8:11], v[240:243], v[208:211], a[8:11]
    v_mfma_f32_16x16x32_bf16 a[28:31], v[240:243], v[212:215], a[28:31]
    v_mfma_f32_16x16x32_bf16 a[48:51], v[240:243], v[216:219], a[48:51]
    v_mfma_f32_16x16x32_bf16 a[68:71], v[240:243], v[220:223], a[68:71]
    v_mfma_f32_16x16x32_bf16 a[88:91], v[240:243], v[224:227], a[88:91]
    v_mfma_f32_16x16x32_bf16 a[108:111], v[240:243], v[228:231], a[108:111]
    buffer_load_dwordx4 v[240:243], v18, s[12:15], s32 offen
    v_mfma_f32_16x16x32_bf16 a[12:15], v[244:247], v[208:211], a[12:15]
    v_mfma_f32_16x16x32_bf16 a[32:35], v[244:247], v[212:215], a[32:35]
    v_mfma_f32_16x16x32_bf16 a[52:55], v[244:247], v[216:219], a[52:55]
    v_mfma_f32_16x16x32_bf16 a[72:75], v[244:247], v[220:223], a[72:75]
    v_mfma_f32_16x16x32_bf16 a[92:95], v[244:247], v[224:227], a[92:95]
    v_mfma_f32_16x16x32_bf16 a[112:115], v[244:247], v[228:231], a[112:115]
    buffer_load_dwordx4 v[244:247], v19, s[12:15], s32 offen
    v_mfma_f32_16x16x32_bf16 a[16:19], v[248:251], v[208:211], a[16:19]
    v_mfma_f32_16x16x32_bf16 a[36:39], v[248:251], v[212:215], a[36:39]
    v_mfma_f32_16x16x32_bf16 a[56:59], v[248:251], v[216:219], a[56:59]
    v_mfma_f32_16x16x32_bf16 a[76:79], v[248:251], v[220:223], a[76:79]
    v_mfma_f32_16x16x32_bf16 a[96:99], v[248:251], v[224:227], a[96:99]
    v_mfma_f32_16x16x32_bf16 a[116:119], v[248:251], v[228:231], a[116:119]
    buffer_load_dwordx4 v[248:251], v20, s[12:15], s32 offen
    s_waitcnt vmcnt(38)
    s_add_u32 s32, s32, 1024
    v_mfma_f32_16x16x32_bf16 a[0:3], v[56:59], v[32:35], a[0:3]
    v_mfma_f32_16x16x32_bf16 a[20:23], v[56:59], v[36:39], a[20:23]
    v_mfma_f32_16x16x32_bf16 a[40:43], v[56:59], v[40:43], a[40:43]
    v_mfma_f32_16x16x32_bf16 a[60:63], v[56:59], v[44:47], a[60:63]
    v_mfma_f32_16x16x32_bf16 a[80:83], v[56:59], v[48:51], a[80:83]
    v_mfma_f32_16x16x32_bf16 a[100:103], v[56:59], v[52:55], a[100:103]
    buffer_load_dwordx4 v[56:59], v16, s[12:15], s32 offen
    v_mfma_f32_16x16x32_bf16 a[4:7], v[60:63], v[32:35], a[4:7]
    v_mfma_f32_16x16x32_bf16 a[24:27], v[60:63], v[36:39], a[24:27]
    v_mfma_f32_16x16x32_bf16 a[44:47], v[60:63], v[40:43], a[44:47]
    v_mfma_f32_16x16x32_bf16 a[64:67], v[60:63], v[44:47], a[64:67]
    v_mfma_f32_16x16x32_bf16 a[84:87], v[60:63], v[48:51], a[84:87]
    v_mfma_f32_16x16x32_bf16 a[104:107], v[60:63], v[52:55], a[104:107]
    buffer_load_dwordx4 v[60:63], v17, s[12:15], s32 offen
    v_mfma_f32_16x16x32_bf16 a[8:11], v[64:67], v[32:35], a[8:11]
    v_mfma_f32_16x16x32_bf16 a[28:31], v[64:67], v[36:39], a[28:31]
    v_mfma_f32_16x16x32_bf16 a[48:51], v[64:67], v[40:43], a[48:51]
    v_mfma_f32_16x16x32_bf16 a[68:71], v[64:67], v[44:47], a[68:71]
    v_mfma_f32_16x16x32_bf16 a[88:91], v[64:67], v[48:51], a[88:91]
    v_mfma_f32_16x16x32_bf16 a[108:111], v[64:67], v[52:55], a[108:111]
    buffer_load_dwordx4 v[64:67], v18, s[12:15], s32 offen
    v_mfma_f32_16x16x32_bf16 a[12:15], v[68:71], v[32:35], a[12:15]
    v_mfma_f32_16x16x32_bf16 a[32:35], v[68:71], v[36:39], a[32:35]
    v_mfma_f32_16x16x32_bf16 a[52:55], v[68:71], v[40:43], a[52:55]
    v_mfma_f32_16x16x32_bf16 a[72:75], v[68:71], v[44:47], a[72:75]
    v_mfma_f32_16x16x32_bf16 a[92:95], v[68:71], v[48:51], a[92:95]
    v_mfma_f32_16x16x32_bf16 a[112:115], v[68:71], v[52:55], a[112:115]
    buffer_load_dwordx4 v[68:71], v19, s[12:15], s32 offen
    v_mfma_f32_16x16x32_bf16 a[16:19], v[72:75], v[32:35], a[16:19]
    v_mfma_f32_16x16x32_bf16 a[36:39], v[72:75], v[36:39], a[36:39]
    v_mfma_f32_16x16x32_bf16 a[56:59], v[72:75], v[40:43], a[56:59]
    v_mfma_f32_16x16x32_bf16 a[76:79], v[72:75], v[44:47], a[76:79]
    v_mfma_f32_16x16x32_bf16 a[96:99], v[72:75], v[48:51], a[96:99]
    v_mfma_f32_16x16x32_bf16 a[116:119], v[72:75], v[52:55], a[116:119]
    buffer_load_dwordx4 v[72:75], v20, s[12:15], s32 offen
    s_waitcnt vmcnt(32)
    s_add_u32 s32, s32, 1024
    v_mfma_f32_16x16x32_bf16 a[0:3], v[100:103], v[76:79], a[0:3]
    v_mfma_f32_16x16x32_bf16 a[20:23], v[100:103], v[80:83], a[20:23]
    v_mfma_f32_16x16x32_bf16 a[40:43], v[100:103], v[84:87], a[40:43]
    v_mfma_f32_16x16x32_bf16 a[60:63], v[100:103], v[88:91], a[60:63]
    v_mfma_f32_16x16x32_bf16 a[80:83], v[100:103], v[92:95], a[80:83]
    v_mfma_f32_16x16x32_bf16 a[100:103], v[100:103], v[96:99], a[100:103]
    buffer_load_dwordx4 v[100:103], v16, s[12:15], s32 offen
    v_mfma_f32_16x16x32_bf16 a[4:7], v[104:107], v[76:79], a[4:7]
    v_mfma_f32_16x16x32_bf16 a[24:27], v[104:107], v[80:83], a[24:27]
    v_mfma_f32_16x16x32_bf16 a[44:47], v[104:107], v[84:87], a[44:47]
    v_mfma_f32_16x16x32_bf16 a[64:67], v[104:107], v[88:91], a[64:67]
    v_mfma_f32_16x16x32_bf16 a[84:87], v[104:107], v[92:95], a[84:87]
    v_mfma_f32_16x16x32_bf16 a[104:107], v[104:107], v[96:99], a[104:107]
    buffer_load_dwordx4 v[104:107], v17, s[12:15], s32 offen
    v_mfma_f32_16x16x32_bf16 a[8:11], v[108:111], v[76:79], a[8:11]
    v_mfma_f32_16x16x32_bf16 a[28:31], v[108:111], v[80:83], a[28:31]
    v_mfma_f32_16x16x32_bf16 a[48:51], v[108:111], v[84:87], a[48:51]
    v_mfma_f32_16x16x32_bf16 a[68:71], v[108:111], v[88:91], a[68:71]
    v_mfma_f32_16x16x32_bf16 a[88:91], v[108:111], v[92:95], a[88:91]
    v_mfma_f32_16x16x32_bf16 a[108:111], v[108:111], v[96:99], a[108:111]
    buffer_load_dwordx4 v[108:111], v18, s[12:15], s32 offen
    v_mfma_f32_16x16x32_bf16 a[12:15], v[112:115], v[76:79], a[12:15]
    v_mfma_f32_16x16x32_bf16 a[32:35], v[112:115], v[80:83], a[32:35]
    v_mfma_f32_16x16x32_bf16 a[52:55], v[112:115], v[84:87], a[52:55]
    v_mfma_f32_16x16x32_bf16 a[72:75], v[112:115], v[88:91], a[72:75]
    v_mfma_f32_16x16x32_bf16 a[92:95], v[112:115], v[92:95], a[92:95]
    v_mfma_f32_16x16x32_bf16 a[112:115], v[112:115], v[96:99], a[112:115]
    buffer_load_dwordx4 v[112:115], v19, s[12:15], s32 offen
    v_mfma_f32_16x16x32_bf16 a[16:19], v[116:119], v[76:79], a[16:19]
    v_mfma_f32_16x16x32_bf16 a[36:39], v[116:119], v[80:83], a[36:39]
    v_mfma_f32_16x16x32_bf16 a[56:59], v[116:119], v[84:87], a[56:59]
    v_mfma_f32_16x16x32_bf16 a[76:79], v[116:119], v[88:91], a[76:79]
    v_mfma_f32_16x16x32_bf16 a[96:99], v[116:119], v[92:95], a[96:99]
    v_mfma_f32_16x16x32_bf16 a[116:119], v[116:119], v[96:99], a[116:119]
    buffer_load_dwordx4 v[116:119], v20, s[12:15], s32 offen
    s_waitcnt vmcnt(26)
    buffer_load_dword v25, v0, s[8:11], 0 offen sc1
    s_add_u32 s32, s32, 1024
    v_mfma_f32_16x16x32_bf16 a[0:3], v[144:147], v[120:123], a[0:3]
    v_mfma_f32_16x16x32_bf16 a[20:23], v[144:147], v[124:127], a[20:23]
    v_mfma_f32_16x16x32_bf16 a[40:43], v[144:147], v[128:131], a[40:43]
    v_mfma_f32_16x16x32_bf16 a[60:63], v[144:147], v[132:135], a[60:63]
    v_mfma_f32_16x16x32_bf16 a[80:83], v[144:147], v[136:139], a[80:83]
    v_mfma_f32_16x16x32_bf16 a[100:103], v[144:147], v[140:143], a[100:103]
    buffer_load_dwordx4 v[144:147], v16, s[12:15], s32 offen
    v_mfma_f32_16x16x32_bf16 a[4:7], v[148:151], v[120:123], a[4:7]
    v_mfma_f32_16x16x32_bf16 a[24:27], v[148:151], v[124:127], a[24:27]
    v_mfma_f32_16x16x32_bf16 a[44:47], v[148:151], v[128:131], a[44:47]
    v_mfma_f32_16x16x32_bf16 a[64:67], v[148:151], v[132:135], a[64:67]
    v_mfma_f32_16x16x32_bf16 a[84:87], v[148:151], v[136:139], a[84:87]
    v_mfma_f32_16x16x32_bf16 a[104:107], v[148:151], v[140:143], a[104:107]
    buffer_load_dwordx4 v[148:151], v17, s[12:15], s32 offen
    v_mfma_f32_16x16x32_bf16 a[8:11], v[152:155], v[120:123], a[8:11]
    v_mfma_f32_16x16x32_bf16 a[28:31], v[152:155], v[124:127], a[28:31]
    v_mfma_f32_16x16x32_bf16 a[48:51], v[152:155], v[128:131], a[48:51]
    v_mfma_f32_16x16x32_bf16 a[68:71], v[152:155], v[132:135], a[68:71]
    v_mfma_f32_16x16x32_bf16 a[88:91], v[152:155], v[136:139], a[88:91]
    v_mfma_f32_16x16x32_bf16 a[108:111], v[152:155], v[140:143], a[108:111]
    buffer_load_dwordx4 v[152:155], v18, s[12:15], s32 offen
    v_mfma_f32_16x16x32_bf16 a[12:15], v[156:159], v[120:123], a[12:15]
    v_mfma_f32_16x16x32_bf16 a[32:35], v[156:159], v[124:127], a[32:35]
    v_mfma_f32_16x16x32_bf16 a[52:55], v[156:159], v[128:131], a[52:55]
    v_mfma_f32_16x16x32_bf16 a[72:75], v[156:159], v[132:135], a[72:75]
    v_mfma_f32_16x16x32_bf16 a[92:95], v[156:159], v[136:139], a[92:95]
    v_mfma_f32_16x16x32_bf16 a[112:115], v[156:159], v[140:143], a[112:115]
    buffer_load_dwordx4 v[156:159], v19, s[12:15], s32 offen
    v_mfma_f32_16x16x32_bf16 a[16:19], v[160:163], v[120:123], a[16:19]
    v_mfma_f32_16x16x32_bf16 a[36:39], v[160:163], v[124:127], a[36:39]
    v_mfma_f32_16x16x32_bf16 a[56:59], v[160:163], v[128:131], a[56:59]
    v_mfma_f32_16x16x32_bf16 a[76:79], v[160:163], v[132:135], a[76:79]
    v_mfma_f32_16x16x32_bf16 a[96:99], v[160:163], v[136:139], a[96:99]
    v_mfma_f32_16x16x32_bf16 a[116:119], v[160:163], v[140:143], a[116:119]
    buffer_load_dwordx4 v[160:163], v20, s[12:15], s32 offen
    s_waitcnt vmcnt(21)
    s_add_u32 s32, s32, 1024
    v_mfma_f32_16x16x32_bf16 a[0:3], v[188:191], v[164:167], a[0:3]
    v_mfma_f32_16x16x32_bf16 a[20:23], v[188:191], v[168:171], a[20:23]
    v_mfma_f32_16x16x32_bf16 a[40:43], v[188:191], v[172:175], a[40:43]
    v_mfma_f32_16x16x32_bf16 a[60:63], v[188:191], v[176:179], a[60:63]
    v_mfma_f32_16x16x32_bf16 a[80:83], v[188:191], v[180:183], a[80:83]
    v_mfma_f32_16x16x32_bf16 a[100:103], v[188:191], v[184:187], a[100:103]
    buffer_load_dwordx4 v[188:191], v16, s[12:15], s32 offen
    v_mfma_f32_16x16x32_bf16 a[4:7], v[192:195], v[164:167], a[4:7]
    v_mfma_f32_16x16x32_bf16 a[24:27], v[192:195], v[168:171], a[24:27]
    v_mfma_f32_16x16x32_bf16 a[44:47], v[192:195], v[172:175], a[44:47]
    v_mfma_f32_16x16x32_bf16 a[64:67], v[192:195], v[176:179], a[64:67]
    v_mfma_f32_16x16x32_bf16 a[84:87], v[192:195], v[180:183], a[84:87]
    v_mfma_f32_16x16x32_bf16 a[104:107], v[192:195], v[184:187], a[104:107]
    buffer_load_dwordx4 v[192:195], v17, s[12:15], s32 offen
    v_mfma_f32_16x16x32_bf16 a[8:11], v[196:199], v[164:167], a[8:11]
    v_mfma_f32_16x16x32_bf16 a[28:31], v[196:199], v[168:171], a[28:31]
    v_mfma_f32_16x16x32_bf16 a[48:51], v[196:199], v[172:175], a[48:51]
    v_mfma_f32_16x16x32_bf16 a[68:71], v[196:199], v[176:179], a[68:71]
    v_mfma_f32_16x16x32_bf16 a[88:91], v[196:199], v[180:183], a[88:91]
    v_mfma_f32_16x16x32_bf16 a[108:111], v[196:199], v[184:187], a[108:111]
    buffer_load_dwordx4 v[196:199], v18, s[12:15], s32 offen
    v_mfma_f32_16x16x32_bf16 a[12:15], v[200:203], v[164:167], a[12:15]
    v_mfma_f32_16x16x32_bf16 a[32:35], v[200:203], v[168:171], a[32:35]
    v_mfma_f32_16x16x32_bf16 a[52:55], v[200:203], v[172:175], a[52:55]
    v_mfma_f32_16x16x32_bf16 a[72:75], v[200:203], v[176:179], a[72:75]
    v_mfma_f32_16x16x32_bf16 a[92:95], v[200:203], v[180:183], a[92:95]
    v_mfma_f32_16x16x32_bf16 a[112:115], v[200:203], v[184:187], a[112:115]
    buffer_load_dwordx4 v[200:203], v19, s[12:15], s32 offen
    v_mfma_f32_16x16x32_bf16 a[16:19], v[204:207], v[164:167], a[16:19]
    v_mfma_f32_16x16x32_bf16 a[36:39], v[204:207], v[168:171], a[36:39]
    v_mfma_f32_16x16x32_bf16 a[56:59], v[204:207], v[172:175], a[56:59]
    v_mfma_f32_16x16x32_bf16 a[76:79], v[204:207], v[176:179], a[76:79]
    v_mfma_f32_16x16x32_bf16 a[96:99], v[204:207], v[180:183], a[96:99]
    v_mfma_f32_16x16x32_bf16 a[116:119], v[204:207], v[184:187], a[116:119]
    buffer_load_dwordx4 v[204:207], v20, s[12:15], s32 offen
    s_cmp_ge_u32 s28, 2
    s_cselect_b32 s34, 1, 0
    s_add_u32 s34, s34, s28
    s_mul_i32 s42, s29, 6
    s_add_u32 s42, s42, s34
    s_add_u32 s42, s42, 0
    s_lshl_b32 s43, s42, 4
    v_lshrrev_b32 v2, 2, v1
    v_add_u32 v2, s43, v2
    v_bfe_u32 v3, v2, 9, 1
    v_lshlrev_b32 v3, 4, v3
    v_bfe_u32 v4, v2, 2, 1
    v_lshlrev_b32 v4, 3, v4
    v_add_u32 v3, v3, v4
    v_bfe_u32 v4, v2, 8, 1
    v_lshlrev_b32 v4, 2, v4
    v_add_u32 v3, v3, v4
    v_and_b32 v4, 3, v2
    v_add_u32 v3, v3, v4
    v_lshlrev_b32 v3, 6, v3
    v_bfe_u32 v4, v2, 10, 1
    v_lshlrev_b32 v4, 5, v4
    v_add_u32 v3, v3, v4
    v_bfe_u32 v4, v2, 3, 5
    v_add_u32 v3, v3, v4
    v_mul_u32_u24 v3, 1280, v3
    s_mul_i32 s43, s30, 160
    v_and_b32 v4, 3, v1
    v_lshlrev_b32 v4, 3, v4
    v_add_u32 v3, v3, v4
    v_add_u32 v22, s43, v3
    s_cmp_lt_u32 s42, 128
    s_cselect_b32 s43, 0, 0x7f000000
    v_add_u32 v22, s43, v22
    s_mul_i32 s42, s29, 6
    s_add_u32 s42, s42, s34
    s_add_u32 s42, s42, 1
    s_lshl_b32 s43, s42, 4
    v_lshrrev_b32 v2, 2, v1
    v_add_u32 v2, s43, v2
    v_bfe_u32 v3, v2, 9, 1
    v_lshlrev_b32 v3, 4, v3
    v_bfe_u32 v4, v2, 2, 1
    v_lshlrev_b32 v4, 3, v4
    v_add_u32 v3, v3, v4
    v_bfe_u32 v4, v2, 8, 1
    v_lshlrev_b32 v4, 2, v4
    v_add_u32 v3, v3, v4
    v_and_b32 v4, 3, v2
    v_add_u32 v3, v3, v4
    v_lshlrev_b32 v3, 6, v3
    v_bfe_u32 v4, v2, 10, 1
    v_lshlrev_b32 v4, 5, v4
    v_add_u32 v3, v3, v4
    v_bfe_u32 v4, v2, 3, 5
    v_add_u32 v3, v3, v4
    v_mul_u32_u24 v3, 1280, v3
    s_mul_i32 s43, s30, 160
    v_and_b32 v4, 3, v1
    v_lshlrev_b32 v4, 3, v4
    v_add_u32 v3, v3, v4
    v_add_u32 v23, s43, v3
    s_cmp_lt_u32 s42, 128
    s_cselect_b32 s43, 0, 0x7f000000
    v_add_u32 v23, s43, v23
    s_mul_i32 s42, s29, 6
    s_add_u32 s42, s42, s34
    s_add_u32 s42, s42, 2
    s_lshl_b32 s43, s42, 4
    v_lshrrev_b32 v2, 2, v1
    v_add_u32 v2, s43, v2
    v_bfe_u32 v3, v2, 9, 1
    v_lshlrev_b32 v3, 4, v3
    v_bfe_u32 v4, v2, 2, 1
    v_lshlrev_b32 v4, 3, v4
    v_add_u32 v3, v3, v4
    v_bfe_u32 v4, v2, 8, 1
    v_lshlrev_b32 v4, 2, v4
    v_add_u32 v3, v3, v4
    v_and_b32 v4, 3, v2
    v_add_u32 v3, v3, v4
    v_lshlrev_b32 v3, 6, v3
    v_bfe_u32 v4, v2, 10, 1
    v_lshlrev_b32 v4, 5, v4
    v_add_u32 v3, v3, v4
    v_bfe_u32 v4, v2, 3, 5
    v_add_u32 v3, v3, v4
    v_mul_u32_u24 v3, 1280, v3
    s_mul_i32 s43, s30, 160
    v_and_b32 v4, 3, v1
    v_lshlrev_b32 v4, 3, v4
    v_add_u32 v3, v3, v4
    v_add_u32 v24, s43, v3
    s_cmp_lt_u32 s42, 128
    s_cselect_b32 s43, 0, 0x7f000000
    v_add_u32 v24, s43, v24
    v_and_b32 v2, 15, v1
    v_lshrrev_b32 v3, 4, v1
    v_bfe_u32 v4, v2, 1, 2
    v_xor_b32 v3, v3, v4
    v_lshlrev_b32 v2, 2, v2
    v_add_u32 v28, v2, v3
    v_lshlrev_b32 v28, 4, v28
    s_lshl_b32 s42, s28, 13
    v_add_u32 v28, s42, v28
    v_add_u32 v30, 65536, v28
    v_lshrrev_b32 v2, 2, v1
    v_and_b32 v3, 3, v1
    v_bfe_u32 v4, v2, 1, 2
    v_xor_b32 v3, v3, v4
    v_lshlrev_b32 v2, 2, v2
    v_add_u32 v29, v2, v3
    v_lshlrev_b32 v29, 4, v29
    s_lshl_b32 s42, s28, 15
    v_add_u32 v29, s42, v29
    s_waitcnt vmcnt(10)
    s_mov_b32 s42, 0
L_kg_polla:
    v_readfirstlane_b32 s44, v25
    s_nop 0
    s_cmp_ge_u32 s44, 20
    s_cbranch_scc1 L_kg_goa
    s_add_u32 s42, s42, 1
    s_cmp_ge_u32 s42, 65536
    s_cbranch_scc1 L_kg_goa
    s_sleep 2
    buffer_load_dword v25, v0, s[8:11], 0 offen sc1
    s_waitcnt vmcnt(0)
    s_branch L_kg_polla
L_kg_goa:
    s_add_u32 s31, s41, 55296
    buffer_load_dwordx4 v[208:211], v5, s[8:11], s31 offen sc1
    buffer_load_dwordx4 v[212:215], v6, s[8:11], s31 offen sc1
    buffer_load_dwordx4 v[216:219], v7, s[8:11], s31 offen sc1
    buffer_load_dwordx4 v[220:223], v8, s[8:11], s31 offen sc1
    buffer_load_dwordx4 v[224:227], v9, s[8:11], s31 offen sc1
    buffer_load_dwordx4 v[228:231], v10, s[8:11], s31 offen sc1
    s_add_u32 s31, s31, 1024
    buffer_load_dwordx4 v[32:35], v5, s[8:11], s31 offen sc1
    buffer_load_dwordx4 v[36:39], v6, s[8:11], s31 offen sc1
    buffer_load_dwordx4 v[40:43], v7, s[8:11], s31 offen sc1
    buffer_load_dwordx4 v[44:47], v8, s[8:11], s31 offen sc1
    buffer_load_dwordx4 v[48:51], v9, s[8:11], s31 offen sc1
    buffer_load_dwordx4 v[52:55], v10, s[8:11], s31 offen sc1
    s_add_u32 s31, s31, 1024
    buffer_load_dwordx4 v[76:79], v5, s[8:11], s31 offen sc1
    buffer_load_dwordx4 v[80:83], v6, s[8:11], s31 offen sc1
    buffer_load_dwordx4 v[84:87], v7, s[8:11], s31 offen sc1
    buffer_load_dwordx4 v[88:91], v8, s[8:11], s31 offen sc1
    buffer_load_dwordx4 v[92:95], v9, s[8:11], s31 offen sc1
    buffer_load_dwordx4 v[96:99], v10, s[8:11], s31 offen sc1
    s_add_u32 s31, s31, 1024
    buffer_load_dwordx4 v[120:123], v5, s[8:11], s31 offen sc1
    buffer_load_dwordx4 v[124:127], v6, s[8:11], s31 offen sc1
    buffer_load_dwordx4 v[128:131], v7, s[8:11], s31 offen sc1
    buffer_load_dwordx4 v[132:135], v8, s[8:11], s31 offen sc1
    buffer_load_dwordx4 v[136:139], v9, s[8:11], s31 offen sc1
    buffer_load_dwordx4 v[140:143], v10, s[8:11], s31 offen sc1
    s_add_u32 s31, s31, 1024
    buffer_load_dwordx4 v[164:167], v5, s[8:11], s31 offen sc1
    buffer_load_dwordx4 v[168:171], v6, s[8:11], s31 offen sc1
    buffer_load_dwordx4 v[172:175], v7, s[8:11], s31 offen sc1
    buffer_load_dwordx4 v[176:179], v8, s[8:11], s31 offen sc1
    buffer_load_dwordx4 v[180:183], v9, s[8:11], s31 offen sc1
    buffer_load_dwordx4 v[184:187], v10, s[8:11], s31 offen sc1
    s_waitcnt vmcnt(24)
    v_mfma_f32_16x16x32_bf16 a[0:3], v[232:235], v[208:211], a[0:3]
    v_mfma_f32_16x16x32_bf16 a[20:23], v[232:235], v[212:215], a[20:23]
    v_mfma_f32_16x16x32_bf16 a[40:43], v[232:235], v[216:219], a[40:43]
    v_mfma_f32_16x16x32_bf16 a[60:63], v[232:235], v[220:223], a[60:63]
    v_mfma_f32_16x16x32_bf16 a[80:83], v[232:235], v[224:227], a[80:83]
    v_mfma_f32_16x16x32_bf16 a[100:103], v[232:235], v[228:231], a[100:103]
    v_mfma_f32_16x16x32_bf16 a[4:7], v[236:239], v[208:211], a[4:7]
    v_mfma_f32_16x16x32_bf16 a[24:27], v[236:239], v[212:215], a[24:27]
    v_mfma_f32_16x16x32_bf16 a[44:47], v[236:239], v[216:219], a[44:47]
    v_mfma_f32_16x16x32_bf16 a[64:67], v[236:239], v[220:223], a[64:67]
    v_mfma_f32_16x16x32_bf16 a[84:87], v[236:239], v[224:227], a[84:87]
    v_mfma_f32_16x16x32_bf16 a[104:107], v[236:239], v[228:231], a[104:107]
    v_mfma_f32_16x16x32_bf16 a[8:11], v[240:243], v[208:211], a[8:11]
    v_mfma_f32_16x16x32_bf16 a[28:31], v[240:243], v[212:215], a[28:31]
    v_mfma_f32_16x16x32_bf16 a[48:51], v[240:243], v[216:219], a[48:51]
    v_mfma_f32_16x16x32_bf16 a[68:71], v[240:243], v[220:223], a[68:71]
    v_mfma_f32_16x16x32_bf16 a[88:91], v[240:243], v[224:227], a[88:91]
    v_mfma_f32_16x16x32_bf16 a[108:111], v[240:243], v[228:231], a[108:111]
    v_mfma_f32_16x16x32_bf16 a[12:15], v[244:247], v[208:211], a[12:15]
    v_mfma_f32_16x16x32_bf16 a[32:35], v[244:247], v[212:215], a[32:35]
    v_mfma_f32_16x16x32_bf16 a[52:55], v[244:247], v[216:219], a[52:55]
    v_mfma_f32_16x16x32_bf16 a[72:75], v[244:247], v[220:223], a[72:75]
    v_mfma_f32_16x16x32_bf16 a[92:95], v[244:247], v[224:227], a[92:95]
    v_mfma_f32_16x16x32_bf16 a[112:115], v[244:247], v[228:231], a[112:115]
    v_mfma_f32_16x16x32_bf16 a[16:19], v[248:251], v[208:211], a[16:19]
    v_mfma_f32_16x16x32_bf16 a[36:39], v[248:251], v[212:215], a[36:39]
    v_mfma_f32_16x16x32_bf16 a[56:59], v[248:251], v[216:219], a[56:59]
    v_mfma_f32_16x16x32_bf16 a[76:79], v[248:251], v[220:223], a[76:79]
    v_mfma_f32_16x16x32_bf16 a[96:99], v[248:251], v[224:227], a[96:99]
    v_mfma_f32_16x16x32_bf16 a[116:119], v[248:251], v[228:231], a[116:119]
    s_waitcnt vmcnt(18)
    v_mfma_f32_16x16x32_bf16 a[0:3], v[56:59], v[32:35], a[0:3]
    v_mfma_f32_16x16x32_bf16 a[20:23], v[56:59], v[36:39], a[20:23]
    v_mfma_f32_16x16x32_bf16 a[40:43], v[56:59], v[40:43], a[40:43]
    v_mfma_f32_16x16x32_bf16 a[60:63], v[56:59], v[44:47], a[60:63]
    v_mfma_f32_16x16x32_bf16 a[80:83], v[56:59], v[48:51], a[80:83]
    v_mfma_f32_16x16x32_bf16 a[100:103], v[56:59], v[52:55], a[100:103]
    v_mfma_f32_16x16x32_bf16 a[4:7], v[60:63], v[32:35], a[4:7]
    v_mfma_f32_16x16x32_bf16 a[24:27], v[60:63], v[36:39], a[24:27]
    v_mfma_f32_16x16x32_bf16 a[44:47], v[60:63], v[40:43], a[44:47]
    v_mfma_f32_16x16x32_bf16 a[64:67], v[60:63], v[44:47], a[64:67]
    v_mfma_f32_16x16x32_bf16 a[84:87], v[60:63], v[48:51], a[84:87]
    v_mfma_f32_16x16x32_bf16 a[104:107], v[60:63], v[52:55], a[104:107]
    v_mfma_f32_16x16x32_bf16 a[8:11], v[64:67], v[32:35], a[8:11]
    v_mfma_f32_16x16x32_bf16 a[28:31], v[64:67], v[36:39], a[28:31]
    v_mfma_f32_16x16x32_bf16 a[48:51], v[64:67], v[40:43], a[48:51]
    v_mfma_f32_16x16x32_bf16 a[68:71], v[64:67], v[44:47], a[68:71]
    v_mfma_f32_16x16x32_bf16 a[88:91], v[64:67], v[48:51], a[88:91]
    v_mfma_f32_16x16x32_bf16 a[108:111], v[64:67], v[52:55], a[108:111]
    v_mfma_f32_16x16x32_bf16 a[12:15], v[68:71], v[32:35], a[12:15]
    v_mfma_f32_16x16x32_bf16 a[32:35], v[68:71], v[36:39], a[32:35]
    v_mfma_f32_16x16x32_bf16 a[52:55], v[68:71], v[40:43], a[52:55]
    v_mfma_f32_16x16x32_bf16 a[72:75], v[68:71], v[44:47], a[72:75]
    v_mfma_f32_16x16x32_bf16 a[92:95], v[68:71], v[48:51], a[92:95]
    v_mfma_f32_16x16x32_bf16 a[112:115], v[68:71], v[52:55], a[112:115]
    v_mfma_f32_16x16x32_bf16 a[16:19], v[72:75], v[32:35], a[16:19]
    v_mfma_f32_16x16x32_bf16 a[36:39], v[72:75], v[36:39], a[36:39]
    v_mfma_f32_16x16x32_bf16 a[56:59], v[72:75], v[40:43], a[56:59]
    v_mfma_f32_16x16x32_bf16 a[76:79], v[72:75], v[44:47], a[76:79]
    v_mfma_f32_16x16x32_bf16 a[96:99], v[72:75], v[48:51], a[96:99]
    v_mfma_f32_16x16x32_bf16 a[116:119], v[72:75], v[52:55], a[116:119]
    s_cmp_eq_u32 s28, 0
    s_cbranch_scc0 L_kg_x1a
    buffer_load_dwordx2 v[208:209], v22, s[16:19], 0 offen offset:0
    buffer_load_dwordx2 v[210:211], v22, s[16:19], 0 offen offset:32
    buffer_load_dwordx2 v[212:213], v22, s[16:19], 0 offen offset:64
    buffer_load_dwordx2 v[214:215], v22, s[16:19], 0 offen offset:96
    buffer_load_dwordx2 v[216:217], v22, s[16:19], 0 offen offset:128
    buffer_load_dwordx2 v[218:219], v23, s[16:19], 0 offen offset:0
    buffer_load_dwordx2 v[220:221], v23, s[16:19], 0 offen offset:32
    buffer_load_dwordx2 v[222:223], v23, s[16:19], 0 offen offset:64
    s_branch L_kg_x2a
L_kg_x1a:
    buffer_load_dwordx2 v[208:209], v22, s[16:19], 0 offen offset:96
    buffer_load_dwordx2 v[210:211], v22, s[16:19], 0 offen offset:128
    buffer_load_dwordx2 v[212:213], v23, s[16:19], 0 offen offset:0
    buffer_load_dwordx2 v[214:215], v23, s[16:19], 0 offen offset:32
    buffer_load_dwordx2 v[216:217], v23, s[16:19], 0 offen offset:64
    buffer_load_dwordx2 v[218:219], v23, s[16:19], 0 offen offset:96
    buffer_load_dwordx2 v[220:221], v23, s[16:19], 0 offen offset:128
    buffer_load_dwordx2 v[222:223], v24, s[16:19], 0 offen offset:0
L_kg_x2a:
    s_waitcnt vmcnt(20)
    v_mfma_f32_16x16x32_bf16 a[0:3], v[100:103], v[76:79], a[0:3]
    v_mfma_f32_16x16x32_bf16 a[20:23], v[100:103], v[80:83], a[20:23]
    v_mfma_f32_16x16x32_bf16 a[40:43], v[100:103], v[84:87], a[40:43]
    v_mfma_f32_16x16x32_bf16 a[60:63], v[100:103], v[88:91], a[60:63]
    v_mfma_f32_16x16x32_bf16 a[80:83], v[100:103], v[92:95], a[80:83]
    v_mfma_f32_16x16x32_bf16 a[100:103], v[100:103], v[96:99], a[100:103]
    v_mfma_f32_16x16x32_bf16 a[4:7], v[104:107], v[76:79], a[4:7]
    v_mfma_f32_16x16x32_bf16 a[24:27], v[104:107], v[80:83], a[24:27]
    v_mfma_f32_16x16x32_bf16 a[44:47], v[104:107], v[84:87], a[44:47]
    v_mfma_f32_16x16x32_bf16 a[64:67], v[104:107], v[88:91], a[64:67]
    v_mfma_f32_16x16x32_bf16 a[84:87], v[104:107], v[92:95], a[84:87]
    v_mfma_f32_16x16x32_bf16 a[104:107], v[104:107], v[96:99], a[104:107]
    v_mfma_f32_16x16x32_bf16 a[8:11], v[108:111], v[76:79], a[8:11]
    v_mfma_f32_16x16x32_bf16 a[28:31], v[108:111], v[80:83], a[28:31]
    v_mfma_f32_16x16x32_bf16 a[48:51], v[108:111], v[84:87], a[48:51]
    v_mfma_f32_16x16x32_bf16 a[68:71], v[108:111], v[88:91], a[68:71]
    v_mfma_f32_16x16x32_bf16 a[88:91], v[108:111], v[92:95], a[88:91]
    v_mfma_f32_16x16x32_bf16 a[108:111], v[108:111], v[96:99], a[108:111]
    v_mfma_f32_16x16x32_bf16 a[12:15], v[112:115], v[76:79], a[12:15]
    v_mfma_f32_16x16x32_bf16 a[32:35], v[112:115], v[80:83], a[32:35]
    v_mfma_f32_16x16x32_bf16 a[52:55], v[112:115], v[84:87], a[52:55]
    v_mfma_f32_16x16x32_bf16 a[72:75], v[112:115], v[88:91], a[72:75]
    v_mfma_f32_16x16x32_bf16 a[92:95], v[112:115], v[92:95], a[92:95]
    v_mfma_f32_16x16x32_bf16 a[112:115], v[112:115], v[96:99], a[112:115]
    v_mfma_f32_16x16x32_bf16 a[16:19], v[116:119], v[76:79], a[16:19]
    v_mfma_f32_16x16x32_bf16 a[36:39], v[116:119], v[80:83], a[36:39]
    v_mfma_f32_16x16x32_bf16 a[56:59], v[116:119], v[84:87], a[56:59]
    v_mfma_f32_16x16x32_bf16 a[76:79], v[116:119], v[88:91], a[76:79]
    v_mfma_f32_16x16x32_bf16 a[96:99], v[116:119], v[92:95], a[96:99]
    v_mfma_f32_16x16x32_bf16 a[116:119], v[116:119], v[96:99], a[116:119]
    s_waitcnt vmcnt(14)
    v_mfma_f32_16x16x32_bf16 a[0:3], v[144:147], v[120:123], a[0:3]
    v_mfma_f32_16x16x32_bf16 a[20:23], v[144:147], v[124:127], a[20:23]
    v_mfma_f32_16x16x32_bf16 a[40:43], v[144:147], v[128:131], a[40:43]
    v_mfma_f32_16x16x32_bf16 a[60:63], v[144:147], v[132:135], a[60:63]
    v_mfma_f32_16x16x32_bf16 a[80:83], v[144:147], v[136:139], a[80:83]
    v_mfma_f32_16x16x32_bf16 a[100:103], v[144:147], v[140:143], a[100:103]
    v_mfma_f32_16x16x32_bf16 a[4:7], v[148:151], v[120:123], a[4:7]
    v_mfma_f32_16x16x32_bf16 a[24:27], v[148:151], v[124:127], a[24:27]
    v_mfma_f32_16x16x32_bf16 a[44:47], v[148:151], v[128:131], a[44:47]
    v_mfma_f32_16x16x32_bf16 a[64:67], v[148:151], v[132:135], a[64:67]
    v_mfma_f32_16x16x32_bf16 a[84:87], v[148:151], v[136:139], a[84:87]
    v_mfma_f32_16x16x32_bf16 a[104:107], v[148:151], v[140:143], a[104:107]
    v_mfma_f32_16x16x32_bf16 a[8:11], v[152:155], v[120:123], a[8:11]
    v_mfma_f32_16x16x32_bf16 a[28:31], v[152:155], v[124:127], a[28:31]
    v_mfma_f32_16x16x32_bf16 a[48:51], v[152:155], v[128:131], a[48:51]
    v_mfma_f32_16x16x32_bf16 a[68:71], v[152:155], v[132:135], a[68:71]
    v_mfma_f32_16x16x32_bf16 a[88:91], v[152:155], v[136:139], a[88:91]
    v_mfma_f32_16x16x32_bf16 a[108:111], v[152:155], v[140:143], a[108:111]
    v_mfma_f32_16x16x32_bf16 a[12:15], v[156:159], v[120:123], a[12:15]
    v_mfma_f32_16x16x32_bf16 a[32:35], v[156:159], v[124:127], a[32:35]
    v_mfma_f32_16x16x32_bf16 a[52:55], v[156:159], v[128:131], a[52:55]
    v_mfma_f32_16x16x32_bf16 a[72:75], v[156:159], v[132:135], a[72:75]
    v_mfma_f32_16x16x32_bf16 a[92:95], v[156:159], v[136:139], a[92:95]
    v_mfma_f32_16x16x32_bf16 a[112:115], v[156:159], v[140:143], a[112:115]
    v_mfma_f32_16x16x32_bf16 a[16:19], v[160:163], v[120:123], a[16:19]
    v_mfma_f32_16x16x32_bf16 a[36:39], v[160:163], v[124:127], a[36:39]
    v_mfma_f32_16x16x32_bf16 a[56:59], v[160:163], v[128:131], a[56:59]
    v_mfma_f32_16x16x32_bf16 a[76:79], v[160:163], v[132:135], a[76:79]
    v_mfma_f32_16x16x32_bf16 a[96:99], v[160:163], v[136:139], a[96:99]
    v_mfma_f32_16x16x32_bf16 a[116:119], v[160:163], v[140:143], a[116:119]
    s_waitcnt vmcnt(8)
    v_mfma_f32_16x16x32_bf16 a[0:3], v[188:191], v[164:167], a[0:3]
    v_mfma_f32_16x16x32_bf16 a[20:23], v[188:191], v[168:171], a[20:23]
    v_mfma_f32_16x16x32_bf16 a[40:43], v[188:191], v[172:175], a[40:43]
    v_mfma_f32_16x16x32_bf16 a[60:63], v[188:191], v[176:179], a[60:63]
    v_mfma_f32_16x16x32_bf16 a[80:83], v[188:191], v[180:183], a[80:83]
    v_mfma_f32_16x16x32_bf16 a[100:103], v[188:191], v[184:187], a[100:103]
    v_mfma_f32_16x16x32_bf16 a[4:7], v[192:195], v[164:167], a[4:7]
    s_nop 1
    ds_write_b128 v28, a[0:3] offset:0
    v_mfma_f32_16x16x32_bf16 a[24:27], v[192:195], v[168:171], a[24:27]
    ds_write_b128 v28, a[20:23] offset:5120
    v_mfma_f32_16x16x32_bf16 a[44:47], v[192:195], v[172:175], a[44:47]
    ds_write_b128 v28, a[40:43] offset:34816
    v_mfma_f32_16x16x32_bf16 a[64:67], v[192:195], v[176:179], a[64:67]
    ds_write_b128 v28, a[60:63] offset:39936
    v_mfma_f32_16x16x32_bf16 a[84:87], v[192:195], v[180:183], a[84:87]
    ds_write_b128 v30, a[80:83] offset:4096
    v_mfma_f32_16x16x32_bf16 a[104:107], v[192:195], v[184:187], a[104:107]
    ds_write_b128 v30, a[100:103] offset:34816
    v_mfma_f32_16x16x32_bf16 a[8:11], v[196:199], v[164:167], a[8:11]
    ds_write_b128 v28, a[4:7] offset:1024
    v_mfma_f32_16x16x32_bf16 a[28:31], v[196:199], v[168:171], a[28:31]
    ds_write_b128 v28, a[24:27] offset:6144
    v_mfma_f32_16x16x32_bf16 a[48:51], v[196:199], v[172:175], a[48:51]
    ds_write_b128 v28, a[44:47] offset:35840
    v_mfma_f32_16x16x32_bf16 a[68:71], v[196:199], v[176:179], a[68:71]
    ds_write_b128 v30, a[64:67] offset:0
    v_mfma_f32_16x16x32_bf16 a[88:91], v[196:199], v[180:183], a[88:91]
    ds_write_b128 v30, a[84:87] offset:5120
    v_mfma_f32_16x16x32_bf16 a[108:111], v[196:199], v[184:187], a[108:111]
    ds_write_b128 v30, a[104:107] offset:35840
    v_mfma_f32_16x16x32_bf16 a[12:15], v[200:203], v[164:167], a[12:15]
    ds_write_b128 v28, a[8:11] offset:2048
    v_mfma_f32_16x16x32_bf16 a[32:35], v[200:203], v[168:171], a[32:35]
    ds_write_b128 v28, a[28:31] offset:7168
    v_mfma_f32_16x16x32_bf16 a[52:55], v[200:203], v[172:175], a[52:55]
    ds_write_b128 v28, a[48:51] offset:36864
    v_mfma_f32_16x16x32_bf16 a[72:75], v[200:203], v[176:179], a[72:75]
    ds_write_b128 v30, a[68:71] offset:1024
    v_mfma_f32_16x16x32_bf16 a[92:95], v[200:203], v[180:183], a[92:95]
    ds_write_b128 v30, a[88:91] offset:6144
    v_mfma_f32_16x16x32_bf16 a[112:115], v[200:203], v[184:187], a[112:115]
    ds_write_b128 v30, a[108:111] offset:36864
    v_mfma_f32_16x16x32_bf16 a[16:19], v[204:207], v[164:167], a[16:19]
    ds_write_b128 v28, a[12:15] offset:3072
    v_mfma_f32_16x16x32_bf16 a[36:39], v[204:207], v[168:171], a[36:39]
    ds_write_b128 v28, a[32:35] offset:32768
    v_mfma_f32_16x16x32_bf16 a[56:59], v[204:207], v[172:175], a[56:59]
    ds_write_b128 v28, a[52:55] offset:37888
    v_mfma_f32_16x16x32_bf16 a[76:79], v[204:207], v[176:179], a[76:79]
    ds_write_b128 v30, a[72:75] offset:2048
    v_mfma_f32_16x16x32_bf16 a[96:99], v[204:207], v[180:183], a[96:99]
    ds_write_b128 v30, a[92:95] offset:32768
    v_mfma_f32_16x16x32_bf16 a[116:119], v[204:207], v[184:187], a[116:119]
    ds_write_b128 v30, a[112:115] offset:37888
    ds_write_b128 v28, a[16:19] offset:4096
    ds_write_b128 v28, a[36:39] offset:33792
    ds_write_b128 v28, a[56:59] offset:38912
    ds_write_b128 v30, a[76:79] offset:3072
    s_nop 0
    ds_write_b128 v30, a[96:99] offset:33792
    s_nop 0
    ds_write_b128 v30, a[116:119] offset:38912
    s_branch L_kg_red
L_kg_v13:
    s_mov_b32 s32, s40
    s_mov_b32 s31, s32
    buffer_load_dwordx4 v[56:59], v11, s[8:11], s32 offen
    buffer_load_dwordx4 v[60:63], v12, s[8:11], s32 offen
    buffer_load_dwordx4 v[64:67], v13, s[8:11], s32 offen
    buffer_load_dwordx4 v[68:71], v14, s[8:11], s32 offen
    buffer_load_dwordx4 v[72:75], v15, s[8:11], s32 offen
    buffer_load_dwordx4 v[32:35], v5, s[8:11], s31 offen
    buffer_load_dwordx4 v[36:39], v6, s[8:11], s31 offen
    buffer_load_dwordx4 v[40:43], v7, s[8:11], s31 offen
    buffer_load_dwordx4 v[44:47], v8, s[8:11], s31 offen
    buffer_load_dwordx4 v[48:51], v9, s[8:11], s31 offen
    buffer_load_dwordx4 v[52:55], v10, s[8:11], s31 offen
    s_add_u32 s32, s32, 1024
    s_mov_b32 s31, s32
    buffer_load_dwordx4 v[100:103], v11, s[8:11], s32 offen
    buffer_load_dwordx4 v[104:107], v12, s[8:11], s32 offen
    buffer_load_dwordx4 v[108:111], v13, s[8:11], s32 offen
    buffer_load_dwordx4 v[112:115], v14, s[8:11], s32 offen
    buffer_load_dwordx4 v[116:119], v15, s[8:11], s32 offen
    buffer_load_dwordx4 v[76:79], v5, s[8:11], s31 offen
    buffer_load_dwordx4 v[80:83], v6, s[8:11], s31 offen
    buffer_load_dwordx4 v[84:87], v7, s[8:11], s31 offen
    buffer_load_dwordx4 v[88:91], v8, s[8:11], s31 offen
    buffer_load_dwordx4 v[92:95], v9, s[8:11], s31 offen
    buffer_load_dwordx4 v[96:99], v10, s[8:11], s31 offen
    s_add_u32 s32, s32, 1024
    s_mov_b32 s31, s32
    buffer_load_dwordx4 v[144:147], v11, s[8:11], s32 offen
    buffer_load_dwordx4 v[148:151], v12, s[8:11], s32 offen
    buffer_load_dwordx4 v[152:155], v13, s[8:11], s32 offen
    buffer_load_dwordx4 v[156:159], v14, s[8:11], s32 offen
    buffer_load_dwordx4 v[160:163], v15, s[8:11], s32 offen
    buffer_load_dwordx4 v[120:123], v5, s[8:11], s31 offen
    buffer_load_dwordx4 v[124:127], v6, s[8:11], s31 offen
    buffer_load_dwordx4 v[128:131], v7, s[8:11], s31 offen
    buffer_load_dwordx4 v[132:135], v8, s[8:11], s31 offen
    buffer_load_dwordx4 v[136:139], v9, s[8:11], s31 offen
    buffer_load_dwordx4 v[140:143], v10, s[8:11], s31 offen
    s_add_u32 s32, s32, 1024
    s_mov_b32 s31, s32
    buffer_load_dwordx4 v[188:191], v11, s[8:11], s32 offen
    buffer_load_dwordx4 v[192:195], v12, s[8:11], s32 offen
    buffer_load_dwordx4 v[196:199], v13, s[8:11], s32 offen
    buffer_load_dwordx4 v[200:203], v14, s[8:11], s32 offen
    buffer_load_dwordx4 v[204:207], v15, s[8:11], s32 offen
    buffer_load_dwordx4 v[164:167], v5, s[8:11], s31 offen
    buffer_load_dwordx4 v[168:171], v6, s[8:11], s31 offen
    buffer_load_dwordx4 v[172:175], v7, s[8:11], s31 offen
    buffer_load_dwordx4 v[176:179], v8, s[8:11], s31 offen
    buffer_load_dwordx4 v[180:183], v9, s[8:11], s31 offen
    buffer_load_dwordx4 v[184:187], v10, s[8:11], s31 offen
    s_add_u32 s32, s32, 1024
    s_mov_b32 s31, s32
    buffer_load_dwordx4 v[232:235], v11, s[8:11], s32 offen
    buffer_load_dwordx4 v[236:239], v12, s[8:11], s32 offen
    buffer_load_dwordx4 v[240:243], v13, s[8:11], s32 offen
    buffer_load_dwordx4 v[244:247], v14, s[8:11], s32 offen
    buffer_load_dwordx4 v[248:251], v15, s[8:11], s32 offen
    buffer_load_dwordx4 v[208:211], v5, s[8:11], s31 offen
    buffer_load_dwordx4 v[212:215], v6, s[8:11], s31 offen
    buffer_load_dwordx4 v[216:219], v7, s[8:11], s31 offen
    buffer_load_dwordx4 v[220:223], v8, s[8:11], s31 offen
    buffer_load_dwordx4 v[224:227], v9, s[8:11], s31 offen
    buffer_load_dwordx4 v[228:231], v10, s[8:11], s31 offen
    s_waitcnt vmcnt(44)
    s_add_u32 s32, s32, 1024
    s_mov_b32 s31, s32
    v_mfma_f32_16x16x32_bf16 a[0:3], v[56:59], v[32:35], 0
    v_mfma_f32_16x16x32_bf16 a[20:23], v[56:59], v[36:39], 0
    v_mfma_f32_16x16x32_bf16 a[40:43], v[56:59], v[40:43], 0
    v_mfma_f32_16x16x32_bf16 a[60:63], v[56:59], v[44:47], 0
    v_mfma_f32_16x16x32_bf16 a[80:83], v[56:59], v[48:51], 0
    v_mfma_f32_16x16x32_bf16 a[100:103], v[56:59], v[52:55], 0
    buffer_load_dwordx4 v[56:59], v11, s[8:11], s32 offen
    v_mfma_f32_16x16x32_bf16 a[4:7], v[60:63], v[32:35], 0
    v_mfma_f32_16x16x32_bf16 a[24:27], v[60:63], v[36:39], 0
    v_mfma_f32_16x16x32_bf16 a[44:47], v[60:63], v[40:43], 0
    v_mfma_f32_16x16x32_bf16 a[64:67], v[60:63], v[44:47], 0
    v_mfma_f32_16x16x32_bf16 a[84:87], v[60:63], v[48:51], 0
    v_mfma_f32_16x16x32_bf16 a[104:107], v[60:63], v[52:55], 0
    buffer_load_dwordx4 v[60:63], v12, s[8:11], s32 offen
    v_mfma_f32_16x16x32_bf16 a[8:11], v[64:67], v[32:35], 0
    v_mfma_f32_16x16x32_bf16 a[28:31], v[64:67], v[36:39], 0
    v_mfma_f32_16x16x32_bf16 a[48:51], v[64:67], v[40:43], 0
    v_mfma_f32_16x16x32_bf16 a[68:71], v[64:67], v[44:47], 0
    v_mfma_f32_16x16x32_bf16 a[88:91], v[64:67], v[48:51], 0
    v_mfma_f32_16x16x32_bf16 a[108:111], v[64:67], v[52:55], 0
    buffer_load_dwordx4 v[64:67], v13, s[8:11], s32 offen
    v_mfma_f32_16x16x32_bf16 a[12:15], v[68:71], v[32:35], 0
    v_mfma_f32_16x16x32_bf16 a[32:35], v[68:71], v[36:39], 0
    v_mfma_f32_16x16x32_bf16 a[52:55], v[68:71], v[40:43], 0
    v_mfma_f32_16x16x32_bf16 a[72:75], v[68:71], v[44:47], 0
    v_mfma_f32_16x16x32_bf16 a[92:95], v[68:71], v[48:51], 0
    v_mfma_f32_16x16x32_bf16 a[112:115], v[68:71], v[52:55], 0
    buffer_load_dwordx4 v[68:71], v14, s[8:11], s32 offen
    v_mfma_f32_16x16x32_bf16 a[16:19], v[72:75], v[32:35], 0
    v_mfma_f32_16x16x32_bf16 a[36:39], v[72:75], v[36:39], 0
    v_mfma_f32_16x16x32_bf16 a[56:59], v[72:75], v[40:43], 0
    v_mfma_f32_16x16x32_bf16 a[76:79], v[72:75], v[44:47], 0
    v_mfma_f32_16x16x32_bf16 a[96:99], v[72:75], v[48:51], 0
    v_mfma_f32_16x16x32_bf16 a[116:119], v[72:75], v[52:55], 0
    buffer_load_dwordx4 v[72:75], v15, s[8:11], s32 offen
    buffer_load_dwordx4 v[32:35], v5, s[8:11], s31 offen
    buffer_load_dwordx4 v[36:39], v6, s[8:11], s31 offen
    buffer_load_dwordx4 v[40:43], v7, s[8:11], s31 offen
    buffer_load_dwordx4 v[44:47], v8, s[8:11], s31 offen
    buffer_load_dwordx4 v[48:51], v9, s[8:11], s31 offen
    buffer_load_dwordx4 v[52:55], v10, s[8:11], s31 offen
    s_waitcnt vmcnt(44)
    s_add_u32 s32, s32, 1024
    s_mov_b32 s31, s32
    v_mfma_f32_16x16x32_bf16 a[0:3], v[100:103], v[76:79], a[0:3]
    v_mfma_f32_16x16x32_bf16 a[20:23], v[100:103], v[80:83], a[20:23]
    v_mfma_f32_16x16x32_bf16 a[40:43], v[100:103], v[84:87], a[40:43]
    v_mfma_f32_16x16x32_bf16 a[60:63], v[100:103], v[88:91], a[60:63]
    v_mfma_f32_16x16x32_bf16 a[80:83], v[100:103], v[92:95], a[80:83]
    v_mfma_f32_16x16x32_bf16 a[100:103], v[100:103], v[96:99], a[100:103]
    buffer_load_dwordx4 v[100:103], v11, s[8:11], s32 offen
    v_mfma_f32_16x16x32_bf16 a[4:7], v[104:107], v[76:79], a[4:7]
    v_mfma_f32_16x16x32_bf16 a[24:27], v[104:107], v[80:83], a[24:27]
    v_mfma_f32_16x16x32_bf16 a[44:47], v[104:107], v[84:87], a[44:47]
    v_mfma_f32_16x16x32_bf16 a[64:67], v[104:107], v[88:91], a[64:67]
    v_mfma_f32_16x16x32_bf16 a[84:87], v[104:107], v[92:95], a[84:87]
    v_mfma_f32_16x16x32_bf16 a[104:107], v[104:107], v[96:99], a[104:107]
    buffer_load_dwordx4 v[104:107], v12, s[8:11], s32 offen
    v_mfma_f32_16x16x32_bf16 a[8:11], v[108:111], v[76:79], a[8:11]
    v_mfma_f32_16x16x32_bf16 a[28:31], v[108:111], v[80:83], a[28:31]
    v_mfma_f32_16x16x32_bf16 a[48:51], v[108:111], v[84:87], a[48:51]
    v_mfma_f32_16x16x32_bf16 a[68:71], v[108:111], v[88:91], a[68:71]
    v_mfma_f32_16x16x32_bf16 a[88:91], v[108:111], v[92:95], a[88:91]
    v_mfma_f32_16x16x32_bf16 a[108:111], v[108:111], v[96:99], a[108:111]
    buffer_load_dwordx4 v[108:111], v13, s[8:11], s32 offen
    v_mfma_f32_16x16x32_bf16 a[12:15], v[112:115], v[76:79], a[12:15]
    v_mfma_f32_16x16x32_bf16 a[32:35], v[112:115], v[80:83], a[32:35]
    v_mfma_f32_16x16x32_bf16 a[52:55], v[112:115], v[84:87], a[52:55]
    v_mfma_f32_16x16x32_bf16 a[72:75], v[112:115], v[88:91], a[72:75]
    v_mfma_f32_16x16x32_bf16 a[92:95], v[112:115], v[92:95], a[92:95]
    v_mfma_f32_16x16x32_bf16 a[112:115], v[112:115], v[96:99], a[112:115]
    buffer_load_dwordx4 v[112:115], v14, s[8:11], s32 offen
    v_mfma_f32_16x16x32_bf16 a[16:19], v[116:119], v[76:79], a[16:19]
    v_mfma_f32_16x16x32_bf16 a[36:39], v[116:119], v[80:83], a[36:39]
    v_mfma_f32_16x16x32_bf16 a[56:59], v[116:119], v[84:87], a[56:59]
    v_mfma_f32_16x16x32_bf16 a[76:79], v[116:119], v[88:91], a[76:79]
    v_mfma_f32_16x16x32_bf16 a[96:99], v[116:119], v[92:95], a[96:99]
    v_mfma_f32_16x16x32_bf16 a[116:119], v[116:119], v[96:99], a[116:119]
    buffer_load_dwordx4 v[116:119], v15, s[8:11], s32 offen
    buffer_load_dwordx4 v[76:79], v5, s[8:11], s31 offen
    buffer_load_dwordx4 v[80:83], v6, s[8:11], s31 offen
    buffer_load_dwordx4 v[84:87], v7, s[8:11], s31 offen
    buffer_load_dwordx4 v[88:91], v8, s[8:11], s31 offen
    buffer_load_dwordx4 v[92:95], v9, s[8:11], s31 offen
    buffer_load_dwordx4 v[96:99], v10, s[8:11], s31 offen
    s_waitcnt vmcnt(44)
    s_add_u32 s32, s32, 1024
    s_mov_b32 s31, s32
    v_mfma_f32_16x16x32_bf16 a[0:3], v[144:147], v[120:123], a[0:3]
    v_mfma_f32_16x16x32_bf16 a[20:23], v[144:147], v[124:127], a[20:23]
    v_mfma_f32_16x16x32_bf16 a[40:43], v[144:147], v[128:131], a[40:43]
    v_mfma_f32_16x16x32_bf16 a[60:63], v[144:147], v[132:135], a[60:63]
    v_mfma_f32_16x16x32_bf16 a[80:83], v[144:147], v[136:139], a[80:83]
    v_mfma_f32_16x16x32_bf16 a[100:103], v[144:147], v[140:143], a[100:103]
    buffer_load_dwordx4 v[144:147], v11, s[8:11], s32 offen
    v_mfma_f32_16x16x32_bf16 a[4:7], v[148:151], v[120:123], a[4:7]
    v_mfma_f32_16x16x32_bf16 a[24:27], v[148:151], v[124:127], a[24:27]
    v_mfma_f32_16x16x32_bf16 a[44:47], v[148:151], v[128:131], a[44:47]
    v_mfma_f32_16x16x32_bf16 a[64:67], v[148:151], v[132:135], a[64:67]
    v_mfma_f32_16x16x32_bf16 a[84:87], v[148:151], v[136:139], a[84:87]
    v_mfma_f32_16x16x32_bf16 a[104:107], v[148:151], v[140:143], a[104:107]
    buffer_load_dwordx4 v[148:151], v12, s[8:11], s32 offen
    v_mfma_f32_16x16x32_bf16 a[8:11], v[152:155], v[120:123], a[8:11]
    v_mfma_f32_16x16x32_bf16 a[28:31], v[152:155], v[124:127], a[28:31]
    v_mfma_f32_16x16x32_bf16 a[48:51], v[152:155], v[128:131], a[48:51]
    v_mfma_f32_16x16x32_bf16 a[68:71], v[152:155], v[132:135], a[68:71]
    v_mfma_f32_16x16x32_bf16 a[88:91], v[152:155], v[136:139], a[88:91]
    v_mfma_f32_16x16x32_bf16 a[108:111], v[152:155], v[140:143], a[108:111]
    buffer_load_dwordx4 v[152:155], v13, s[8:11], s32 offen
    v_mfma_f32_16x16x32_bf16 a[12:15], v[156:159], v[120:123], a[12:15]
    v_mfma_f32_16x16x32_bf16 a[32:35], v[156:159], v[124:127], a[32:35]
    v_mfma_f32_16x16x32_bf16 a[52:55], v[156:159], v[128:131], a[52:55]
    v_mfma_f32_16x16x32_bf16 a[72:75], v[156:159], v[132:135], a[72:75]
    v_mfma_f32_16x16x32_bf16 a[92:95], v[156:159], v[136:139], a[92:95]
    v_mfma_f32_16x16x32_bf16 a[112:115], v[156:159], v[140:143], a[112:115]
    buffer_load_dwordx4 v[156:159], v14, s[8:11], s32 offen
    v_mfma_f32_16x16x32_bf16 a[16:19], v[160:163], v[120:123], a[16:19]
    v_mfma_f32_16x16x32_bf16 a[36:39], v[160:163], v[124:127], a[36:39]
    v_mfma_f32_16x16x32_bf16 a[56:59], v[160:163], v[128:131], a[56:59]
    v_mfma_f32_16x16x32_bf16 a[76:79], v[160:163], v[132:135], a[76:79]
    v_mfma_f32_16x16x32_bf16 a[96:99], v[160:163], v[136:139], a[96:99]
    v_mfma_f32_16x16x32_bf16 a[116:119], v[160:163], v[140:143], a[116:119]
    buffer_load_dwordx4 v[160:163], v15, s[8:11], s32 offen
    buffer_load_dwordx4 v[120:123], v5, s[8:11], s31 offen
    buffer_load_dwordx4 v[124:127], v6, s[8:11], s31 offen
    buffer_load_dwordx4 v[128:131], v7, s[8:11], s31 offen
    buffer_load_dwordx4 v[132:135], v8, s[8:11], s31 offen
    buffer_load_dwordx4 v[136:139], v9, s[8:11], s31 offen
    buffer_load_dwordx4 v[140:143], v10, s[8:11], s31 offen
    s_waitcnt vmcnt(44)
    s_add_u32 s32, s32, 1024
    s_mov_b32 s31, s32
    v_mfma_f32_16x16x32_bf16 a[0:3], v[188:191], v[164:167], a[0:3]
    v_mfma_f32_16x16x32_bf16 a[20:23], v[188:191], v[168:171], a[20:23]
    v_mfma_f32_16x16x32_bf16 a[40:43], v[188:191], v[172:175], a[40:43]
    v_mfma_f32_16x16x32_bf16 a[60:63], v[188:191], v[176:179], a[60:63]
    v_mfma_f32_16x16x32_bf16 a[80:83], v[188:191], v[180:183], a[80:83]
    v_mfma_f32_16x16x32_bf16 a[100:103], v[188:191], v[184:187], a[100:103]
    buffer_load_dwordx4 v[188:191], v11, s[8:11], s32 offen
    v_mfma_f32_16x16x32_bf16 a[4:7], v[192:195], v[164:167], a[4:7]
    v_mfma_f32_16x16x32_bf16 a[24:27], v[192:195], v[168:171], a[24:27]
    v_mfma_f32_16x16x32_bf16 a[44:47], v[192:195], v[172:175], a[44:47]
    v_mfma_f32_16x16x32_bf16 a[64:67], v[192:195], v[176:179], a[64:67]
    v_mfma_f32_16x16x32_bf16 a[84:87], v[192:195], v[180:183], a[84:87]
    v_mfma_f32_16x16x32_bf16 a[104:107], v[192:195], v[184:187], a[104:107]
    buffer_load_dwordx4 v[192:195], v12, s[8:11], s32 offen
    v_mfma_f32_16x16x32_bf16 a[8:11], v[196:199], v[164:167], a[8:11]
    v_mfma_f32_16x16x32_bf16 a[28:31], v[196:199], v[168:171], a[28:31]
    v_mfma_f32_16x16x32_bf16 a[48:51], v[196:199], v[172:175], a[48:51]
    v_mfma_f32_16x16x32_bf16 a[68:71], v[196:199], v[176:179], a[68:71]
    v_mfma_f32_16x16x32_bf16 a[88:91], v[196:199], v[180:183], a[88:91]
    v_mfma_f32_16x16x32_bf16 a[108:111], v[196:199], v[184:187], a[108:111]
    buffer_load_dwordx4 v[196:199], v13, s[8:11], s32 offen
    v_mfma_f32_16x16x32_bf16 a[12:15], v[200:203], v[164:167], a[12:15]
    v_mfma_f32_16x16x32_bf16 a[32:35], v[200:203], v[168:171], a[32:35]
    v_mfma_f32_16x16x32_bf16 a[52:55], v[200:203], v[172:175], a[52:55]
    v_mfma_f32_16x16x32_bf16 a[72:75], v[200:203], v[176:179], a[72:75]
    v_mfma_f32_16x16x32_bf16 a[92:95], v[200:203], v[180:183], a[92:95]
    v_mfma_f32_16x16x32_bf16 a[112:115], v[200:203], v[184:187], a[112:115]
    buffer_load_dwordx4 v[200:203], v14, s[8:11], s32 offen
    v_mfma_f32_16x16x32_bf16 a[16:19], v[204:207], v[164:167], a[16:19]
    v_mfma_f32_16x16x32_bf16 a[36:39], v[204:207], v[168:171], a[36:39]
    v_mfma_f32_16x16x32_bf16 a[56:59], v[204:207], v[172:175], a[56:59]
    v_mfma_f32_16x16x32_bf16 a[76:79], v[204:207], v[176:179], a[76:79]
    v_mfma_f32_16x16x32_bf16 a[96:99], v[204:207], v[180:183], a[96:99]
    v_mfma_f32_16x16x32_bf16 a[116:119], v[204:207], v[184:187], a[116:119]
    buffer_load_dwordx4 v[204:207], v15, s[8:11], s32 offen
    buffer_load_dwordx4 v[164:167], v5, s[8:11], s31 offen
    buffer_load_dwordx4 v[168:171], v6, s[8:11], s31 offen
    buffer_load_dwordx4 v[172:175], v7, s[8:11], s31 offen
    buffer_load_dwordx4 v[176:179], v8, s[8:11], s31 offen
    buffer_load_dwordx4 v[180:183], v9, s[8:11], s31 offen
    buffer_load_dwordx4 v[184:187], v10, s[8:11], s31 offen
    s_waitcnt vmcnt(44)
    s_add_u32 s32, s32, 1024
    s_mov_b32 s31, s32
    v_mfma_f32_16x16x32_bf16 a[0:3], v[232:235], v[208:211], a[0:3]
    v_mfma_f32_16x16x32_bf16 a[20:23], v[232:235], v[212:215], a[20:23]
    v_mfma_f32_16x16x32_bf16 a[40:43], v[232:235], v[216:219], a[40:43]
    v_mfma_f32_16x16x32_bf16 a[60:63], v[232:235], v[220:223], a[60:63]
    v_mfma_f32_16x16x32_bf16 a[80:83], v[232:235], v[224:227], a[80:83]
    v_mfma_f32_16x16x32_bf16 a[100:103], v[232:235], v[228:231], a[100:103]
    buffer_load_dwordx4 v[232:235], v11, s[8:11], s32 offen
    v_mfma_f32_16x16x32_bf16 a[4:7], v[236:239], v[208:211], a[4:7]
    v_mfma_f32_16x16x32_bf16 a[24:27], v[236:239], v[212:215], a[24:27]
    v_mfma_f32_16x16x32_bf16 a[44:47], v[236:239], v[216:219], a[44:47]
    v_mfma_f32_16x16x32_bf16 a[64:67], v[236:239], v[220:223], a[64:67]
    v_mfma_f32_16x16x32_bf16 a[84:87], v[236:239], v[224:227], a[84:87]
    v_mfma_f32_16x16x32_bf16 a[104:107], v[236:239], v[228:231], a[104:107]
    buffer_load_dwordx4 v[236:239], v12, s[8:11], s32 offen
    v_mfma_f32_16x16x32_bf16 a[8:11], v[240:243], v[208:211], a[8:11]
    v_mfma_f32_16x16x32_bf16 a[28:31], v[240:243], v[212:215], a[28:31]
    v_mfma_f32_16x16x32_bf16 a[48:51], v[240:243], v[216:219], a[48:51]
    v_mfma_f32_16x16x32_bf16 a[68:71], v[240:243], v[220:223], a[68:71]
    v_mfma_f32_16x16x32_bf16 a[88:91], v[240:243], v[224:227], a[88:91]
    v_mfma_f32_16x16x32_bf16 a[108:111], v[240:243], v[228:231], a[108:111]
    buffer_load_dwordx4 v[240:243], v13, s[8:11], s32 offen
    v_mfma_f32_16x16x32_bf16 a[12:15], v[244:247], v[208:211], a[12:15]
    v_mfma_f32_16x16x32_bf16 a[32:35], v[244:247], v[212:215], a[32:35]
    v_mfma_f32_16x16x32_bf16 a[52:55], v[244:247], v[216:219], a[52:55]
    v_mfma_f32_16x16x32_bf16 a[72:75], v[244:247], v[220:223], a[72:75]
    v_mfma_f32_16x16x32_bf16 a[92:95], v[244:247], v[224:227], a[92:95]
    v_mfma_f32_16x16x32_bf16 a[112:115], v[244:247], v[228:231], a[112:115]
    buffer_load_dwordx4 v[244:247], v14, s[8:11], s32 offen
    v_mfma_f32_16x16x32_bf16 a[16:19], v[248:251], v[208:211], a[16:19]
    v_mfma_f32_16x16x32_bf16 a[36:39], v[248:251], v[212:215], a[36:39]
    v_mfma_f32_16x16x32_bf16 a[56:59], v[248:251], v[216:219], a[56:59]
    v_mfma_f32_16x16x32_bf16 a[76:79], v[248:251], v[220:223], a[76:79]
    v_mfma_f32_16x16x32_bf16 a[96:99], v[248:251], v[224:227], a[96:99]
    v_mfma_f32_16x16x32_bf16 a[116:119], v[248:251], v[228:231], a[116:119]
    buffer_load_dwordx4 v[248:251], v15, s[8:11], s32 offen
    buffer_load_dwordx4 v[208:211], v5, s[8:11], s31 offen
    buffer_load_dwordx4 v[212:215], v6, s[8:11], s31 offen
    buffer_load_dwordx4 v[216:219], v7, s[8:11], s31 offen
    buffer_load_dwordx4 v[220:223], v8, s[8:11], s31 offen
    buffer_load_dwordx4 v[224:227], v9, s[8:11], s31 offen
    buffer_load_dwordx4 v[228:231], v10, s[8:11], s31 offen
    s_waitcnt vmcnt(44)
    s_add_u32 s32, s32, 1024
    s_mov_b32 s31, s32
    v_mfma_f32_16x16x32_bf16 a[0:3], v[56:59], v[32:35], a[0:3]
    v_mfma_f32_16x16x32_bf16 a[20:23], v[56:59], v[36:39], a[20:23]
    v_mfma_f32_16x16x32_bf16 a[40:43], v[56:59], v[40:43], a[40:43]
    v_mfma_f32_16x16x32_bf16 a[60:63], v[56:59], v[44:47], a[60:63]
    v_mfma_f32_16x16x32_bf16 a[80:83], v[56:59], v[48:51], a[80:83]
    v_mfma_f32_16x16x32_bf16 a[100:103], v[56:59], v[52:55], a[100:103]
    buffer_load_dwordx4 v[56:59], v11, s[8:11], s32 offen
    v_mfma_f32_16x16x32_bf16 a[4:7], v[60:63], v[32:35], a[4:7]
    v_mfma_f32_16x16x32_bf16 a[24:27], v[60:63], v[36:39], a[24:27]
    v_mfma_f32_16x16x32_bf16 a[44:47], v[60:63], v[40:43], a[44:47]
    v_mfma_f32_16x16x32_bf16 a[64:67], v[60:63], v[44:47], a[64:67]
    v_mfma_f32_16x16x32_bf16 a[84:87], v[60:63], v[48:51], a[84:87]
    v_mfma_f32_16x16x32_bf16 a[104:107], v[60:63], v[52:55], a[104:107]
    buffer_load_dwordx4 v[60:63], v12, s[8:11], s32 offen
    v_mfma_f32_16x16x32_bf16 a[8:11], v[64:67], v[32:35], a[8:11]
    v_mfma_f32_16x16x32_bf16 a[28:31], v[64:67], v[36:39], a[28:31]
    v_mfma_f32_16x16x32_bf16 a[48:51], v[64:67], v[40:43], a[48:51]
    v_mfma_f32_16x16x32_bf16 a[68:71], v[64:67], v[44:47], a[68:71]
    v_mfma_f32_16x16x32_bf16 a[88:91], v[64:67], v[48:51], a[88:91]
    v_mfma_f32_16x16x32_bf16 a[108:111], v[64:67], v[52:55], a[108:111]
    buffer_load_dwordx4 v[64:67], v13, s[8:11], s32 offen
    v_mfma_f32_16x16x32_bf16 a[12:15], v[68:71], v[32:35], a[12:15]
    v_mfma_f32_16x16x32_bf16 a[32:35], v[68:71], v[36:39], a[32:35]
    v_mfma_f32_16x16x32_bf16 a[52:55], v[68:71], v[40:43], a[52:55]
    v_mfma_f32_16x16x32_bf16 a[72:75], v[68:71], v[44:47], a[72:75]
    v_mfma_f32_16x16x32_bf16 a[92:95], v[68:71], v[48:51], a[92:95]
    v_mfma_f32_16x16x32_bf16 a[112:115], v[68:71], v[52:55], a[112:115]
    buffer_load_dwordx4 v[68:71], v14, s[8:11], s32 offen
    v_mfma_f32_16x16x32_bf16 a[16:19], v[72:75], v[32:35], a[16:19]
    v_mfma_f32_16x16x32_bf16 a[36:39], v[72:75], v[36:39], a[36:39]
    v_mfma_f32_16x16x32_bf16 a[56:59], v[72:75], v[40:43], a[56:59]
    v_mfma_f32_16x16x32_bf16 a[76:79], v[72:75], v[44:47], a[76:79]
    v_mfma_f32_16x16x32_bf16 a[96:99], v[72:75], v[48:51], a[96:99]
    v_mfma_f32_16x16x32_bf16 a[116:119], v[72:75], v[52:55], a[116:119]
    buffer_load_dwordx4 v[72:75], v15, s[8:11], s32 offen
    buffer_load_dwordx4 v[32:35], v5, s[8:11], s31 offen
    buffer_load_dwordx4 v[36:39], v6, s[8:11], s31 offen
    buffer_load_dwordx4 v[40:43], v7, s[8:11], s31 offen
    buffer_load_dwordx4 v[44:47], v8, s[8:11], s31 offen
    buffer_load_dwordx4 v[48:51], v9, s[8:11], s31 offen
    buffer_load_dwordx4 v[52:55], v10, s[8:11], s31 offen
    s_waitcnt vmcnt(44)
    s_add_u32 s32, s32, 1024
    s_mov_b32 s31, s32
    v_mfma_f32_16x16x32_bf16 a[0:3], v[100:103], v[76:79], a[0:3]
    v_mfma_f32_16x16x32_bf16 a[20:23], v[100:103], v[80:83], a[20:23]
    v_mfma_f32_16x16x32_bf16 a[40:43], v[100:103], v[84:87], a[40:43]
    v_mfma_f32_16x16x32_bf16 a[60:63], v[100:103], v[88:91], a[60:63]
    v_mfma_f32_16x16x32_bf16 a[80:83], v[100:103], v[92:95], a[80:83]
    v_mfma_f32_16x16x32_bf16 a[100:103], v[100:103], v[96:99], a[100:103]
    buffer_load_dwordx4 v[100:103], v11, s[8:11], s32 offen
    v_mfma_f32_16x16x32_bf16 a[4:7], v[104:107], v[76:79], a[4:7]
    v_mfma_f32_16x16x32_bf16 a[24:27], v[104:107], v[80:83], a[24:27]
    v_mfma_f32_16x16x32_bf16 a[44:47], v[104:107], v[84:87], a[44:47]
    v_mfma_f32_16x16x32_bf16 a[64:67], v[104:107], v[88:91], a[64:67]
    v_mfma_f32_16x16x32_bf16 a[84:87], v[104:107], v[92:95], a[84:87]
    v_mfma_f32_16x16x32_bf16 a[104:107], v[104:107], v[96:99], a[104:107]
    buffer_load_dwordx4 v[104:107], v12, s[8:11], s32 offen
    v_mfma_f32_16x16x32_bf16 a[8:11], v[108:111], v[76:79], a[8:11]
    v_mfma_f32_16x16x32_bf16 a[28:31], v[108:111], v[80:83], a[28:31]
    v_mfma_f32_16x16x32_bf16 a[48:51], v[108:111], v[84:87], a[48:51]
    v_mfma_f32_16x16x32_bf16 a[68:71], v[108:111], v[88:91], a[68:71]
    v_mfma_f32_16x16x32_bf16 a[88:91], v[108:111], v[92:95], a[88:91]
    v_mfma_f32_16x16x32_bf16 a[108:111], v[108:111], v[96:99], a[108:111]
    buffer_load_dwordx4 v[108:111], v13, s[8:11], s32 offen
    v_mfma_f32_16x16x32_bf16 a[12:15], v[112:115], v[76:79], a[12:15]
    v_mfma_f32_16x16x32_bf16 a[32:35], v[112:115], v[80:83], a[32:35]
    v_mfma_f32_16x16x32_bf16 a[52:55], v[112:115], v[84:87], a[52:55]
    v_mfma_f32_16x16x32_bf16 a[72:75], v[112:115], v[88:91], a[72:75]
    v_mfma_f32_16x16x32_bf16 a[92:95], v[112:115], v[92:95], a[92:95]
    v_mfma_f32_16x16x32_bf16 a[112:115], v[112:115], v[96:99], a[112:115]
    buffer_load_dwordx4 v[112:115], v14, s[8:11], s32 offen
    v_mfma_f32_16x16x32_bf16 a[16:19], v[116:119], v[76:79], a[16:19]
    v_mfma_f32_16x16x32_bf16 a[36:39], v[116:119], v[80:83], a[36:39]
    v_mfma_f32_16x16x32_bf16 a[56:59], v[116:119], v[84:87], a[56:59]
    v_mfma_f32_16x16x32_bf16 a[76:79], v[116:119], v[88:91], a[76:79]
    v_mfma_f32_16x16x32_bf16 a[96:99], v[116:119], v[92:95], a[96:99]
    v_mfma_f32_16x16x32_bf16 a[116:119], v[116:119], v[96:99], a[116:119]
    buffer_load_dwordx4 v[116:119], v15, s[8:11], s32 offen
    buffer_load_dwordx4 v[76:79], v5, s[8:11], s31 offen
    buffer_load_dwordx4 v[80:83], v6, s[8:11], s31 offen
    buffer_load_dwordx4 v[84:87], v7, s[8:11], s31 offen
    buffer_load_dwordx4 v[88:91], v8, s[8:11], s31 offen
    buffer_load_dwordx4 v[92:95], v9, s[8:11], s31 offen
    buffer_load_dwordx4 v[96:99], v10, s[8:11], s31 offen
    s_waitcnt vmcnt(44)
    s_add_u32 s32, s32, 1024
    s_mov_b32 s31, s32
    v_mfma_f32_16x16x32_bf16 a[0:3], v[144:147], v[120:123], a[0:3]
    v_mfma_f32_16x16x32_bf16 a[20:23], v[144:147], v[124:127], a[20:23]
    v_mfma_f32_16x16x32_bf16 a[40:43], v[144:147], v[128:131], a[40:43]
    v_mfma_f32_16x16x32_bf16 a[60:63], v[144:147], v[132:135], a[60:63]
    v_mfma_f32_16x16x32_bf16 a[80:83], v[144:147], v[136:139], a[80:83]
    v_mfma_f32_16x16x32_bf16 a[100:103], v[144:147], v[140:143], a[100:103]
    buffer_load_dwordx4 v[144:147], v11, s[8:11], s32 offen
    v_mfma_f32_16x16x32_bf16 a[4:7], v[148:151], v[120:123], a[4:7]
    v_mfma_f32_16x16x32_bf16 a[24:27], v[148:151], v[124:127], a[24:27]
    v_mfma_f32_16x16x32_bf16 a[44:47], v[148:151], v[128:131], a[44:47]
    v_mfma_f32_16x16x32_bf16 a[64:67], v[148:151], v[132:135], a[64:67]
    v_mfma_f32_16x16x32_bf16 a[84:87], v[148:151], v[136:139], a[84:87]
    v_mfma_f32_16x16x32_bf16 a[104:107], v[148:151], v[140:143], a[104:107]
    buffer_load_dwordx4 v[148:151], v12, s[8:11], s32 offen
    v_mfma_f32_16x16x32_bf16 a[8:11], v[152:155], v[120:123], a[8:11]
    v_mfma_f32_16x16x32_bf16 a[28:31], v[152:155], v[124:127], a[28:31]
    v_mfma_f32_16x16x32_bf16 a[48:51], v[152:155], v[128:131], a[48:51]
    v_mfma_f32_16x16x32_bf16 a[68:71], v[152:155], v[132:135], a[68:71]
    v_mfma_f32_16x16x32_bf16 a[88:91], v[152:155], v[136:139], a[88:91]
    v_mfma_f32_16x16x32_bf16 a[108:111], v[152:155], v[140:143], a[108:111]
    buffer_load_dwordx4 v[152:155], v13, s[8:11], s32 offen
    v_mfma_f32_16x16x32_bf16 a[12:15], v[156:159], v[120:123], a[12:15]
    v_mfma_f32_16x16x32_bf16 a[32:35], v[156:159], v[124:127], a[32:35]
    v_mfma_f32_16x16x32_bf16 a[52:55], v[156:159], v[128:131], a[52:55]
    v_mfma_f32_16x16x32_bf16 a[72:75], v[156:159], v[132:135], a[72:75]
    v_mfma_f32_16x16x32_bf16 a[92:95], v[156:159], v[136:139], a[92:95]
    v_mfma_f32_16x16x32_bf16 a[112:115], v[156:159], v[140:143], a[112:115]
    buffer_load_dwordx4 v[156:159], v14, s[8:11], s32 offen
    v_mfma_f32_16x16x32_bf16 a[16:19], v[160:163], v[120:123], a[16:19]
    v_mfma_f32_16x16x32_bf16 a[36:39], v[160:163], v[124:127], a[36:39]
    v_mfma_f32_16x16x32_bf16 a[56:59], v[160:163], v[128:131], a[56:59]
    v_mfma_f32_16x16x32_bf16 a[76:79], v[160:163], v[132:135], a[76:79]
    v_mfma_f32_16x16x32_bf16 a[96:99], v[160:163], v[136:139], a[96:99]
    v_mfma_f32_16x16x32_bf16 a[116:119], v[160:163], v[140:143], a[116:119]
    buffer_load_dwordx4 v[160:163], v15, s[8:11], s32 offen
    buffer_load_dwordx4 v[120:123], v5, s[8:11], s31 offen
    buffer_load_dwordx4 v[124:127], v6, s[8:11], s31 offen
    buffer_load_dwordx4 v[128:131], v7, s[8:11], s31 offen
    buffer_load_dwordx4 v[132:135], v8, s[8:11], s31 offen
    buffer_load_dwordx4 v[136:139], v9, s[8:11], s31 offen
    buffer_load_dwordx4 v[140:143], v10, s[8:11], s31 offen
    s_waitcnt vmcnt(44)
    s_mov_b32 s32, s41
    v_mfma_f32_16x16x32_bf16 a[0:3], v[188:191], v[164:167], a[0:3]
    v_mfma_f32_16x16x32_bf16 a[20:23], v[188:191], v[168:171], a[20:23]
    v_mfma_f32_16x16x32_bf16 a[40:43], v[188:191], v[172:175], a[40:43]
    v_mfma_f32_16x16x32_bf16 a[60:63], v[188:191], v[176:179], a[60:63]
    v_mfma_f32_16x16x32_bf16 a[80:83], v[188:191], v[180:183], a[80:83]
    v_mfma_f32_16x16x32_bf16 a[100:103], v[188:191], v[184:187], a[100:103]
    buffer_load_dwordx4 v[188:191], v16, s[12:15], s32 offen
    v_mfma_f32_16x16x32_bf16 a[4:7], v[192:195], v[164:167], a[4:7]
    v_mfma_f32_16x16x32_bf16 a[24:27], v[192:195], v[168:171], a[24:27]
    v_mfma_f32_16x16x32_bf16 a[44:47], v[192:195], v[172:175], a[44:47]
    v_mfma_f32_16x16x32_bf16 a[64:67], v[192:195], v[176:179], a[64:67]
    v_mfma_f32_16x16x32_bf16 a[84:87], v[192:195], v[180:183], a[84:87]
    v_mfma_f32_16x16x32_bf16 a[104:107], v[192:195], v[184:187], a[104:107]
    buffer_load_dwordx4 v[192:195], v17, s[12:15], s32 offen
    v_mfma_f32_16x16x32_bf16 a[8:11], v[196:199], v[164:167], a[8:11]
    v_mfma_f32_16x16x32_bf16 a[28:31], v[196:199], v[168:171], a[28:31]
    v_mfma_f32_16x16x32_bf16 a[48:51], v[196:199], v[172:175], a[48:51]
    v_mfma_f32_16x16x32_bf16 a[68:71], v[196:199], v[176:179], a[68:71]
    v_mfma_f32_16x16x32_bf16 a[88:91], v[196:199], v[180:183], a[88:91]
    v_mfma_f32_16x16x32_bf16 a[108:111], v[196:199], v[184:187], a[108:111]
    buffer_load_dwordx4 v[196:199], v18, s[12:15], s32 offen
    v_mfma_f32_16x16x32_bf16 a[12:15], v[200:203], v[164:167], a[12:15]
    v_mfma_f32_16x16x32_bf16 a[32:35], v[200:203], v[168:171], a[32:35]
    v_mfma_f32_16x16x32_bf16 a[52:55], v[200:203], v[172:175], a[52:55]
    v_mfma_f32_16x16x32_bf16 a[72:75], v[200:203], v[176:179], a[72:75]
    v_mfma_f32_16x16x32_bf16 a[92:95], v[200:203], v[180:183], a[92:95]
    v_mfma_f32_16x16x32_bf16 a[112:115], v[200:203], v[184:187], a[112:115]
    buffer_load_dwordx4 v[200:203], v19, s[12:15], s32 offen
    v_mfma_f32_16x16x32_bf16 a[16:19], v[204:207], v[164:167], a[16:19]
    v_mfma_f32_16x16x32_bf16 a[36:39], v[204:207], v[168:171], a[36:39]
    v_mfma_f32_16x16x32_bf16 a[56:59], v[204:207], v[172:175], a[56:59]
    v_mfma_f32_16x16x32_bf16 a[76:79], v[204:207], v[176:179], a[76:79]
    v_mfma_f32_16x16x32_bf16 a[96:99], v[204:207], v[180:183], a[96:99]
    v_mfma_f32_16x16x32_bf16 a[116:119], v[204:207], v[184:187], a[116:119]
    buffer_load_dwordx4 v[204:207], v20, s[12:15], s32 offen
    s_waitcnt vmcnt(38)
    s_add_u32 s32, s32, 1024
    v_mfma_f32_16x16x32_bf16 a[0:3], v[232:235], v[208:211], a[0:3]
    v_mfma_f32_16x16x32_bf16 a[20:23], v[232:235], v[212:215], a[20:23]
    v_mfma_f32_16x16x32_bf16 a[40:43], v[232:235], v[216:219], a[40:43]
    v_mfma_f32_16x16x32_bf16 a[60:63], v[232:235], v[220:223], a[60:63]
    v_mfma_f32_16x16x32_bf16 a[80:83], v[232:235], v[224:227], a[80:83]
    v_mfma_f32_16x16x32_bf16 a[100:103], v[232:235], v[228:231], a[100:103]
    buffer_load_dwordx4 v[232:235], v16, s[12:15], s32 offen
    v_mfma_f32_16x16x32_bf16 a[4:7], v[236:239], v[208:211], a[4:7]
    v_mfma_f32_16x16x32_bf16 a[24:27], v[236:239], v[212:215], a[24:27]
    v_mfma_f32_16x16x32_bf16 a[44:47], v[236:239], v[216:219], a[44:47]
    v_mfma_f32_16x16x32_bf16 a[64:67], v[236:239], v[220:223], a[64:67]
    v_mfma_f32_16x16x32_bf16 a[84:87], v[236:239], v[224:227], a[84:87]
    v_mfma_f32_16x16x32_bf16 a[104:107], v[236:239], v[228:231], a[104:107]
    buffer_load_dwordx4 v[236:239], v17, s[12:15], s32 offen
    v_mfma_f32_16x16x32_bf16 a[8:11], v[240:243], v[208:211], a[8:11]
    v_mfma_f32_16x16x32_bf16 a[28:31], v[240:243], v[212:215], a[28:31]
    v_mfma_f32_16x16x32_bf16 a[48:51], v[240:243], v[216:219], a[48:51]
    v_mfma_f32_16x16x32_bf16 a[68:71], v[240:243], v[220:223], a[68:71]
    v_mfma_f32_16x16x32_bf16 a[88:91], v[240:243], v[224:227], a[88:91]
    v_mfma_f32_16x16x32_bf16 a[108:111], v[240:243], v[228:231], a[108:111]
    buffer_load_dwordx4 v[240:243], v18, s[12:15], s32 offen
    v_mfma_f32_16x16x32_bf16 a[12:15], v[244:247], v[208:211], a[12:15]
    v_mfma_f32_16x16x32_bf16 a[32:35], v[244:247], v[212:215], a[32:35]
    v_mfma_f32_16x16x32_bf16 a[52:55], v[244:247], v[216:219], a[52:55]
    v_mfma_f32_16x16x32_bf16 a[72:75], v[244:247], v[220:223], a[72:75]
    v_mfma_f32_16x16x32_bf16 a[92:95], v[244:247], v[224:227], a[92:95]
    v_mfma_f32_16x16x32_bf16 a[112:115], v[244:247], v[228:231], a[112:115]
    buffer_load_dwordx4 v[244:247], v19, s[12:15], s32 offen
    v_mfma_f32_16x16x32_bf16 a[16:19], v[248:251], v[208:211], a[16:19]
    v_mfma_f32_16x16x32_bf16 a[36:39], v[248:251], v[212:215], a[36:39]
    v_mfma_f32_16x16x32_bf16 a[56:59], v[248:251], v[216:219], a[56:59]
    v_mfma_f32_16x16x32_bf16 a[76:79], v[248:251], v[220:223], a[76:79]
    v_mfma_f32_16x16x32_bf16 a[96:99], v[248:251], v[224:227], a[96:99]
    v_mfma_f32_16x16x32_bf16 a[116:119], v[248:251], v[228:231], a[116:119]
    buffer_load_dwordx4 v[248:251], v20, s[12:15], s32 offen
    s_waitcnt vmcnt(32)
    s_add_u32 s32, s32, 1024
    v_mfma_f32_16x16x32_bf16 a[0:3], v[56:59], v[32:35], a[0:3]
    v_mfma_f32_16x16x32_bf16 a[20:23], v[56:59], v[36:39], a[20:23]
    v_mfma_f32_16x16x32_bf16 a[40:43], v[56:59], v[40:43], a[40:43]
    v_mfma_f32_16x16x32_bf16 a[60:63], v[56:59], v[44:47], a[60:63]
    v_mfma_f32_16x16x32_bf16 a[80:83], v[56:59], v[48:51], a[80:83]
    v_mfma_f32_16x16x32_bf16 a[100:103], v[56:59], v[52:55], a[100:103]
    buffer_load_dwordx4 v[56:59], v16, s[12:15], s32 offen
    v_mfma_f32_16x16x32_bf16 a[4:7], v[60:63], v[32:35], a[4:7]
    v_mfma_f32_16x16x32_bf16 a[24:27], v[60:63], v[36:39], a[24:27]
    v_mfma_f32_16x16x32_bf16 a[44:47], v[60:63], v[40:43], a[44:47]
    v_mfma_f32_16x16x32_bf16 a[64:67], v[60:63], v[44:47], a[64:67]
    v_mfma_f32_16x16x32_bf16 a[84:87], v[60:63], v[48:51], a[84:87]
    v_mfma_f32_16x16x32_bf16 a[104:107], v[60:63], v[52:55], a[104:107]
    buffer_load_dwordx4 v[60:63], v17, s[12:15], s32 offen
    v_mfma_f32_16x16x32_bf16 a[8:11], v[64:67], v[32:35], a[8:11]
    v_mfma_f32_16x16x32_bf16 a[28:31], v[64:67], v[36:39], a[28:31]
    v_mfma_f32_16x16x32_bf16 a[48:51], v[64:67], v[40:43], a[48:51]
    v_mfma_f32_16x16x32_bf16 a[68:71], v[64:67], v[44:47], a[68:71]
    v_mfma_f32_16x16x32_bf16 a[88:91], v[64:67], v[48:51], a[88:91]
    v_mfma_f32_16x16x32_bf16 a[108:111], v[64:67], v[52:55], a[108:111]
    buffer_load_dwordx4 v[64:67], v18, s[12:15], s32 offen
    v_mfma_f32_16x16x32_bf16 a[12:15], v[68:71], v[32:35], a[12:15]
    v_mfma_f32_16x16x32_bf16 a[32:35], v[68:71], v[36:39], a[32:35]
    v_mfma_f32_16x16x32_bf16 a[52:55], v[68:71], v[40:43], a[52:55]
    v_mfma_f32_16x16x32_bf16 a[72:75], v[68:71], v[44:47], a[72:75]
    v_mfma_f32_16x16x32_bf16 a[92:95], v[68:71], v[48:51], a[92:95]
    v_mfma_f32_16x16x32_bf16 a[112:115], v[68:71], v[52:55], a[112:115]
    buffer_load_dwordx4 v[68:71], v19, s[12:15], s32 offen
    v_mfma_f32_16x16x32_bf16 a[16:19], v[72:75], v[32:35], a[16:19]
    v_mfma_f32_16x16x32_bf16 a[36:39], v[72:75], v[36:39], a[36:39]
    v_mfma_f32_16x16x32_bf16 a[56:59], v[72:75], v[40:43], a[56:59]
    v_mfma_f32_16x16x32_bf16 a[76:79], v[72:75], v[44:47], a[76:79]
    v_mfma_f32_16x16x32_bf16 a[96:99], v[72:75], v[48:51], a[96:99]
    v_mfma_f32_16x16x32_bf16 a[116:119], v[72:75], v[52:55], a[116:119]
    buffer_load_dwordx4 v[72:75], v20, s[12:15], s32 offen
    s_waitcnt vmcnt(26)
    buffer_load_dword v25, v0, s[8:11], 0 offen sc1
    s_add_u32 s32, s32, 1024
    v_mfma_f32_16x16x32_bf16 a[0:3], v[100:103], v[76:79], a[0:3]
    v_mfma_f32_16x16x32_bf16 a[20:23], v[100:103], v[80:83], a[20:23]
    v_mfma_f32_16x16x32_bf16 a[40:43], v[100:103], v[84:87], a[40:43]
    v_mfma_f32_16x16x32_bf16 a[60:63], v[100:103], v[88:91], a[60:63]
    v_mfma_f32_16x16x32_bf16 a[80:83], v[100:103], v[92:95], a[80:83]
    v_mfma_f32_16x16x32_bf16 a[100:103], v[100:103], v[96:99], a[100:103]
    buffer_load_dwordx4 v[100:103], v16, s[12:15], s32 offen
    v_mfma_f32_16x16x32_bf16 a[4:7], v[104:107], v[76:79], a[4:7]
    v_mfma_f32_16x16x32_bf16 a[24:27], v[104:107], v[80:83], a[24:27]
    v_mfma_f32_16x16x32_bf16 a[44:47], v[104:107], v[84:87], a[44:47]
    v_mfma_f32_16x16x32_bf16 a[64:67], v[104:107], v[88:91], a[64:67]
    v_mfma_f32_16x16x32_bf16 a[84:87], v[104:107], v[92:95], a[84:87]
    v_mfma_f32_16x16x32_bf16 a[104:107], v[104:107], v[96:99], a[104:107]
    buffer_load_dwordx4 v[104:107], v17, s[12:15], s32 offen
    v_mfma_f32_16x16x32_bf16 a[8:11], v[108:111], v[76:79], a[8:11]
    v_mfma_f32_16x16x32_bf16 a[28:31], v[108:111], v[80:83], a[28:31]
    v_mfma_f32_16x16x32_bf16 a[48:51], v[108:111], v[84:87], a[48:51]
    v_mfma_f32_16x16x32_bf16 a[68:71], v[108:111], v[88:91], a[68:71]
    v_mfma_f32_16x16x32_bf16 a[88:91], v[108:111], v[92:95], a[88:91]
    v_mfma_f32_16x16x32_bf16 a[108:111], v[108:111], v[96:99], a[108:111]
    buffer_load_dwordx4 v[108:111], v18, s[12:15], s32 offen
    v_mfma_f32_16x16x32_bf16 a[12:15], v[112:115], v[76:79], a[12:15]
    v_mfma_f32_16x16x32_bf16 a[32:35], v[112:115], v[80:83], a[32:35]
    v_mfma_f32_16x16x32_bf16 a[52:55], v[112:115], v[84:87], a[52:55]
    v_mfma_f32_16x16x32_bf16 a[72:75], v[112:115], v[88:91], a[72:75]
    v_mfma_f32_16x16x32_bf16 a[92:95], v[112:115], v[92:95], a[92:95]
    v_mfma_f32_16x16x32_bf16 a[112:115], v[112:115], v[96:99], a[112:115]
    buffer_load_dwordx4 v[112:115], v19, s[12:15], s32 offen
    v_mfma_f32_16x16x32_bf16 a[16:19], v[116:119], v[76:79], a[16:19]
    v_mfma_f32_16x16x32_bf16 a[36:39], v[116:119], v[80:83], a[36:39]
    v_mfma_f32_16x16x32_bf16 a[56:59], v[116:119], v[84:87], a[56:59]
    v_mfma_f32_16x16x32_bf16 a[76:79], v[116:119], v[88:91], a[76:79]
    v_mfma_f32_16x16x32_bf16 a[96:99], v[116:119], v[92:95], a[96:99]
    v_mfma_f32_16x16x32_bf16 a[116:119], v[116:119], v[96:99], a[116:119]
    buffer_load_dwordx4 v[116:119], v20, s[12:15], s32 offen
    s_waitcnt vmcnt(21)
    s_add_u32 s32, s32, 1024
    v_mfma_f32_16x16x32_bf16 a[0:3], v[144:147], v[120:123], a[0:3]
    v_mfma_f32_16x16x32_bf16 a[20:23], v[144:147], v[124:127], a[20:23]
    v_mfma_f32_16x16x32_bf16 a[40:43], v[144:147], v[128:131], a[40:43]
    v_mfma_f32_16x16x32_bf16 a[60:63], v[144:147], v[132:135], a[60:63]
    v_mfma_f32_16x16x32_bf16 a[80:83], v[144:147], v[136:139], a[80:83]
    v_mfma_f32_16x16x32_bf16 a[100:103], v[144:147], v[140:143], a[100:103]
    buffer_load_dwordx4 v[144:147], v16, s[12:15], s32 offen
    v_mfma_f32_16x16x32_bf16 a[4:7], v[148:151], v[120:123], a[4:7]
    v_mfma_f32_16x16x32_bf16 a[24:27], v[148:151], v[124:127], a[24:27]
    v_mfma_f32_16x16x32_bf16 a[44:47], v[148:151], v[128:131], a[44:47]
    v_mfma_f32_16x16x32_bf16 a[64:67], v[148:151], v[132:135], a[64:67]
    v_mfma_f32_16x16x32_bf16 a[84:87], v[148:151], v[136:139], a[84:87]
    v_mfma_f32_16x16x32_bf16 a[104:107], v[148:151], v[140:143], a[104:107]
    buffer_load_dwordx4 v[148:151], v17, s[12:15], s32 offen
    v_mfma_f32_16x16x32_bf16 a[8:11], v[152:155], v[120:123], a[8:11]
    v_mfma_f32_16x16x32_bf16 a[28:31], v[152:155], v[124:127], a[28:31]
    v_mfma_f32_16x16x32_bf16 a[48:51], v[152:155], v[128:131], a[48:51]
    v_mfma_f32_16x16x32_bf16 a[68:71], v[152:155], v[132:135], a[68:71]
    v_mfma_f32_16x16x32_bf16 a[88:91], v[152:155], v[136:139], a[88:91]
    v_mfma_f32_16x16x32_bf16 a[108:111], v[152:155], v[140:143], a[108:111]
    buffer_load_dwordx4 v[152:155], v18, s[12:15], s32 offen
    v_mfma_f32_16x16x32_bf16 a[12:15], v[156:159], v[120:123], a[12:15]
    v_mfma_f32_16x16x32_bf16 a[32:35], v[156:159], v[124:127], a[32:35]
    v_mfma_f32_16x16x32_bf16 a[52:55], v[156:159], v[128:131], a[52:55]
    v_mfma_f32_16x16x32_bf16 a[72:75], v[156:159], v[132:135], a[72:75]
    v_mfma_f32_16x16x32_bf16 a[92:95], v[156:159], v[136:139], a[92:95]
    v_mfma_f32_16x16x32_bf16 a[112:115], v[156:159], v[140:143], a[112:115]
    buffer_load_dwordx4 v[156:159], v19, s[12:15], s32 offen
    v_mfma_f32_16x16x32_bf16 a[16:19], v[160:163], v[120:123], a[16:19]
    v_mfma_f32_16x16x32_bf16 a[36:39], v[160:163], v[124:127], a[36:39]
    v_mfma_f32_16x16x32_bf16 a[56:59], v[160:163], v[128:131], a[56:59]
    v_mfma_f32_16x16x32_bf16 a[76:79], v[160:163], v[132:135], a[76:79]
    v_mfma_f32_16x16x32_bf16 a[96:99], v[160:163], v[136:139], a[96:99]
    v_mfma_f32_16x16x32_bf16 a[116:119], v[160:163], v[140:143], a[116:119]
    buffer_load_dwordx4 v[160:163], v20, s[12:15], s32 offen
    s_cmp_ge_u32 s28, 2
    s_cselect_b32 s34, 1, 0
    s_add_u32 s34, s34, s28
    s_mul_i32 s42, s29, 6
    s_add_u32 s42, s42, s34
    s_add_u32 s42, s42, 0
    s_lshl_b32 s43, s42, 4
    v_lshrrev_b32 v2, 2, v1
    v_add_u32 v2, s43, v2
    v_bfe_u32 v3, v2, 9, 1
    v_lshlrev_b32 v3, 4, v3
    v_bfe_u32 v4, v2, 2, 1
    v_lshlrev_b32 v4, 3, v4
    v_add_u32 v3, v3, v4
    v_bfe_u32 v4, v2, 8, 1
    v_lshlrev_b32 v4, 2, v4
    v_add_u32 v3, v3, v4
    v_and_b32 v4, 3, v2
    v_add_u32 v3, v3, v4
    v_lshlrev_b32 v3, 6, v3
    v_bfe_u32 v4, v2, 10, 1
    v_lshlrev_b32 v4, 5, v4
    v_add_u32 v3, v3, v4
    v_bfe_u32 v4, v2, 3, 5
    v_add_u32 v3, v3, v4
    v_mul_u32_u24 v3, 1280, v3
    s_mul_i32 s43, s30, 160
    v_and_b32 v4, 3, v1
    v_lshlrev_b32 v4, 3, v4
    v_add_u32 v3, v3, v4
    v_add_u32 v22, s43, v3
    s_cmp_lt_u32 s42, 128
    s_cselect_b32 s43, 0, 0x7f000000
    v_add_u32 v22, s43, v22
    s_mul_i32 s42, s29, 6
    s_add_u32 s42, s42, s34
    s_add_u32 s42, s42, 1
    s_lshl_b32 s43, s42, 4
    v_lshrrev_b32 v2, 2, v1
    v_add_u32 v2, s43, v2
    v_bfe_u32 v3, v2, 9, 1
    v_lshlrev_b32 v3, 4, v3
    v_bfe_u32 v4, v2, 2, 1
    v_lshlrev_b32 v4, 3, v4
    v_add_u32 v3, v3, v4
    v_bfe_u32 v4, v2, 8, 1
    v_lshlrev_b32 v4, 2, v4
    v_add_u32 v3, v3, v4
    v_and_b32 v4, 3, v2
    v_add_u32 v3, v3, v4
    v_lshlrev_b32 v3, 6, v3
    v_bfe_u32 v4, v2, 10, 1
    v_lshlrev_b32 v4, 5, v4
    v_add_u32 v3, v3, v4
    v_bfe_u32 v4, v2, 3, 5
    v_add_u32 v3, v3, v4
    v_mul_u32_u24 v3, 1280, v3
    s_mul_i32 s43, s30, 160
    v_and_b32 v4, 3, v1
    v_lshlrev_b32 v4, 3, v4
    v_add_u32 v3, v3, v4
    v_add_u32 v23, s43, v3
    s_cmp_lt_u32 s42, 128
    s_cselect_b32 s43, 0, 0x7f000000
    v_add_u32 v23, s43, v23
    s_mul_i32 s42, s29, 6
    s_add_u32 s42, s42, s34
    s_add_u32 s42, s42, 2
    s_lshl_b32 s43, s42, 4
    v_lshrrev_b32 v2, 2, v1
    v_add_u32 v2, s43, v2
    v_bfe_u32 v3, v2, 9, 1
    v_lshlrev_b32 v3, 4, v3
    v_bfe_u32 v4, v2, 2, 1
    v_lshlrev_b32 v4, 3, v4
    v_add_u32 v3, v3, v4
    v_bfe_u32 v4, v2, 8, 1
    v_lshlrev_b32 v4, 2, v4
    v_add_u32 v3, v3, v4
    v_and_b32 v4, 3, v2
    v_add_u32 v3, v3, v4
    v_lshlrev_b32 v3, 6, v3
    v_bfe_u32 v4, v2, 10, 1
    v_lshlrev_b32 v4, 5, v4
    v_add_u32 v3, v3, v4
    v_bfe_u32 v4, v2, 3, 5
    v_add_u32 v3, v3, v4
    v_mul_u32_u24 v3, 1280, v3
    s_mul_i32 s43, s30, 160
    v_and_b32 v4, 3, v1
    v_lshlrev_b32 v4, 3, v4
    v_add_u32 v3, v3, v4
    v_add_u32 v24, s43, v3
    s_cmp_lt_u32 s42, 128
    s_cselect_b32 s43, 0, 0x7f000000
    v_add_u32 v24, s43, v24
    v_and_b32 v2, 15, v1
    v_lshrrev_b32 v3, 4, v1
    v_bfe_u32 v4, v2, 1, 2
    v_xor_b32 v3, v3, v4
    v_lshlrev_b32 v2, 2, v2
    v_add_u32 v28, v2, v3
    v_lshlrev_b32 v28, 4, v28
    s_lshl_b32 s42, s28, 13
    v_add_u32 v28, s42, v28
    v_add_u32 v30, 65536, v28
    v_lshrrev_b32 v2, 2, v1
    v_and_b32 v3, 3, v1
    v_bfe_u32 v4, v2, 1, 2
    v_xor_b32 v3, v3, v4
    v_lshlrev_b32 v2, 2, v2
    v_add_u32 v29, v2, v3
    v_lshlrev_b32 v29, 4, v29
    s_lshl_b32 s42, s28, 15
    v_add_u32 v29, s42, v29
    s_waitcnt vmcnt(10)
    s_mov_b32 s42, 0
L_kg_pollb:
    v_readfirstlane_b32 s44, v25
    s_nop 0
    s_cmp_ge_u32 s44, 20
    s_cbranch_scc1 L_kg_gob
    s_add_u32 s42, s42, 1
    s_cmp_ge_u32 s42, 65536
    s_cbranch_scc1 L_kg_gob
    s_sleep 2
    buffer_load_dword v25, v0, s[8:11], 0 offen sc1
    s_waitcnt vmcnt(0)
    s_branch L_kg_pollb
L_kg_gob:
    s_add_u32 s31, s41, 55296
    buffer_load_dwordx4 v[164:167], v5, s[8:11], s31 offen sc1
    buffer_load_dwordx4 v[168:171], v6, s[8:11], s31 offen sc1
    buffer_load_dwordx4 v[172:175], v7, s[8:11], s31 offen sc1
    buffer_load_dwordx4 v[176:179], v8, s[8:11], s31 offen sc1
    buffer_load_dwordx4 v[180:183], v9, s[8:11], s31 offen sc1
    buffer_load_dwordx4 v[184:187], v10, s[8:11], s31 offen sc1
    s_add_u32 s31, s31, 1024
    buffer_load_dwordx4 v[208:211], v5, s[8:11], s31 offen sc1
    buffer_load_dwordx4 v[212:215], v6, s[8:11], s31 offen sc1
    buffer_load_dwordx4 v[216:219], v7, s[8:11], s31 offen sc1
    buffer_load_dwordx4 v[220:223], v8, s[8:11], s31 offen sc1
    buffer_load_dwordx4 v[224:227], v9, s[8:11], s31 offen sc1
    buffer_load_dwordx4 v[228:231], v10, s[8:11], s31 offen sc1
    s_add_u32 s31, s31, 1024
    buffer_load_dwordx4 v[32:35], v5, s[8:11], s31 offen sc1
    buffer_load_dwordx4 v[36:39], v6, s[8:11], s31 offen sc1
    buffer_load_dwordx4 v[40:43], v7, s[8:11], s31 offen sc1
    buffer_load_dwordx4 v[44:47], v8, s[8:11], s31 offen sc1
    buffer_load_dwordx4 v[48:51], v9, s[8:11], s31 offen sc1
    buffer_load_dwordx4 v[52:55], v10, s[8:11], s31 offen sc1
    s_add_u32 s31, s31, 1024
    buffer_load_dwordx4 v[76:79], v5, s[8:11], s31 offen sc1
    buffer_load_dwordx4 v[80:83], v6, s[8:11], s31 offen sc1
    buffer_load_dwordx4 v[84:87], v7, s[8:11], s31 offen sc1
    buffer_load_dwordx4 v[88:91], v8, s[8:11], s31 offen sc1
    buffer_load_dwordx4 v[92:95], v9, s[8:11], s31 offen sc1
    buffer_load_dwordx4 v[96:99], v10, s[8:11], s31 offen sc1
    s_add_u32 s31, s31, 1024
    buffer_load_dwordx4 v[120:123], v5, s[8:11], s31 offen sc1
    buffer_load_dwordx4 v[124:127], v6, s[8:11], s31 offen sc1
    buffer_load_dwordx4 v[128:131], v7, s[8:11], s31 offen sc1
    buffer_load_dwordx4 v[132:135], v8, s[8:11], s31 offen sc1
    buffer_load_dwordx4 v[136:139], v9, s[8:11], s31 offen sc1
    buffer_load_dwordx4 v[140:143], v10, s[8:11], s31 offen sc1
    s_waitcnt vmcnt(24)
    v_mfma_f32_16x16x32_bf16 a[0:3], v[188:191], v[164:167], a[0:3]
    v_mfma_f32_16x16x32_bf16 a[20:23], v[188:191], v[168:171], a[20:23]
    v_mfma_f32_16x16x32_bf16 a[40:43], v[188:191], v[172:175], a[40:43]
    v_mfma_f32_16x16x32_bf16 a[60:63], v[188:191], v[176:179], a[60:63]
    v_mfma_f32_16x16x32_bf16 a[80:83], v[188:191], v[180:183], a[80:83]
    v_mfma_f32_16x16x32_bf16 a[100:103], v[188:191], v[184:187], a[100:103]
    v_mfma_f32_16x16x32_bf16 a[4:7], v[192:195], v[164:167], a[4:7]
    v_mfma_f32_16x16x32_bf16 a[24:27], v[192:195], v[168:171], a[24:27]
    v_mfma_f32_16x16x32_bf16 a[44:47], v[192:195], v[172:175], a[44:47]
    v_mfma_f32_16x16x32_bf16 a[64:67], v[192:195], v[176:179], a[64:67]
    v_mfma_f32_16x16x32_bf16 a[84:87], v[192:195], v[180:183], a[84:87]
    v_mfma_f32_16x16x32_bf16 a[104:107], v[192:195], v[184:187], a[104:107]
    v_mfma_f32_16x16x32_bf16 a[8:11], v[196:199], v[164:167], a[8:11]
    v_mfma_f32_16x16x32_bf16 a[28:31], v[196:199], v[168:171], a[28:31]
    v_mfma_f32_16x16x32_bf16 a[48:51], v[196:199], v[172:175], a[48:51]
    v_mfma_f32_16x16x32_bf16 a[68:71], v[196:199], v[176:179], a[68:71]
    v_mfma_f32_16x16x32_bf16 a[88:91], v[196:199], v[180:183], a[88:91]
    v_mfma_f32_16x16x32_bf16 a[108:111], v[196:199], v[184:187], a[108:111]
    v_mfma_f32_16x16x32_bf16 a[12:15], v[200:203], v[164:167], a[12:15]
    v_mfma_f32_16x16x32_bf16 a[32:35], v[200:203], v[168:171], a[32:35]
    v_mfma_f32_16x16x32_bf16 a[52:55], v[200:203], v[172:175], a[52:55]
    v_mfma_f32_16x16x32_bf16 a[72:75], v[200:203], v[176:179], a[72:75]
    v_mfma_f32_16x16x32_bf16 a[92:95], v[200:203], v[180:183], a[92:95]
    v_mfma_f32_16x16x32_bf16 a[112:115], v[200:203], v[184:187], a[112:115]
    v_mfma_f32_16x16x32_bf16 a[16:19], v[204:207], v[164:167], a[16:19]
    v_mfma_f32_16x16x32_bf16 a[36:39], v[204:207], v[168:171], a[36:39]
    v_mfma_f32_16x16x32_bf16 a[56:59], v[204:207], v[172:175], a[56:59]
    v_mfma_f32_16x16x32_bf16 a[76:79], v[204:207], v[176:179], a[76:79]
    v_mfma_f32_16x16x32_bf16 a[96:99], v[204:207], v[180:183], a[96:99]
    v_mfma_f32_16x16x32_bf16 a[116:119], v[204:207], v[184:187], a[116:119]
    s_waitcnt vmcnt(18)
    v_mfma_f32_16x16x32_bf16 a[0:3], v[232:235], v[208:211], a[0:3]
    v_mfma_f32_16x16x32_bf16 a[20:23], v[232:235], v[212:215], a[20:23]
    v_mfma_f32_16x16x32_bf16 a[40:43], v[232:235], v[216:219], a[40:43]
    v_mfma_f32_16x16x32_bf16 a[60:63], v[232:235], v[220:223], a[60:63]
    v_mfma_f32_16x16x32_bf16 a[80:83], v[232:235], v[224:227], a[80:83]
    v_mfma_f32_16x16x32_bf16 a[100:103], v[232:235], v[228:231], a[100:103]
    v_mfma_f32_16x16x32_bf16 a[4:7], v[236:239], v[208:211], a[4:7]
    v_mfma_f32_16x16x32_bf16 a[24:27], v[236:239], v[212:215], a[24:27]
    v_mfma_f32_16x16x32_bf16 a[44:47], v[236:239], v[216:219], a[44:47]
    v_mfma_f32_16x16x32_bf16 a[64:67], v[236:239], v[220:223], a[64:67]
    v_mfma_f32_16x16x32_bf16 a[84:87], v[236:239], v[224:227], a[84:87]
    v_mfma_f32_16x16x32_bf16 a[104:107], v[236:239], v[228:231], a[104:107]
    v_mfma_f32_16x16x32_bf16 a[8:11], v[240:243], v[208:211], a[8:11]
    v_mfma_f32_16x16x32_bf16 a[28:31], v[240:243], v[212:215], a[28:31]
    v_mfma_f32_16x16x32_bf16 a[48:51], v[240:243], v[216:219], a[48:51]
    v_mfma_f32_16x16x32_bf16 a[68:71], v[240:243], v[220:223], a[68:71]
    v_mfma_f32_16x16x32_bf16 a[88:91], v[240:243], v[224:227], a[88:91]
    v_mfma_f32_16x16x32_bf16 a[108:111], v[240:243], v[228:231], a[108:111]
    v_mfma_f32_16x16x32_bf16 a[12:15], v[244:247], v[208:211], a[12:15]
    v_mfma_f32_16x16x32_bf16 a[32:35], v[244:247], v[212:215], a[32:35]
    v_mfma_f32_16x16x32_bf16 a[52:55], v[244:247], v[216:219], a[52:55]
    v_mfma_f32_16x16x32_bf16 a[72:75], v[244:247], v[220:223], a[72:75]
    v_mfma_f32_16x16x32_bf16 a[92:95], v[244:247], v[224:227], a[92:95]
    v_mfma_f32_16x16x32_bf16 a[112:115], v[244:247], v[228:231], a[112:115]
    v_mfma_f32_16x16x32_bf16 a[16:19], v[248:251], v[208:211], a[16:19]
    v_mfma_f32_16x16x32_bf16 a[36:39], v[248:251], v[212:215], a[36:39]
    v_mfma_f32_16x16x32_bf16 a[56:59], v[248:251], v[216:219], a[56:59]
    v_mfma_f32_16x16x32_bf16 a[76:79], v[248:251], v[220:223], a[76:79]
    v_mfma_f32_16x16x32_bf16 a[96:99], v[248:251], v[224:227], a[96:99]
    v_mfma_f32_16x16x32_bf16 a[116:119], v[248:251], v[228:231], a[116:119]
    s_cmp_eq_u32 s28, 2
    s_cbranch_scc0 L_kg_x1b
    buffer_load_dwordx2 v[164:165], v22, s[16:19], 0 offen offset:32
    buffer_load_dwordx2 v[166:167], v22, s[16:19], 0 offen offset:64
    buffer_load_dwordx2 v[168:169], v22, s[16:19], 0 offen offset:96
    buffer_load_dwordx2 v[170:171], v22, s[16:19], 0 offen offset:128
    buffer_load_dwordx2 v[172:173], v23, s[16:19], 0 offen offset:0
    buffer_load_dwordx2 v[174:175], v23, s[16:19], 0 offen offset:32
    buffer_load_dwordx2 v[176:177], v23, s[16:19], 0 offen offset:64
    buffer_load_dwordx2 v[176:177], v23, s[16:19], 0 offen offset:64
    s_branch L_kg_x2b
L_kg_x1b:
    buffer_load_dwordx2 v[164:165], v22, s[16:19], 0 offen offset:96
    buffer_load_dwordx2 v[166:167], v22, s[16:19], 0 offen offset:128
    buffer_load_dwordx2 v[168:169], v23, s[16:19], 0 offen offset:0
    buffer_load_dwordx2 v[170:171], v23, s[16:19], 0 offen offset:32
    buffer_load_dwordx2 v[172:173], v23, s[16:19], 0 offen offset:64
    buffer_load_dwordx2 v[174:175], v23, s[16:19], 0 offen offset:96
    buffer_load_dwordx2 v[176:177], v23, s[16:19], 0 offen offset:128
    buffer_load_dwordx2 v[176:177], v23, s[16:19], 0 offen offset:128
L_kg_x2b:
    s_waitcnt vmcnt(20)
    v_mfma_f32_16x16x32_bf16 a[0:3], v[56:59], v[32:35], a[0:3]
    v_mfma_f32_16x16x32_bf16 a[20:23], v[56:59], v[36:39], a[20:23]
    v_mfma_f32_16x16x32_bf16 a[40:43], v[56:59], v[40:43], a[40:43]
    v_mfma_f32_16x16x32_bf16 a[60:63], v[56:59], v[44:47], a[60:63]
    v_mfma_f32_16x16x32_bf16 a[80:83], v[56:59], v[48:51], a[80:83]
    v_mfma_f32_16x16x32_bf16 a[100:103], v[56:59], v[52:55], a[100:103]
    v_mfma_f32_16x16x32_bf16 a[4:7], v[60:63], v[32:35], a[4:7]
    v_mfma_f32_16x16x32_bf16 a[24:27], v[60:63], v[36:39], a[24:27]
    v_mfma_f32_16x16x32_bf16 a[44:47], v[60:63], v[40:43], a[44:47]
    v_mfma_f32_16x16x32_bf16 a[64:67], v[60:63], v[44:47], a[64:67]
    v_mfma_f32_16x16x32_bf16 a[84:87], v[60:63], v[48:51], a[84:87]
    v_mfma_f32_16x16x32_bf16 a[104:107], v[60:63], v[52:55], a[104:107]
    v_mfma_f32_16x16x32_bf16 a[8:11], v[64:67], v[32:35], a[8:11]
    v_mfma_f32_16x16x32_bf16 a[28:31], v[64:67], v[36:39], a[28:31]
    v_mfma_f32_16x16x32_bf16 a[48:51], v[64:67], v[40:43], a[48:51]
    v_mfma_f32_16x16x32_bf16 a[68:71], v[64:67], v[44:47], a[68:71]
    v_mfma_f32_16x16x32_bf16 a[88:91], v[64:67], v[48:51], a[88:91]
    v_mfma_f32_16x16x32_bf16 a[108:111], v[64:67], v[52:55], a[108:111]
    v_mfma_f32_16x16x32_bf16 a[12:15], v[68:71], v[32:35], a[12:15]
    v_mfma_f32_16x16x32_bf16 a[32:35], v[68:71], v[36:39], a[32:35]
    v_mfma_f32_16x16x32_bf16 a[52:55], v[68:71], v[40:43], a[52:55]
    v_mfma_f32_16x16x32_bf16 a[72:75], v[68:71], v[44:47], a[72:75]
    v_mfma_f32_16x16x32_bf16 a[92:95], v[68:71], v[48:51], a[92:95]
    v_mfma_f32_16x16x32_bf16 a[112:115], v[68:71], v[52:55], a[112:115]
    v_mfma_f32_16x16x32_bf16 a[16:19], v[72:75], v[32:35], a[16:19]
    v_mfma_f32_16x16x32_bf16 a[36:39], v[72:75], v[36:39], a[36:39]
    v_mfma_f32_16x16x32_bf16 a[56:59], v[72:75], v[40:43], a[56:59]
    v_mfma_f32_16x16x32_bf16 a[76:79], v[72:75], v[44:47], a[76:79]
    v_mfma_f32_16x16x32_bf16 a[96:99], v[72:75], v[48:51], a[96:99]
    v_mfma_f32_16x16x32_bf16 a[116:119], v[72:75], v[52:55], a[116:119]
    s_waitcnt vmcnt(14)
    v_mfma_f32_16x16x32_bf16 a[0:3], v[100:103], v[76:79], a[0:3]
    v_mfma_f32_16x16x32_bf16 a[20:23], v[100:103], v[80:83], a[20:23]
    v_mfma_f32_16x16x32_bf16 a[40:43], v[100:103], v[84:87], a[40:43]
    v_mfma_f32_16x16x32_bf16 a[60:63], v[100:103], v[88:91], a[60:63]
    v_mfma_f32_16x16x32_bf16 a[80:83], v[100:103], v[92:95], a[80:83]
    v_mfma_f32_16x16x32_bf16 a[100:103], v[100:103], v[96:99], a[100:103]
    v_mfma_f32_16x16x32_bf16 a[4:7], v[104:107], v[76:79], a[4:7]
    v_mfma_f32_16x16x32_bf16 a[24:27], v[104:107], v[80:83], a[24:27]
    v_mfma_f32_16x16x32_bf16 a[44:47], v[104:107], v[84:87], a[44:47]
    v_mfma_f32_16x16x32_bf16 a[64:67], v[104:107], v[88:91], a[64:67]
    v_mfma_f32_16x16x32_bf16 a[84:87], v[104:107], v[92:95], a[84:87]
    v_mfma_f32_16x16x32_bf16 a[104:107], v[104:107], v[96:99], a[104:107]
    v_mfma_f32_16x16x32_bf16 a[8:11], v[108:111], v[76:79], a[8:11]
    v_mfma_f32_16x16x32_bf16 a[28:31], v[108:111], v[80:83], a[28:31]
    v_mfma_f32_16x16x32_bf16 a[48:51], v[108:111], v[84:87], a[48:51]
    v_mfma_f32_16x16x32_bf16 a[68:71], v[108:111], v[88:91], a[68:71]
    v_mfma_f32_16x16x32_bf16 a[88:91], v[108:111], v[92:95], a[88:91]
    v_mfma_f32_16x16x32_bf16 a[108:111], v[108:111], v[96:99], a[108:111]
    v_mfma_f32_16x16x32_bf16 a[12:15], v[112:115], v[76:79], a[12:15]
    v_mfma_f32_16x16x32_bf16 a[32:35], v[112:115], v[80:83], a[32:35]
    v_mfma_f32_16x16x32_bf16 a[52:55], v[112:115], v[84:87], a[52:55]
    v_mfma_f32_16x16x32_bf16 a[72:75], v[112:115], v[88:91], a[72:75]
    v_mfma_f32_16x16x32_bf16 a[92:95], v[112:115], v[92:95], a[92:95]
    v_mfma_f32_16x16x32_bf16 a[112:115], v[112:115], v[96:99], a[112:115]
    v_mfma_f32_16x16x32_bf16 a[16:19], v[116:119], v[76:79], a[16:19]
    v_mfma_f32_16x16x32_bf16 a[36:39], v[116:119], v[80:83], a[36:39]
    v_mfma_f32_16x16x32_bf16 a[56:59], v[116:119], v[84:87], a[56:59]
    v_mfma_f32_16x16x32_bf16 a[76:79], v[116:119], v[88:91], a[76:79]
    v_mfma_f32_16x16x32_bf16 a[96:99], v[116:119], v[92:95], a[96:99]
    v_mfma_f32_16x16x32_bf16 a[116:119], v[116:119], v[96:99], a[116:119]
    s_waitcnt vmcnt(8)
    v_mfma_f32_16x16x32_bf16 a[0:3], v[144:147], v[120:123], a[0:3]
    v_mfma_f32_16x16x32_bf16 a[20:23], v[144:147], v[124:127], a[20:23]
    v_mfma_f32_16x16x32_bf16 a[40:43], v[144:147], v[128:131], a[40:43]
    v_mfma_f32_16x16x32_bf16 a[60:63], v[144:147], v[132:135], a[60:63]
    v_mfma_f32_16x16x32_bf16 a[80:83], v[144:147], v[136:139], a[80:83]
    v_mfma_f32_16x16x32_bf16 a[100:103], v[144:147], v[140:143], a[100:103]
    v_mfma_f32_16x16x32_bf16 a[4:7], v[148:151], v[120:123], a[4:7]
    s_nop 1
    ds_write_b128 v28, a[0:3] offset:0
    v_mfma_f32_16x16x32_bf16 a[24:27], v[148:151], v[124:127], a[24:27]
    ds_write_b128 v28, a[20:23] offset:5120
    v_mfma_f32_16x16x32_bf16 a[44:47], v[148:151], v[128:131], a[44:47]
    ds_write_b128 v28, a[40:43] offset:34816
    v_mfma_f32_16x16x32_bf16 a[64:67], v[148:151], v[132:135], a[64:67]
    ds_write_b128 v28, a[60:63] offset:39936
    v_mfma_f32_16x16x32_bf16 a[84:87], v[148:151], v[136:139], a[84:87]
    ds_write_b128 v30, a[80:83] offset:4096
    v_mfma_f32_16x16x32_bf16 a[104:107], v[148:151], v[140:143], a[104:107]
    ds_write_b128 v30, a[100:103] offset:34816
    v_mfma_f32_16x16x32_bf16 a[8:11], v[152:155], v[120:123], a[8:11]
    ds_write_b128 v28, a[4:7] offset:1024
    v_mfma_f32_16x16x32_bf16 a[28:31], v[152:155], v[124:127], a[28:31]
    ds_write_b128 v28, a[24:27] offset:6144
    v_mfma_f32_16x16x32_bf16 a[48:51], v[152:155], v[128:131], a[48:51]
    ds_write_b128 v28, a[44:47] offset:35840
    v_mfma_f32_16x16x32_bf16 a[68:71], v[152:155], v[132:135], a[68:71]
    ds_write_b128 v30, a[64:67] offset:0
    v_mfma_f32_16x16x32_bf16 a[88:91], v[152:155], v[136:139], a[88:91]
    ds_write_b128 v30, a[84:87] offset:5120
    v_mfma_f32_16x16x32_bf16 a[108:111], v[152:155], v[140:143], a[108:111]
    ds_write_b128 v30, a[104:107] offset:35840
    v_mfma_f32_16x16x32_bf16 a[12:15], v[156:159], v[120:123], a[12:15]
    ds_write_b128 v28, a[8:11] offset:2048
    v_mfma_f32_16x16x32_bf16 a[32:35], v[156:159], v[124:127], a[32:35]
    ds_write_b128 v28, a[28:31] offset:7168
    v_mfma_f32_16x16x32_bf16 a[52:55], v[156:159], v[128:131], a[52:55]
    ds_write_b128 v28, a[48:51] offset:36864
    v_mfma_f32_16x16x32_bf16 a[72:75], v[156:159], v[132:135], a[72:75]
    ds_write_b128 v30, a[68:71] offset:1024
    v_mfma_f32_16x16x32_bf16 a[92:95], v[156:159], v[136:139], a[92:95]
    ds_write_b128 v30, a[88:91] offset:6144
    v_mfma_f32_16x16x32_bf16 a[112:115], v[156:159], v[140:143], a[112:115]
    ds_write_b128 v30, a[108:111] offset:36864
    v_mfma_f32_16x16x32_bf16 a[16:19], v[160:163], v[120:123], a[16:19]
    ds_write_b128 v28, a[12:15] offset:3072
    v_mfma_f32_16x16x32_bf16 a[36:39], v[160:163], v[124:127], a[36:39]
    ds_write_b128 v28, a[32:35] offset:32768
    v_mfma_f32_16x16x32_bf16 a[56:59], v[160:163], v[128:131], a[56:59]
    ds_write_b128 v28, a[52:55] offset:37888
    v_mfma_f32_16x16x32_bf16 a[76:79], v[160:163], v[132:135], a[76:79]
    ds_write_b128 v30, a[72:75] offset:2048
    v_mfma_f32_16x16x32_bf16 a[96:99], v[160:163], v[136:139], a[96:99]
    ds_write_b128 v30, a[92:95] offset:32768
    v_mfma_f32_16x16x32_bf16 a[116:119], v[160:163], v[140:143], a[116:119]
    ds_write_b128 v30, a[112:115] offset:37888
    ds_write_b128 v28, a[16:19] offset:4096
    ds_write_b128 v28, a[36:39] offset:33792
    ds_write_b128 v28, a[56:59] offset:38912
    ds_write_b128 v30, a[76:79] offset:3072
    s_nop 0
    ds_write_b128 v30, a[96:99] offset:33792
    s_nop 0
    ds_write_b128 v30, a[116:119] offset:38912
L_kg_red:
    s_cmp_eq_u32 s28, 0
    s_cbranch_scc0 L_kg_e1
    s_waitcnt lgkmcnt(0)
    s_barrier
    ds_read_b128 v[32:35], v29 offset:0
    ds_read_b128 v[64:67], v29 offset:8192
    ds_read_b128 v[96:99], v29 offset:16384
    ds_read_b128 v[128:131], v29 offset:24576
    ds_read_b128 v[36:39], v29 offset:1024
    ds_read_b128 v[68:71], v29 offset:9216
    ds_read_b128 v[100:103], v29 offset:17408
    ds_read_b128 v[132:135], v29 offset:25600
    ds_read_b128 v[40:43], v29 offset:2048
    ds_read_b128 v[72:75], v29 offset:10240
    ds_read_b128 v[104:107], v29 offset:18432
    ds_read_b128 v[136:139], v29 offset:26624
    ds_read_b128 v[44:47], v29 offset:3072
    ds_read_b128 v[76:79], v29 offset:11264
    ds_read_b128 v[108:111], v29 offset:19456
    ds_read_b128 v[140:143], v29 offset:27648
    ds_read_b128 v[48:51], v29 offset:4096
    ds_read_b128 v[80:83], v29 offset:12288
    ds_read_b128 v[112:115], v29 offset:20480
    ds_read_b128 v[144:147], v29 offset:28672
    ds_read_b128 v[52:55], v29 offset:5120
    ds_read_b128 v[84:87], v29 offset:13312
    ds_read_b128 v[116:119], v29 offset:21504
    ds_read_b128 v[148:151], v29 offset:29696
    ds_read_b128 v[56:59], v29 offset:6144
    ds_read_b128 v[88:91], v29 offset:14336
    ds_read_b128 v[120:123], v29 offset:22528
    ds_read_b128 v[152:155], v29 offset:30720
    ds_read_b128 v[60:63], v29 offset:7168
    ds_read_b128 v[92:95], v29 offset:15360
    ds_read_b128 v[124:127], v29 offset:23552
    ds_read_b128 v[156:159], v29 offset:31744
    s_waitcnt vmcnt(0)
    v_lshlrev_b32 v176, 16, v208
    v_and_b32 v177, 0xffff0000, v208
    v_lshlrev_b32 v178, 16, v209
    v_and_b32 v179, 0xffff0000, v209
    v_lshlrev_b32 v180, 16, v210
    v_and_b32 v181, 0xffff0000, v210
    v_lshlrev_b32 v182, 16, v211
    v_and_b32 v183, 0xffff0000, v211
    v_lshlrev_b32 v184, 16, v212
    v_and_b32 v185, 0xffff0000, v212
    v_lshlrev_b32 v186, 16, v213
    v_and_b32 v187, 0xffff0000, v213
    v_lshlrev_b32 v188, 16, v214
    v_and_b32 v189, 0xffff0000, v214
    v_lshlrev_b32 v190, 16, v215
    v_and_b32 v191, 0xffff0000, v215
    v_lshlrev_b32 v192, 16, v216
    v_and_b32 v193, 0xffff0000, v216
    v_lshlrev_b32 v194, 16, v217
    v_and_b32 v195, 0xffff0000, v217
    v_lshlrev_b32 v196, 16, v218
    v_and_b32 v197, 0xffff0000, v218
    v_lshlrev_b32 v198, 16, v219
    v_and_b32 v199, 0xffff0000, v219
    v_lshlrev_b32 v200, 16, v220
    v_and_b32 v201, 0xffff0000, v220
    v_lshlrev_b32 v202, 16, v221
    v_and_b32 v203, 0xffff0000, v221
    v_lshlrev_b32 v204, 16, v222
    v_and_b32 v205, 0xffff0000, v222
    v_lshlrev_b32 v206, 16, v223
    v_and_b32 v207, 0xffff0000, v223
    s_waitcnt lgkmcnt(15)
    v_pk_add_f32 v[176:177], v[176:177], v[32:33]
    v_pk_add_f32 v[176:177], v[176:177], v[64:65]
    v_pk_add_f32 v[176:177], v[176:177], v[96:97]
    v_pk_add_f32 v[176:177], v[176:177], v[128:129]
    v_cvt_pk_bf16_f32 v208, v176, v177
    v_pk_add_f32 v[178:179], v[178:179], v[34:35]
    v_pk_add_f32 v[178:179], v[178:179], v[66:67]
    v_pk_add_f32 v[178:179], v[178:179], v[98:99]
    v_pk_add_f32 v[178:179], v[178:179], v[130:131]
    v_cvt_pk_bf16_f32 v209, v178, v179
    buffer_store_dwordx2 v[208:209], v22, s[20:23], 0 offen offset:0
    s_waitcnt lgkmcnt(15)
    v_pk_add_f32 v[180:181], v[180:181], v[36:37]
    v_pk_add_f32 v[180:181], v[180:181], v[68:69]
    v_pk_add_f32 v[180:181], v[180:181], v[100:101]
    v_pk_add_f32 v[180:181], v[180:181], v[132:133]
    v_cvt_pk_bf16_f32 v210, v180, v181
    v_pk_add_f32 v[182:183], v[182:183], v[38:39]
    v_pk_add_f32 v[182:183], v[182:183], v[70:71]
    v_pk_add_f32 v[182:183], v[182:183], v[102:103]
    v_pk_add_f32 v[182:183], v[182:183], v[134:135]
    v_cvt_pk_bf16_f32 v211, v182, v183
    buffer_store_dwordx2 v[210:211], v22, s[20:23], 0 offen offset:32
    s_waitcnt lgkmcnt(15)
    v_pk_add_f32 v[184:185], v[184:185], v[40:41]
    v_pk_add_f32 v[184:185], v[184:185], v[72:73]
    v_pk_add_f32 v[184:185], v[184:185], v[104:105]
    v_pk_add_f32 v[184:185], v[184:185], v[136:137]
    v_cvt_pk_bf16_f32 v212, v184, v185
    v_pk_add_f32 v[186:187], v[186:187], v[42:43]
    v_pk_add_f32 v[186:187], v[186:187], v[74:75]
    v_pk_add_f32 v[186:187], v[186:187], v[106:107]
    v_pk_add_f32 v[186:187], v[186:187], v[138:139]
    v_cvt_pk_bf16_f32 v213, v186, v187
    buffer_store_dwordx2 v[212:213], v22, s[20:23], 0 offen offset:64
    s_waitcnt lgkmcnt(15)
    v_pk_add_f32 v[188:189], v[188:189], v[44:45]
    v_pk_add_f32 v[188:189], v[188:189], v[76:77]
    v_pk_add_f32 v[188:189], v[188:189], v[108:109]
    v_pk_add_f32 v[188:189], v[188:189], v[140:141]
    v_cvt_pk_bf16_f32 v214, v188, v189
    v_pk_add_f32 v[190:191], v[190:191], v[46:47]
    v_pk_add_f32 v[190:191], v[190:191], v[78:79]
    v_pk_add_f32 v[190:191], v[190:191], v[110:111]
    v_pk_add_f32 v[190:191], v[190:191], v[142:143]
    v_cvt_pk_bf16_f32 v215, v190, v191
    buffer_store_dwordx2 v[214:215], v22, s[20:23], 0 offen offset:96
    s_waitcnt lgkmcnt(12)
    v_pk_add_f32 v[192:193], v[192:193], v[48:49]
    v_pk_add_f32 v[192:193], v[192:193], v[80:81]
    v_pk_add_f32 v[192:193], v[192:193], v[112:113]
    v_pk_add_f32 v[192:193], v[192:193], v[144:145]
    v_cvt_pk_bf16_f32 v216, v192, v193
    v_pk_add_f32 v[194:195], v[194:195], v[50:51]
    v_pk_add_f32 v[194:195], v[194:195], v[82:83]
    v_pk_add_f32 v[194:195], v[194:195], v[114:115]
    v_pk_add_f32 v[194:195], v[194:195], v[146:147]
    v_cvt_pk_bf16_f32 v217, v194, v195
    buffer_store_dwordx2 v[216:217], v22, s[20:23], 0 offen offset:128
    s_waitcnt lgkmcnt(8)
    v_pk_add_f32 v[196:197], v[196:197], v[52:53]
    v_pk_add_f32 v[196:197], v[196:197], v[84:85]
    v_pk_add_f32 v[196:197], v[196:197], v[116:117]
    v_pk_add_f32 v[196:197], v[196:197], v[148:149]
    v_cvt_pk_bf16_f32 v218, v196, v197
    v_pk_add_f32 v[198:199], v[198:199], v[54:55]
    v_pk_add_f32 v[198:199], v[198:199], v[86:87]
    v_pk_add_f32 v[198:199], v[198:199], v[118:119]
    v_pk_add_f32 v[198:199], v[198:199], v[150:151]
    v_cvt_pk_bf16_f32 v219, v198, v199
    buffer_store_dwordx2 v[218:219], v23, s[20:23], 0 offen offset:0
    s_waitcnt lgkmcnt(4)
    v_pk_add_f32 v[200:201], v[200:201], v[56:57]
    v_pk_add_f32 v[200:201], v[200:201], v[88:89]
    v_pk_add_f32 v[200:201], v[200:201], v[120:121]
    v_pk_add_f32 v[200:201], v[200:201], v[152:153]
    v_cvt_pk_bf16_f32 v220, v200, v201
    v_pk_add_f32 v[202:203], v[202:203], v[58:59]
    v_pk_add_f32 v[202:203], v[202:203], v[90:91]
    v_pk_add_f32 v[202:203], v[202:203], v[122:123]
    v_pk_add_f32 v[202:203], v[202:203], v[154:155]
    v_cvt_pk_bf16_f32 v221, v202, v203
    buffer_store_dwordx2 v[220:221], v23, s[20:23], 0 offen offset:32
    s_waitcnt lgkmcnt(0)
    v_pk_add_f32 v[204:205], v[204:205], v[60:61]
    v_pk_add_f32 v[204:205], v[204:205], v[92:93]
    v_pk_add_f32 v[204:205], v[204:205], v[124:125]
    v_pk_add_f32 v[204:205], v[204:205], v[156:157]
    v_cvt_pk_bf16_f32 v222, v204, v205
    v_pk_add_f32 v[206:207], v[206:207], v[62:63]
    v_pk_add_f32 v[206:207], v[206:207], v[94:95]
    v_pk_add_f32 v[206:207], v[206:207], v[126:127]
    v_pk_add_f32 v[206:207], v[206:207], v[158:159]
    v_cvt_pk_bf16_f32 v223, v206, v207
    buffer_store_dwordx2 v[222:223], v23, s[20:23], 0 offen offset:64
    s_endpgm
L_kg_e1:
    s_cmp_eq_u32 s28, 1
    s_cbranch_scc0 L_kg_e2
    s_waitcnt lgkmcnt(0)
    s_barrier
    ds_read_b128 v[32:35], v29 offset:0
    ds_read_b128 v[64:67], v29 offset:8192
    ds_read_b128 v[96:99], v29 offset:16384
    ds_read_b128 v[128:131], v29 offset:24576
    ds_read_b128 v[36:39], v29 offset:1024
    ds_read_b128 v[68:71], v29 offset:9216
    ds_read_b128 v[100:103], v29 offset:17408
    ds_read_b128 v[132:135], v29 offset:25600
    ds_read_b128 v[40:43], v29 offset:2048
    ds_read_b128 v[72:75], v29 offset:10240
    ds_read_b128 v[104:107], v29 offset:18432
    ds_read_b128 v[136:139], v29 offset:26624
    ds_read_b128 v[44:47], v29 offset:3072
    ds_read_b128 v[76:79], v29 offset:11264
    ds_read_b128 v[108:111], v29 offset:19456
    ds_read_b128 v[140:143], v29 offset:27648
    ds_read_b128 v[48:51], v29 offset:4096
    ds_read_b128 v[80:83], v29 offset:12288
    ds_read_b128 v[112:115], v29 offset:20480
    ds_read_b128 v[144:147], v29 offset:28672
    ds_read_b128 v[52:55], v29 offset:5120
    ds_read_b128 v[84:87], v29 offset:13312
    ds_read_b128 v[116:119], v29 offset:21504
    ds_read_b128 v[148:151], v29 offset:29696
    ds_read_b128 v[56:59], v29 offset:6144
    ds_read_b128 v[88:91], v29 offset:14336
    ds_read_b128 v[120:123], v29 offset:22528
    ds_read_b128 v[152:155], v29 offset:30720
    ds_read_b128 v[60:63], v29 offset:7168
    ds_read_b128 v[92:95], v29 offset:15360
    ds_read_b128 v[124:127], v29 offset:23552
    ds_read_b128 v[156:159], v29 offset:31744
    s_waitcnt vmcnt(0)
    v_lshlrev_b32 v176, 16, v208
    v_and_b32 v177, 0xffff0000, v208
    v_lshlrev_b32 v178, 16, v209
    v_and_b32 v179, 0xffff0000, v209
    v_lshlrev_b32 v180, 16, v210
    v_and_b32 v181, 0xffff0000, v210
    v_lshlrev_b32 v182, 16, v211
    v_and_b32 v183, 0xffff0000, v211
    v_lshlrev_b32 v184, 16, v212
    v_and_b32 v185, 0xffff0000, v212
    v_lshlrev_b32 v186, 16, v213
    v_and_b32 v187, 0xffff0000, v213
    v_lshlrev_b32 v188, 16, v214
    v_and_b32 v189, 0xffff0000, v214
    v_lshlrev_b32 v190, 16, v215
    v_and_b32 v191, 0xffff0000, v215
    v_lshlrev_b32 v192, 16, v216
    v_and_b32 v193, 0xffff0000, v216
    v_lshlrev_b32 v194, 16, v217
    v_and_b32 v195, 0xffff0000, v217
    v_lshlrev_b32 v196, 16, v218
    v_and_b32 v197, 0xffff0000, v218
    v_lshlrev_b32 v198, 16, v219
    v_and_b32 v199, 0xffff0000, v219
    v_lshlrev_b32 v200, 16, v220
    v_and_b32 v201, 0xffff0000, v220
    v_lshlrev_b32 v202, 16, v221
    v_and_b32 v203, 0xffff0000, v221
    v_lshlrev_b32 v204, 16, v222
    v_and_b32 v205, 0xffff0000, v222
    v_lshlrev_b32 v206, 16, v223
    v_and_b32 v207, 0xffff0000, v223
    s_waitcnt lgkmcnt(15)
    v_pk_add_f32 v[176:177], v[176:177], v[32:33]
    v_pk_add_f32 v[176:177], v[176:177], v[64:65]
    v_pk_add_f32 v[176:177], v[176:177], v[96:97]
    v_pk_add_f32 v[176:177], v[176:177], v[128:129]
    v_cvt_pk_bf16_f32 v208, v176, v177
    v_pk_add_f32 v[178:179], v[178:179], v[34:35]
    v_pk_add_f32 v[178:179], v[178:179], v[66:67]
    v_pk_add_f32 v[178:179], v[178:179], v[98:99]
    v_pk_add_f32 v[178:179], v[178:179], v[130:131]
    v_cvt_pk_bf16_f32 v209, v178, v179
    buffer_store_dwordx2 v[208:209], v22, s[20:23], 0 offen offset:96
    s_waitcnt lgkmcnt(15)
    v_pk_add_f32 v[180:181], v[180:181], v[36:37]
    v_pk_add_f32 v[180:181], v[180:181], v[68:69]
    v_pk_add_f32 v[180:181], v[180:181], v[100:101]
    v_pk_add_f32 v[180:181], v[180:181], v[132:133]
    v_cvt_pk_bf16_f32 v210, v180, v181
    v_pk_add_f32 v[182:183], v[182:183], v[38:39]
    v_pk_add_f32 v[182:183], v[182:183], v[70:71]
    v_pk_add_f32 v[182:183], v[182:183], v[102:103]
    v_pk_add_f32 v[182:183], v[182:183], v[134:135]
    v_cvt_pk_bf16_f32 v211, v182, v183
    buffer_store_dwordx2 v[210:211], v22, s[20:23], 0 offen offset:128
    s_waitcnt lgkmcnt(15)
    v_pk_add_f32 v[184:185], v[184:185], v[40:41]
    v_pk_add_f32 v[184:185], v[184:185], v[72:73]
    v_pk_add_f32 v[184:185], v[184:185], v[104:105]
    v_pk_add_f32 v[184:185], v[184:185], v[136:137]
    v_cvt_pk_bf16_f32 v212, v184, v185
    v_pk_add_f32 v[186:187], v[186:187], v[42:43]
    v_pk_add_f32 v[186:187], v[186:187], v[74:75]
    v_pk_add_f32 v[186:187], v[186:187], v[106:107]
    v_pk_add_f32 v[186:187], v[186:187], v[138:139]
    v_cvt_pk_bf16_f32 v213, v186, v187
    buffer_store_dwordx2 v[212:213], v23, s[20:23], 0 offen offset:0
    s_waitcnt lgkmcnt(15)
    v_pk_add_f32 v[188:189], v[188:189], v[44:45]
    v_pk_add_f32 v[188:189], v[188:189], v[76:77]
    v_pk_add_f32 v[188:189], v[188:189], v[108:109]
    v_pk_add_f32 v[188:189], v[188:189], v[140:141]
    v_cvt_pk_bf16_f32 v214, v188, v189
    v_pk_add_f32 v[190:191], v[190:191], v[46:47]
    v_pk_add_f32 v[190:191], v[190:191], v[78:79]
    v_pk_add_f32 v[190:191], v[190:191], v[110:111]
    v_pk_add_f32 v[190:191], v[190:191], v[142:143]
    v_cvt_pk_bf16_f32 v215, v190, v191
    buffer_store_dwordx2 v[214:215], v23, s[20:23], 0 offen offset:32
    s_waitcnt lgkmcnt(12)
    v_pk_add_f32 v[192:193], v[192:193], v[48:49]
    v_pk_add_f32 v[192:193], v[192:193], v[80:81]
    v_pk_add_f32 v[192:193], v[192:193], v[112:113]
    v_pk_add_f32 v[192:193], v[192:193], v[144:145]
    v_cvt_pk_bf16_f32 v216, v192, v193
    v_pk_add_f32 v[194:195], v[194:195], v[50:51]
    v_pk_add_f32 v[194:195], v[194:195], v[82:83]
    v_pk_add_f32 v[194:195], v[194:195], v[114:115]
    v_pk_add_f32 v[194:195], v[194:195], v[146:147]
    v_cvt_pk_bf16_f32 v217, v194, v195
    buffer_store_dwordx2 v[216:217], v23, s[20:23], 0 offen offset:64
    s_waitcnt lgkmcnt(8)
    v_pk_add_f32 v[196:197], v[196:197], v[52:53]
    v_pk_add_f32 v[196:197], v[196:197], v[84:85]
    v_pk_add_f32 v[196:197], v[196:197], v[116:117]
    v_pk_add_f32 v[196:197], v[196:197], v[148:149]
    v_cvt_pk_bf16_f32 v218, v196, v197
    v_pk_add_f32 v[198:199], v[198:199], v[54:55]
    v_pk_add_f32 v[198:199], v[198:199], v[86:87]
    v_pk_add_f32 v[198:199], v[198:199], v[118:119]
    v_pk_add_f32 v[198:199], v[198:199], v[150:151]
    v_cvt_pk_bf16_f32 v219, v198, v199
    buffer_store_dwordx2 v[218:219], v23, s[20:23], 0 offen offset:96
    s_waitcnt lgkmcnt(4)
    v_pk_add_f32 v[200:201], v[200:201], v[56:57]
    v_pk_add_f32 v[200:201], v[200:201], v[88:89]
    v_pk_add_f32 v[200:201], v[200:201], v[120:121]
    v_pk_add_f32 v[200:201], v[200:201], v[152:153]
    v_cvt_pk_bf16_f32 v220, v200, v201
    v_pk_add_f32 v[202:203], v[202:203], v[58:59]
    v_pk_add_f32 v[202:203], v[202:203], v[90:91]
    v_pk_add_f32 v[202:203], v[202:203], v[122:123]
    v_pk_add_f32 v[202:203], v[202:203], v[154:155]
    v_cvt_pk_bf16_f32 v221, v202, v203
    buffer_store_dwordx2 v[220:221], v23, s[20:23], 0 offen offset:128
    s_waitcnt lgkmcnt(0)
    v_pk_add_f32 v[204:205], v[204:205], v[60:61]
    v_pk_add_f32 v[204:205], v[204:205], v[92:93]
    v_pk_add_f32 v[204:205], v[204:205], v[124:125]
    v_pk_add_f32 v[204:205], v[204:205], v[156:157]
    v_cvt_pk_bf16_f32 v222, v204, v205
    v_pk_add_f32 v[206:207], v[206:207], v[62:63]
    v_pk_add_f32 v[206:207], v[206:207], v[94:95]
    v_pk_add_f32 v[206:207], v[206:207], v[126:127]
    v_pk_add_f32 v[206:207], v[206:207], v[158:159]
    v_cvt_pk_bf16_f32 v223, v206, v207
    buffer_store_dwordx2 v[222:223], v24, s[20:23], 0 offen offset:0
    s_endpgm
L_kg_e2:
    s_cmp_eq_u32 s28, 2
    s_cbranch_scc0 L_kg_e3
    s_waitcnt lgkmcnt(0)
    s_barrier
    ds_read_b128 v[32:35], v29 offset:0
    ds_read_b128 v[64:67], v29 offset:8192
    ds_read_b128 v[96:99], v29 offset:16384
    ds_read_b128 v[128:131], v29 offset:24576
    ds_read_b128 v[36:39], v29 offset:1024
    ds_read_b128 v[68:71], v29 offset:9216
    ds_read_b128 v[100:103], v29 offset:17408
    ds_read_b128 v[132:135], v29 offset:25600
    ds_read_b128 v[40:43], v29 offset:2048
    ds_read_b128 v[72:75], v29 offset:10240
    ds_read_b128 v[104:107], v29 offset:18432
    ds_read_b128 v[136:139], v29 offset:26624
    ds_read_b128 v[44:47], v29 offset:3072
    ds_read_b128 v[76:79], v29 offset:11264
    ds_read_b128 v[108:111], v29 offset:19456
    ds_read_b128 v[140:143], v29 offset:27648
    ds_read_b128 v[48:51], v29 offset:4096
    ds_read_b128 v[80:83], v29 offset:12288
    ds_read_b128 v[112:115], v29 offset:20480
    ds_read_b128 v[144:147], v29 offset:28672
    ds_read_b128 v[52:55], v29 offset:5120
    ds_read_b128 v[84:87], v29 offset:13312
    ds_read_b128 v[116:119], v29 offset:21504
    ds_read_b128 v[148:151], v29 offset:29696
    ds_read_b128 v[56:59], v29 offset:6144
    ds_read_b128 v[88:91], v29 offset:14336
    ds_read_b128 v[120:123], v29 offset:22528
    ds_read_b128 v[152:155], v29 offset:30720
    s_waitcnt vmcnt(0)
    v_lshlrev_b32 v208, 16, v164
    v_and_b32 v209, 0xffff0000, v164
    v_lshlrev_b32 v210, 16, v165
    v_and_b32 v211, 0xffff0000, v165
    v_lshlrev_b32 v212, 16, v166
    v_and_b32 v213, 0xffff0000, v166
    v_lshlrev_b32 v214, 16, v167
    v_and_b32 v215, 0xffff0000, v167
    v_lshlrev_b32 v216, 16, v168
    v_and_b32 v217, 0xffff0000, v168
    v_lshlrev_b32 v218, 16, v169
    v_and_b32 v219, 0xffff0000, v169
    v_lshlrev_b32 v220, 16, v170
    v_and_b32 v221, 0xffff0000, v170
    v_lshlrev_b32 v222, 16, v171
    v_and_b32 v223, 0xffff0000, v171
    v_lshlrev_b32 v224, 16, v172
    v_and_b32 v225, 0xffff0000, v172
    v_lshlrev_b32 v226, 16, v173
    v_and_b32 v227, 0xffff0000, v173
    v_lshlrev_b32 v228, 16, v174
    v_and_b32 v229, 0xffff0000, v174
    v_lshlrev_b32 v230, 16, v175
    v_and_b32 v231, 0xffff0000, v175
    v_lshlrev_b32 v232, 16, v176
    v_and_b32 v233, 0xffff0000, v176
    v_lshlrev_b32 v234, 16, v177
    v_and_b32 v235, 0xffff0000, v177
    s_waitcnt lgkmcnt(15)
    v_pk_add_f32 v[208:209], v[208:209], v[32:33]
    v_pk_add_f32 v[208:209], v[208:209], v[64:65]
    v_pk_add_f32 v[208:209], v[208:209], v[96:97]
    v_pk_add_f32 v[208:209], v[208:209], v[128:129]
    v_cvt_pk_bf16_f32 v164, v208, v209
    v_pk_add_f32 v[210:211], v[210:211], v[34:35]
    v_pk_add_f32 v[210:211], v[210:211], v[66:67]
    v_pk_add_f32 v[210:211], v[210:211], v[98:99]
    v_pk_add_f32 v[210:211], v[210:211], v[130:131]
    v_cvt_pk_bf16_f32 v165, v210, v211
    buffer_store_dwordx2 v[164:165], v22, s[20:23], 0 offen offset:32
    s_waitcnt lgkmcnt(15)
    v_pk_add_f32 v[212:213], v[212:213], v[36:37]
    v_pk_add_f32 v[212:213], v[212:213], v[68:69]
    v_pk_add_f32 v[212:213], v[212:213], v[100:101]
    v_pk_add_f32 v[212:213], v[212:213], v[132:133]
    v_cvt_pk_bf16_f32 v166, v212, v213
    v_pk_add_f32 v[214:215], v[214:215], v[38:39]
    v_pk_add_f32 v[214:215], v[214:215], v[70:71]
    v_pk_add_f32 v[214:215], v[214:215], v[102:103]
    v_pk_add_f32 v[214:215], v[214:215], v[134:135]
    v_cvt_pk_bf16_f32 v167, v214, v215
    buffer_store_dwordx2 v[166:167], v22, s[20:23], 0 offen offset:64
    s_waitcnt lgkmcnt(15)
    v_pk_add_f32 v[216:217], v[216:217], v[40:41]
    v_pk_add_f32 v[216:217], v[216:217], v[72:73]
    v_pk_add_f32 v[216:217], v[216:217], v[104:105]
    v_pk_add_f32 v[216:217], v[216:217], v[136:137]
    v_cvt_pk_bf16_f32 v168, v216, v217
    v_pk_add_f32 v[218:219], v[218:219], v[42:43]
    v_pk_add_f32 v[218:219], v[218:219], v[74:75]
    v_pk_add_f32 v[218:219], v[218:219], v[106:107]
    v_pk_add_f32 v[218:219], v[218:219], v[138:139]
    v_cvt_pk_bf16_f32 v169, v218, v219
    buffer_store_dwordx2 v[168:169], v22, s[20:23], 0 offen offset:96
    s_waitcnt lgkmcnt(12)
    v_pk_add_f32 v[220:221], v[220:221], v[44:45]
    v_pk_add_f32 v[220:221], v[220:221], v[76:77]
    v_pk_add_f32 v[220:221], v[220:221], v[108:109]
    v_pk_add_f32 v[220:221], v[220:221], v[140:141]
    v_cvt_pk_bf16_f32 v170, v220, v221
    v_pk_add_f32 v[222:223], v[222:223], v[46:47]
    v_pk_add_f32 v[222:223], v[222:223], v[78:79]
    v_pk_add_f32 v[222:223], v[222:223], v[110:111]
    v_pk_add_f32 v[222:223], v[222:223], v[142:143]
    v_cvt_pk_bf16_f32 v171, v222, v223
    buffer_store_dwordx2 v[170:171], v22, s[20:23], 0 offen offset:128
    s_waitcnt lgkmcnt(8)
    v_pk_add_f32 v[224:225], v[224:225], v[48:49]
    v_pk_add_f32 v[224:225], v[224:225], v[80:81]
    v_pk_add_f32 v[224:225], v[224:225], v[112:113]
    v_pk_add_f32 v[224:225], v[224:225], v[144:145]
    v_cvt_pk_bf16_f32 v172, v224, v225
    v_pk_add_f32 v[226:227], v[226:227], v[50:51]
    v_pk_add_f32 v[226:227], v[226:227], v[82:83]
    v_pk_add_f32 v[226:227], v[226:227], v[114:115]
    v_pk_add_f32 v[226:227], v[226:227], v[146:147]
    v_cvt_pk_bf16_f32 v173, v226, v227
    buffer_store_dwordx2 v[172:173], v23, s[20:23], 0 offen offset:0
    s_waitcnt lgkmcnt(4)
    v_pk_add_f32 v[228:229], v[228:229], v[52:53]
    v_pk_add_f32 v[228:229], v[228:229], v[84:85]
    v_pk_add_f32 v[228:229], v[228:229], v[116:117]
    v_pk_add_f32 v[228:229], v[228:229], v[148:149]
    v_cvt_pk_bf16_f32 v174, v228, v229
    v_pk_add_f32 v[230:231], v[230:231], v[54:55]
    v_pk_add_f32 v[230:231], v[230:231], v[86:87]
    v_pk_add_f32 v[230:231], v[230:231], v[118:119]
    v_pk_add_f32 v[230:231], v[230:231], v[150:151]
    v_cvt_pk_bf16_f32 v175, v230, v231
    buffer_store_dwordx2 v[174:175], v23, s[20:23], 0 offen offset:32
    s_waitcnt lgkmcnt(0)
    v_pk_add_f32 v[232:233], v[232:233], v[56:57]
    v_pk_add_f32 v[232:233], v[232:233], v[88:89]
    v_pk_add_f32 v[232:233], v[232:233], v[120:121]
    v_pk_add_f32 v[232:233], v[232:233], v[152:153]
    v_cvt_pk_bf16_f32 v176, v232, v233
    v_pk_add_f32 v[234:235], v[234:235], v[58:59]
    v_pk_add_f32 v[234:235], v[234:235], v[90:91]
    v_pk_add_f32 v[234:235], v[234:235], v[122:123]
    v_pk_add_f32 v[234:235], v[234:235], v[154:155]
    v_cvt_pk_bf16_f32 v177, v234, v235
    buffer_store_dwordx2 v[176:177], v23, s[20:23], 0 offen offset:64
    s_endpgm
L_kg_e3:
    s_waitcnt lgkmcnt(0)
    s_barrier
    ds_read_b128 v[32:35], v29 offset:0
    ds_read_b128 v[64:67], v29 offset:8192
    ds_read_b128 v[96:99], v29 offset:16384
    ds_read_b128 v[128:131], v29 offset:24576
    ds_read_b128 v[36:39], v29 offset:1024
    ds_read_b128 v[68:71], v29 offset:9216
    ds_read_b128 v[100:103], v29 offset:17408
    ds_read_b128 v[132:135], v29 offset:25600
    ds_read_b128 v[40:43], v29 offset:2048
    ds_read_b128 v[72:75], v29 offset:10240
    ds_read_b128 v[104:107], v29 offset:18432
    ds_read_b128 v[136:139], v29 offset:26624
    ds_read_b128 v[44:47], v29 offset:3072
    ds_read_b128 v[76:79], v29 offset:11264
    ds_read_b128 v[108:111], v29 offset:19456
    ds_read_b128 v[140:143], v29 offset:27648
    ds_read_b128 v[48:51], v29 offset:4096
    ds_read_b128 v[80:83], v29 offset:12288
    ds_read_b128 v[112:115], v29 offset:20480
    ds_read_b128 v[144:147], v29 offset:28672
    ds_read_b128 v[52:55], v29 offset:5120
    ds_read_b128 v[84:87], v29 offset:13312
    ds_read_b128 v[116:119], v29 offset:21504
    ds_read_b128 v[148:151], v29 offset:29696
    ds_read_b128 v[56:59], v29 offset:6144
    ds_read_b128 v[88:91], v29 offset:14336
    ds_read_b128 v[120:123], v29 offset:22528
    ds_read_b128 v[152:155], v29 offset:30720
    s_waitcnt vmcnt(0)
    v_lshlrev_b32 v208, 16, v164
    v_and_b32 v209, 0xffff0000, v164
    v_lshlrev_b32 v210, 16, v165
    v_and_b32 v211, 0xffff0000, v165
    v_lshlrev_b32 v212, 16, v166
    v_and_b32 v213, 0xffff0000, v166
    v_lshlrev_b32 v214, 16, v167
    v_and_b32 v215, 0xffff0000, v167
    v_lshlrev_b32 v216, 16, v168
    v_and_b32 v217, 0xffff0000, v168
    v_lshlrev_b32 v218, 16, v169
    v_and_b32 v219, 0xffff0000, v169
    v_lshlrev_b32 v220, 16, v170
    v_and_b32 v221, 0xffff0000, v170
    v_lshlrev_b32 v222, 16, v171
    v_and_b32 v223, 0xffff0000, v171
    v_lshlrev_b32 v224, 16, v172
    v_and_b32 v225, 0xffff0000, v172
    v_lshlrev_b32 v226, 16, v173
    v_and_b32 v227, 0xffff0000, v173
    v_lshlrev_b32 v228, 16, v174
    v_and_b32 v229, 0xffff0000, v174
    v_lshlrev_b32 v230, 16, v175
    v_and_b32 v231, 0xffff0000, v175
    v_lshlrev_b32 v232, 16, v176
    v_and_b32 v233, 0xffff0000, v176
    v_lshlrev_b32 v234, 16, v177
    v_and_b32 v235, 0xffff0000, v177
    s_waitcnt lgkmcnt(15)
    v_pk_add_f32 v[208:209], v[208:209], v[32:33]
    v_pk_add_f32 v[208:209], v[208:209], v[64:65]
    v_pk_add_f32 v[208:209], v[208:209], v[96:97]
    v_pk_add_f32 v[208:209], v[208:209], v[128:129]
    v_cvt_pk_bf16_f32 v164, v208, v209
    v_pk_add_f32 v[210:211], v[210:211], v[34:35]
    v_pk_add_f32 v[210:211], v[210:211], v[66:67]
    v_pk_add_f32 v[210:211], v[210:211], v[98:99]
    v_pk_add_f32 v[210:211], v[210:211], v[130:131]
    v_cvt_pk_bf16_f32 v165, v210, v211
    buffer_store_dwordx2 v[164:165], v22, s[20:23], 0 offen offset:96
    s_waitcnt lgkmcnt(15)
    v_pk_add_f32 v[212:213], v[212:213], v[36:37]
    v_pk_add_f32 v[212:213], v[212:213], v[68:69]
    v_pk_add_f32 v[212:213], v[212:213], v[100:101]
    v_pk_add_f32 v[212:213], v[212:213], v[132:133]
    v_cvt_pk_bf16_f32 v166, v212, v213
    v_pk_add_f32 v[214:215], v[214:215], v[38:39]
    v_pk_add_f32 v[214:215], v[214:215], v[70:71]
    v_pk_add_f32 v[214:215], v[214:215], v[102:103]
    v_pk_add_f32 v[214:215], v[214:215], v[134:135]
    v_cvt_pk_bf16_f32 v167, v214, v215
    buffer_store_dwordx2 v[166:167], v22, s[20:23], 0 offen offset:128
    s_waitcnt lgkmcnt(15)
    v_pk_add_f32 v[216:217], v[216:217], v[40:41]
    v_pk_add_f32 v[216:217], v[216:217], v[72:73]
    v_pk_add_f32 v[216:217], v[216:217], v[104:105]
    v_pk_add_f32 v[216:217], v[216:217], v[136:137]
    v_cvt_pk_bf16_f32 v168, v216, v217
    v_pk_add_f32 v[218:219], v[218:219], v[42:43]
    v_pk_add_f32 v[218:219], v[218:219], v[74:75]
    v_pk_add_f32 v[218:219], v[218:219], v[106:107]
    v_pk_add_f32 v[218:219], v[218:219], v[138:139]
    v_cvt_pk_bf16_f32 v169, v218, v219
    buffer_store_dwordx2 v[168:169], v23, s[20:23], 0 offen offset:0
    s_waitcnt lgkmcnt(12)
    v_pk_add_f32 v[220:221], v[220:221], v[44:45]
    v_pk_add_f32 v[220:221], v[220:221], v[76:77]
    v_pk_add_f32 v[220:221], v[220:221], v[108:109]
    v_pk_add_f32 v[220:221], v[220:221], v[140:141]
    v_cvt_pk_bf16_f32 v170, v220, v221
    v_pk_add_f32 v[222:223], v[222:223], v[46:47]
    v_pk_add_f32 v[222:223], v[222:223], v[78:79]
    v_pk_add_f32 v[222:223], v[222:223], v[110:111]
    v_pk_add_f32 v[222:223], v[222:223], v[142:143]
    v_cvt_pk_bf16_f32 v171, v222, v223
    buffer_store_dwordx2 v[170:171], v23, s[20:23], 0 offen offset:32
    s_waitcnt lgkmcnt(8)
    v_pk_add_f32 v[224:225], v[224:225], v[48:49]
    v_pk_add_f32 v[224:225], v[224:225], v[80:81]
    v_pk_add_f32 v[224:225], v[224:225], v[112:113]
    v_pk_add_f32 v[224:225], v[224:225], v[144:145]
    v_cvt_pk_bf16_f32 v172, v224, v225
    v_pk_add_f32 v[226:227], v[226:227], v[50:51]
    v_pk_add_f32 v[226:227], v[226:227], v[82:83]
    v_pk_add_f32 v[226:227], v[226:227], v[114:115]
    v_pk_add_f32 v[226:227], v[226:227], v[146:147]
    v_cvt_pk_bf16_f32 v173, v226, v227
    buffer_store_dwordx2 v[172:173], v23, s[20:23], 0 offen offset:64
    s_waitcnt lgkmcnt(4)
    v_pk_add_f32 v[228:229], v[228:229], v[52:53]
    v_pk_add_f32 v[228:229], v[228:229], v[84:85]
    v_pk_add_f32 v[228:229], v[228:229], v[116:117]
    v_pk_add_f32 v[228:229], v[228:229], v[148:149]
    v_cvt_pk_bf16_f32 v174, v228, v229
    v_pk_add_f32 v[230:231], v[230:231], v[54:55]
    v_pk_add_f32 v[230:231], v[230:231], v[86:87]
    v_pk_add_f32 v[230:231], v[230:231], v[118:119]
    v_pk_add_f32 v[230:231], v[230:231], v[150:151]
    v_cvt_pk_bf16_f32 v175, v230, v231
    buffer_store_dwordx2 v[174:175], v23, s[20:23], 0 offen offset:96
    s_waitcnt lgkmcnt(0)
    v_pk_add_f32 v[232:233], v[232:233], v[56:57]
    v_pk_add_f32 v[232:233], v[232:233], v[88:89]
    v_pk_add_f32 v[232:233], v[232:233], v[120:121]
    v_pk_add_f32 v[232:233], v[232:233], v[152:153]
    v_cvt_pk_bf16_f32 v176, v232, v233
    v_pk_add_f32 v[234:235], v[234:235], v[58:59]
    v_pk_add_f32 v[234:235], v[234:235], v[90:91]
    v_pk_add_f32 v[234:235], v[234:235], v[122:123]
    v_pk_add_f32 v[234:235], v[234:235], v[154:155]
    v_cvt_pk_bf16_f32 v177, v234, v235
    buffer_store_dwordx2 v[176:177], v23, s[20:23], 0 offen offset:128
    s_endpgm
L_k2_exit:
    s_endpgm

k2c_kernel_end:
.section .rodata,"a"
.p2align 6
.amdhsa_kernel k1_kernel
  .amdhsa_next_free_vgpr 256
  .amdhsa_next_free_sgpr 102
  .amdhsa_accum_offset 256
  .amdhsa_group_segment_fixed_size 0
  .amdhsa_kernarg_size 80
  .amdhsa_user_sgpr_count 2
  .amdhsa_user_sgpr_kernarg_segment_ptr 1
  .amdhsa_system_sgpr_workgroup_id_x 1
  .amdhsa_float_denorm_mode_32 3
.end_amdhsa_kernel
.p2align 6
.amdhsa_kernel k2c_kernel
  .amdhsa_next_free_vgpr 376
  .amdhsa_next_free_sgpr 102
  .amdhsa_accum_offset 256
  .amdhsa_group_segment_fixed_size 0
  .amdhsa_kernarg_size 80
  .amdhsa_user_sgpr_count 2
  .amdhsa_user_sgpr_kernarg_segment_ptr 1
  .amdhsa_system_sgpr_workgroup_id_x 1
  .amdhsa_float_denorm_mode_32 3
.end_amdhsa_kernel
.set CT0, 16256
.set CT1, 16256
.set CT2, 16256
.set CT3, 16256
.set CT4, 16256
.set CT5, 16256
.set CT6, 16256
.set CT7, 16255
.set CT8, 16255
.set CT9, 16255
.set CT10, 16255
.set CT11, 16255
.set CT12, 16254
.set CT13, 16254
.set CT14, 16254
.set CT15, 16253
.set CT16, 16253
.set CT17, 16252
.set CT18, 16252
.set CT19, 16252
.set CT20, 16251
.set CT21, 16251
.set CT22, 16250
.set CT23, 16250
.set CT24, 16249
.set CT25, 16248
.set CT26, 16248
.set CT27, 16247
.set CT28, 16246
.set CT29, 16246
.set CT30, 16245
.set CT31, 16244
.set CT32, 16243
.set CT33, 16243
.set CT34, 16242
.set CT35, 16241
.set CT36, 16240
.set CT37, 16239
.set CT38, 16238
.set CT39, 16237
.set CT40, 16237
.set CT41, 16236
.set CT42, 16235
.set CT43, 16234
.set CT44, 16232
.set CT45, 16231
.set CT46, 16230
.set CT47, 16229
.set CT48, 16228
.set CT49, 16227
.set CT50, 16226
.set CT51, 16225
.set CT52, 16223
.set CT53, 16222
.set CT54, 16221
.set CT55, 16220
.set CT56, 16218
.set CT57, 16217
.set CT58, 16216
.set CT59, 16214
.set CT60, 16213
.set CT61, 16211
.set CT62, 16210
.set CT63, 16209
.set CT64, 16207
.set CT65, 16206
.set CT66, 16204
.set CT67, 16203
.set CT68, 16201
.set CT69, 16199
.set CT70, 16198
.set CT71, 16196
.set CT72, 16195
.set CT73, 16193
.set CT74, 16191
.set CT75, 16190
.set CT76, 16188
.set CT77, 16186
.set CT78, 16185
.set CT79, 16183
.set CT80, 16181
.set CT81, 16179
.set CT82, 16177
.set CT83, 16176
.set CT84, 16174
.set CT85, 16172
.set CT86, 16170
.set CT87, 16168
.set CT88, 16166
.set CT89, 16164
.set CT90, 16162
.set CT91, 16160
.set CT92, 16158
.set CT93, 16157
.set CT94, 16155
.set CT95, 16152
.set CT96, 16150
.set CT97, 16148
.set CT98, 16146
.set CT99, 16144
.set CT100, 16142
.set CT101, 16140
.set CT102, 16138
.set CT103, 16136
.set CT104, 16134
.set CT105, 16132
.set CT106, 16129
.set CT107, 16127
.set CT108, 16122
.set CT109, 16118
.set CT110, 16113
.set CT111, 16109
.set CT112, 16104
.set CT113, 16100
.set CT114, 16095
.set CT115, 16091
.set CT116, 16086
.set CT117, 16082
.set CT118, 16077
.set CT119, 16073
.set CT120, 16068
.set CT121, 16063
.set CT122, 16059
.set CT123, 16054
.set CT124, 16049
.set CT125, 16044
.set CT126, 16040
.set CT127, 16035
.set CT128, 16030
.set CT129, 16025
.set CT130, 16021
.set CT131, 16016
.set CT132, 16011
.set CT133, 16006
.set CT134, 16001
.set CT135, 15993
.set CT136, 15983
.set CT137, 15973
.set CT138, 15963
.set CT139, 15954
.set CT140, 15944
.set CT141, 15934
.set CT142, 15924
.set CT143, 15914
.set CT144, 15904
.set CT145, 15894
.set CT146, 15884
.set CT147, 15874
.set CT148, 15857
.set CT149, 15837
.set CT150, 15817
.set CT151, 15797
.set CT152, 15777
.set CT153, 15757
.set CT154, 15729
.set CT155, 15689
.set CT156, 15649
.set CT157, 15601
.set CT158, 15521
.set CT159, 15393
.set CT160, 0
.set CT161, 48161
.set CT162, 48289
.set CT163, 48369
.set CT164, 48417
.set CT165, 48457
.set CT166, 48497
.set CT167, 48525
.set CT168, 48545
.set CT169, 48565
.set CT170, 48585
.set CT171, 48605
.set CT172, 48625
.set CT173, 48642
.set CT174, 48652
.set CT175, 48662
.set CT176, 48672
.set CT177, 48682
.set CT178, 48692
.set CT179, 48702
.set CT180, 48712
.set CT181, 48722
.set CT182, 48731
.set CT183, 48741
.set CT184, 48751
.set CT185, 48761
.set CT186, 48769
.set CT187, 48774
.set CT188, 48779
.set CT189, 48784
.set CT190, 48789
.set CT191, 48793
.set CT192, 48798
.set CT193, 48803
.set CT194, 48808
.set CT195, 48812
.set CT196, 48817
.set CT197, 48822
.set CT198, 48827
.set CT199, 48831
.set CT200, 48836
.set CT201, 48841
.set CT202, 48845
.set CT203, 48850
.set CT204, 48854
.set CT205, 48859
.set CT206, 48863
.set CT207, 48868
.set CT208, 48872
.set CT209, 48877
.set CT210, 48881
.set CT211, 48886
.set CT212, 48890
.set CT213, 48895
.set CT214, 48897
.set CT215, 48900
.set CT216, 48902
.set CT217, 48904
.set CT218, 48906
.set CT219, 48908
.set CT220, 48910
.set CT221, 48912
.set CT222, 48914
.set CT223, 48916
.set CT224, 48918
.set CT225, 48920
.set CT226, 48923
.set CT227, 48925
.set CT228, 48926
.set CT229, 48928
.set CT230, 48930
.set CT231, 48932
.set CT232, 48934
.set CT233, 48936
.set CT234, 48938
.set CT235, 48940
.set CT236, 48942
.set CT237, 48944
.set CT238, 48945
.set CT239, 48947
.set CT240, 48949
.set CT241, 48951
.set CT242, 48953
.set CT243, 48954
.set CT244, 48956
.set CT245, 48958
.set CT246, 48959
.set CT247, 48961
.set CT248, 48963
.set CT249, 48964
.set CT250, 48966
.set CT251, 48967
.set CT252, 48969
.set CT253, 48971
.set CT254, 48972
.set CT255, 48974
.set CT256, 48975
.set CT257, 48977
.set CT258, 48978
.set CT259, 48979
.set CT260, 48981
.set CT261, 48982
.set CT262, 48984
.set CT263, 48985
.set CT264, 48986
.set CT265, 48988
.set CT266, 48989
.set CT267, 48990
.set CT268, 48991
.set CT269, 48993
.set CT270, 48994
.set CT271, 48995
.set CT272, 48996
.set CT273, 48997
.set CT274, 48998
.set CT275, 48999
.set CT276, 49000
.set CT277, 49002
.set CT278, 49003
.set CT279, 49004
.set CT280, 49005
.set CT281, 49005
.set CT282, 49006
.set CT283, 49007
.set CT284, 49008
.set CT285, 49009
.set CT286, 49010
.set CT287, 49011
.set CT288, 49011
.set CT289, 49012
.set CT290, 49013
.set CT291, 49014
.set CT292, 49014
.set CT293, 49015
.set CT294, 49016
.set CT295, 49016
.set CT296, 49017
.set CT297, 49018
.set CT298, 49018
.set CT299, 49019
.set CT300, 49019
.set CT301, 49020
.set CT302, 49020
.set CT303, 49020
.set CT304, 49021
.set CT305, 49021
.set CT306, 49022
.set CT307, 49022
.set CT308, 49022
.set CT309, 49023
.set CT310, 49023
.set CT311, 49023
.set CT312, 49023
.set CT313, 49023
.set CT314, 49024
.set CT315, 49024
.set CT316, 49024
.set CT317, 49024
.set CT318, 49024
.set CT319, 49024
.set CT320, 49024
.set CT321, 49024
.set CT322, 49024
.set CT323, 49024
.set CT324, 49024
.set CT325, 49024
.set CT326, 49024
.set CT327, 49023
.set CT328, 49023
.set CT329, 49023
.set CT330, 49023
.set CT331, 49023
.set CT332, 49022
.set CT333, 49022
.set CT334, 49022
.set CT335, 49021
.set CT336, 49021
.set CT337, 49020
.set CT338, 49020
.set CT339, 49020
.set CT340, 49019
.set CT341, 49019
.set CT342, 49018
.set CT343, 49018
.set CT344, 49017
.set CT345, 49016
.set CT346, 49016
.set CT347, 49015
.set CT348, 49014
.set CT349, 49014
.set CT350, 49013
.set CT351, 49012
.set CT352, 49011
.set CT353, 49011
.set CT354, 49010
.set CT355, 49009
.set CT356, 49008
.set CT357, 49007
.set CT358, 49006
.set CT359, 49005
.set CT360, 49005
.set CT361, 49004
.set CT362, 49003
.set CT363, 49002
.set CT364, 49000
.set CT365, 48999
.set CT366, 48998
.set CT367, 48997
.set CT368, 48996
.set CT369, 48995
.set CT370, 48994
.set CT371, 48993
.set CT372, 48991
.set CT373, 48990
.set CT374, 48989
.set CT375, 48988
.set CT376, 48986
.set CT377, 48985
.set CT378, 48984
.set CT379, 48982
.set CT380, 48981
.set CT381, 48979
.set CT382, 48978
.set CT383, 48977
.set CT384, 48975
.set CT385, 48974
.set CT386, 48972
.set CT387, 48971
.set CT388, 48969
.set CT389, 48967
.set CT390, 48966
.set CT391, 48964
.set CT392, 48963
.set CT393, 48961
.set CT394, 48959
.set CT395, 48958
.set CT396, 48956
.set CT397, 48954
.set CT398, 48953
.set CT399, 48951
.set CT400, 48949
.set CT401, 48947
.set CT402, 48945
.set CT403, 48944
.set CT404, 48942
.set CT405, 48940
.set CT406, 48938
.set CT407, 48936
.set CT408, 48934
.set CT409, 48932
.set CT410, 48930
.set CT411, 48928
.set CT412, 48926
.set CT413, 48925
.set CT414, 48923
.set CT415, 48920
.set CT416, 48918
.set CT417, 48916
.set CT418, 48914
.set CT419, 48912
.set CT420, 48910
.set CT421, 48908
.set CT422, 48906
.set CT423, 48904
.set CT424, 48902
.set CT425, 48900
.set CT426, 48897
.set CT427, 48895
.set CT428, 48890
.set CT429, 48886
.set CT430, 48881
.set CT431, 48877
.set CT432, 48872
.set CT433, 48868
.set CT434, 48863
.set CT435, 48859
.set CT436, 48854
.set CT437, 48850
.set CT438, 48845
.set CT439, 48841
.set CT440, 48836
.set CT441, 48831
.set CT442, 48827
.set CT443, 48822
.set CT444, 48817
.set CT445, 48812
.set CT446, 48808
.set CT447, 48803
.set CT448, 48798
.set CT449, 48793
.set CT450, 48789
.set CT451, 48784
.set CT452, 48779
.set CT453, 48774
.set CT454, 48769
.set CT455, 48761
.set CT456, 48751
.set CT457, 48741
.set CT458, 48731
.set CT459, 48722
.set CT460, 48712
.set CT461, 48702
.set CT462, 48692
.set CT463, 48682
.set CT464, 48672
.set CT465, 48662
.set CT466, 48652
.set CT467, 48642
.set CT468, 48625
.set CT469, 48605
.set CT470, 48585
.set CT471, 48565
.set CT472, 48545
.set CT473, 48525
.set CT474, 48497
.set CT475, 48457
.set CT476, 48417
.set CT477, 48369
.set CT478, 48289
.set CT479, 48161
.set CT480, 0
.set CT481, 15393
.set CT482, 15521
.set CT483, 15601
.set CT484, 15649
.set CT485, 15689
.set CT486, 15729
.set CT487, 15757
.set CT488, 15777
.set CT489, 15797
.set CT490, 15817
.set CT491, 15837
.set CT492, 15857
.set CT493, 15874
.set CT494, 15884
.set CT495, 15894
.set CT496, 15904
.set CT497, 15914
.set CT498, 15924
.set CT499, 15934
.set CT500, 15944
.set CT501, 15954
.set CT502, 15963
.set CT503, 15973
.set CT504, 15983
.set CT505, 15993
.set CT506, 16001
.set CT507, 16006
.set CT508, 16011
.set CT509, 16016
.set CT510, 16021
.set CT511, 16025
.set CT512, 16030
.set CT513, 16035
.set CT514, 16040
.set CT515, 16044
.set CT516, 16049
.set CT517, 16054
.set CT518, 16059
.set CT519, 16063
.set CT520, 16068
.set CT521, 16073
.set CT522, 16077
.set CT523, 16082
.set CT524, 16086
.set CT525, 16091
.set CT526, 16095
.set CT527, 16100
.set CT528, 16104
.set CT529, 16109
.set CT530, 16113
.set CT531, 16118
.set CT532, 16122
.set CT533, 16127
.set CT534, 16129
.set CT535, 16132
.set CT536, 16134
.set CT537, 16136
.set CT538, 16138
.set CT539, 16140
.set CT540, 16142
.set CT541, 16144
.set CT542, 16146
.set CT543, 16148
.set CT544, 16150
.set CT545, 16152
.set CT546, 16155
.set CT547, 16157
.set CT548, 16158
.set CT549, 16160
.set CT550, 16162
.set CT551, 16164
.set CT552, 16166
.set CT553, 16168
.set CT554, 16170
.set CT555, 16172
.set CT556, 16174
.set CT557, 16176
.set CT558, 16177
.set CT559, 16179
.set CT560, 16181
.set CT561, 16183
.set CT562, 16185
.set CT563, 16186
.set CT564, 16188
.set CT565, 16190
.set CT566, 16191
.set CT567, 16193
.set CT568, 16195
.set CT569, 16196
.set CT570, 16198
.set CT571, 16199
.set CT572, 16201
.set CT573, 16203
.set CT574, 16204
.set CT575, 16206
.set CT576, 16207
.set CT577, 16209
.set CT578, 16210
.set CT579, 16211
.set CT580, 16213
.set CT581, 16214
.set CT582, 16216
.set CT583, 16217
.set CT584, 16218
.set CT585, 16220
.set CT586, 16221
.set CT587, 16222
.set CT588, 16223
.set CT589, 16225
.set CT590, 16226
.set CT591, 16227
.set CT592, 16228
.set CT593, 16229
.set CT594, 16230
.set CT595, 16231
.set CT596, 16232
.set CT597, 16234
.set CT598, 16235
.set CT599, 16236
.set CT600, 16237
.set CT601, 16237
.set CT602, 16238
.set CT603, 16239
.set CT604, 16240
.set CT605, 16241
.set CT606, 16242
.set CT607, 16243
.set CT608, 16243
.set CT609, 16244
.set CT610, 16245
.set CT611, 16246
.set CT612, 16246
.set CT613, 16247
.set CT614, 16248
.set CT615, 16248
.set CT616, 16249
.set CT617, 16250
.set CT618, 16250
.set CT619, 16251
.set CT620, 16251
.set CT621, 16252
.set CT622, 16252
.set CT623, 16252
.set CT624, 16253
.set CT625, 16253
.set CT626, 16254
.set CT627, 16254
.set CT628, 16254
.set CT629, 16255
.set CT630, 16255
.set CT631, 16255
.set CT632, 16255
.set CT633, 16255
.set CT634, 16256
.set CT635, 16256
.set CT636, 16256
.set CT637, 16256
.set CT638, 16256
.set CT639, 16256

.altmacro
.macro ft_e a0, a1, a2, a3, a4, a5, a6, a7
.long (CT\a0)|(CT\a1<<16), (CT\a2)|(CT\a3<<16), (CT\a4)|(CT\a5<<16), (CT\a6)|(CT\a7<<16)
.endm
.macro ft_row p, ph
.set ft_x, \ph
.rept 80
ft_e %(ft_x%640), %((ft_x+\p)%640), %((ft_x+2*\p)%640), %((ft_x+3*\p)%640), %((ft_x+4*\p)%640), %((ft_x+5*\p)%640), %((ft_x+6*\p)%640), %((ft_x+7*\p)%640)
.set ft_x, (ft_x+8*\p)%640
.endr
.endm
.p2align 8
.type ft_table,@object
ft_table:
ft_row 0, 0
ft_row 320, 0
.set ft_p, 1
.rept 319
ft_row %ft_p, 0
ft_row %ft_p, 160
.set ft_p, ft_p+1
.endr
.size ft_table, 819200
.noaltmacro

.set CG0, 13773
.set CG1, 13773
.set CG2, 13773
.set CG3, 13773
.set CG4, 13773
.set CG5, 13773
.set CG6, 13772
.set CG7, 13772
.set CG8, 13772
.set CG9, 13772
.set CG10, 13772
.set CG11, 13772
.set CG12, 13771
.set CG13, 13771
.set CG14, 13771
.set CG15, 13771
.set CG16, 13770
.set CG17, 13770
.set CG18, 13770
.set CG19, 13769
.set CG20, 13769
.set CG21, 13768
.set CG22, 13768
.set CG23, 13768
.set CG24, 13767
.set CG25, 13767
.set CG26, 13766
.set CG27, 13766
.set CG28, 13765
.set CG29, 13765
.set CG30, 13764
.set CG31, 13763
.set CG32, 13763
.set CG33, 13762
.set CG34, 13761
.set CG35, 13761
.set CG36, 13760
.set CG37, 13759
.set CG38, 13759
.set CG39, 13758
.set CG40, 13757
.set CG41, 13756
.set CG42, 13756
.set CG43, 13755
.set CG44, 13754
.set CG45, 13753
.set CG46, 13752
.set CG47, 13751
.set CG48, 13750
.set CG49, 13750
.set CG50, 13749
.set CG51, 13748
.set CG52, 13747
.set CG53, 13746
.set CG54, 13745
.set CG55, 13744
.set CG56, 13743
.set CG57, 13742
.set CG58, 13740
.set CG59, 13739
.set CG60, 13738
.set CG61, 13737
.set CG62, 13736
.set CG63, 13735
.set CG64, 13734
.set CG65, 13732
.set CG66, 13731
.set CG67, 13730
.set CG68, 13729
.set CG69, 13728
.set CG70, 13726
.set CG71, 13725
.set CG72, 13724
.set CG73, 13722
.set CG74, 13721
.set CG75, 13720
.set CG76, 13718
.set CG77, 13717
.set CG78, 13716
.set CG79, 13714
.set CG80, 13713
.set CG81, 13711
.set CG82, 13710
.set CG83, 13708
.set CG84, 13707
.set CG85, 13706
.set CG86, 13704
.set CG87, 13703
.set CG88, 13701
.set CG89, 13699
.set CG90, 13698
.set CG91, 13696
.set CG92, 13694
.set CG93, 13690
.set CG94, 13687
.set CG95, 13684
.set CG96, 13681
.set CG97, 13677
.set CG98, 13674
.set CG99, 13671
.set CG100, 13668
.set CG101, 13664
.set CG102, 13661
.set CG103, 13657
.set CG104, 13654
.set CG105, 13651
.set CG106, 13647
.set CG107, 13644
.set CG108, 13640
.set CG109, 13637
.set CG110, 13633
.set CG111, 13630
.set CG112, 13626
.set CG113, 13622
.set CG114, 13619
.set CG115, 13615
.set CG116, 13611
.set CG117, 13608
.set CG118, 13604
.set CG119, 13600
.set CG120, 13597
.set CG121, 13593
.set CG122, 13589
.set CG123, 13586
.set CG124, 13582
.set CG125, 13578
.set CG126, 13574
.set CG127, 13570
.set CG128, 13565
.set CG129, 13557
.set CG130, 13550
.set CG131, 13542
.set CG132, 13534
.set CG133, 13527
.set CG134, 13519
.set CG135, 13511
.set CG136, 13503
.set CG137, 13495
.set CG138, 13488
.set CG139, 13480
.set CG140, 13472
.set CG141, 13464
.set CG142, 13456
.set CG143, 13448
.set CG144, 13440
.set CG145, 13424
.set CG146, 13408
.set CG147, 13393
.set CG148, 13377
.set CG149, 13361
.set CG150, 13345
.set CG151, 13329
.set CG152, 13313
.set CG153, 13281
.set CG154, 13249
.set CG155, 13217
.set CG156, 13185
.set CG157, 13121
.set CG158, 13057
.set CG159, 12929
.set CG160, 0
.set CG161, 45697
.set CG162, 45825
.set CG163, 45889
.set CG164, 45953
.set CG165, 45985
.set CG166, 46017
.set CG167, 46049
.set CG168, 46081
.set CG169, 46097
.set CG170, 46113
.set CG171, 46129
.set CG172, 46145
.set CG173, 46161
.set CG174, 46176
.set CG175, 46192
.set CG176, 46208
.set CG177, 46216
.set CG178, 46224
.set CG179, 46232
.set CG180, 46240
.set CG181, 46248
.set CG182, 46256
.set CG183, 46263
.set CG184, 46271
.set CG185, 46279
.set CG186, 46287
.set CG187, 46295
.set CG188, 46302
.set CG189, 46310
.set CG190, 46318
.set CG191, 46325
.set CG192, 46333
.set CG193, 46338
.set CG194, 46342
.set CG195, 46346
.set CG196, 46350
.set CG197, 46354
.set CG198, 46357
.set CG199, 46361
.set CG200, 46365
.set CG201, 46368
.set CG202, 46372
.set CG203, 46376
.set CG204, 46379
.set CG205, 46383
.set CG206, 46387
.set CG207, 46390
.set CG208, 46394
.set CG209, 46398
.set CG210, 46401
.set CG211, 46405
.set CG212, 46408
.set CG213, 46412
.set CG214, 46415
.set CG215, 46419
.set CG216, 46422
.set CG217, 46425
.set CG218, 46429
.set CG219, 46432
.set CG220, 46436
.set CG221, 46439
.set CG222, 46442
.set CG223, 46445
.set CG224, 46449
.set CG225, 46452
.set CG226, 46455
.set CG227, 46458
.set CG228, 46462
.set CG229, 46464
.set CG230, 46466
.set CG231, 46467
.set CG232, 46469
.set CG233, 46471
.set CG234, 46472
.set CG235, 46474
.set CG236, 46475
.set CG237, 46476
.set CG238, 46478
.set CG239, 46479
.set CG240, 46481
.set CG241, 46482
.set CG242, 46484
.set CG243, 46485
.set CG244, 46486
.set CG245, 46488
.set CG246, 46489
.set CG247, 46490
.set CG248, 46492
.set CG249, 46493
.set CG250, 46494
.set CG251, 46496
.set CG252, 46497
.set CG253, 46498
.set CG254, 46499
.set CG255, 46500
.set CG256, 46502
.set CG257, 46503
.set CG258, 46504
.set CG259, 46505
.set CG260, 46506
.set CG261, 46507
.set CG262, 46508
.set CG263, 46510
.set CG264, 46511
.set CG265, 46512
.set CG266, 46513
.set CG267, 46514
.set CG268, 46515
.set CG269, 46516
.set CG270, 46517
.set CG271, 46518
.set CG272, 46518
.set CG273, 46519
.set CG274, 46520
.set CG275, 46521
.set CG276, 46522
.set CG277, 46523
.set CG278, 46524
.set CG279, 46524
.set CG280, 46525
.set CG281, 46526
.set CG282, 46527
.set CG283, 46527
.set CG284, 46528
.set CG285, 46529
.set CG286, 46529
.set CG287, 46530
.set CG288, 46531
.set CG289, 46531
.set CG290, 46532
.set CG291, 46533
.set CG292, 46533
.set CG293, 46534
.set CG294, 46534
.set CG295, 46535
.set CG296, 46535
.set CG297, 46536
.set CG298, 46536
.set CG299, 46536
.set CG300, 46537
.set CG301, 46537
.set CG302, 46538
.set CG303, 46538
.set CG304, 46538
.set CG305, 46539
.set CG306, 46539
.set CG307, 46539
.set CG308, 46539
.set CG309, 46540
.set CG310, 46540
.set CG311, 46540
.set CG312, 46540
.set CG313, 46540
.set CG314, 46540
.set CG315, 46541
.set CG316, 46541
.set CG317, 46541
.set CG318, 46541
.set CG319, 46541
.set CG320, 46541
.set CG321, 46541
.set CG322, 46541
.set CG323, 46541
.set CG324, 46541
.set CG325, 46541
.set CG326, 46540
.set CG327, 46540
.set CG328, 46540
.set CG329, 46540
.set CG330, 46540
.set CG331, 46540
.set CG332, 46539
.set CG333, 46539
.set CG334, 46539
.set CG335, 46539
.set CG336, 46538
.set CG337, 46538
.set CG338, 46538
.set CG339, 46537
.set CG340, 46537
.set CG341, 46536
.set CG342, 46536
.set CG343, 46536
.set CG344, 46535
.set CG345, 46535
.set CG346, 46534
.set CG347, 46534
.set CG348, 46533
.set CG349, 46533
.set CG350, 46532
.set CG351, 46531
.set CG352, 46531
.set CG353, 46530
.set CG354, 46529
.set CG355, 46529
.set CG356, 46528
.set CG357, 46527
.set CG358, 46527
.set CG359, 46526
.set CG360, 46525
.set CG361, 46524
.set CG362, 46524
.set CG363, 46523
.set CG364, 46522
.set CG365, 46521
.set CG366, 46520
.set CG367, 46519
.set CG368, 46518
.set CG369, 46518
.set CG370, 46517
.set CG371, 46516
.set CG372, 46515
.set CG373, 46514
.set CG374, 46513
.set CG375, 46512
.set CG376, 46511
.set CG377, 46510
.set CG378, 46508
.set CG379, 46507
.set CG380, 46506
.set CG381, 46505
.set CG382, 46504
.set CG383, 46503
.set CG384, 46502
.set CG385, 46500
.set CG386, 46499
.set CG387, 46498
.set CG388, 46497
.set CG389, 46496
.set CG390, 46494
.set CG391, 46493
.set CG392, 46492
.set CG393, 46490
.set CG394, 46489
.set CG395, 46488
.set CG396, 46486
.set CG397, 46485
.set CG398, 46484
.set CG399, 46482
.set CG400, 46481
.set CG401, 46479
.set CG402, 46478
.set CG403, 46476
.set CG404, 46475
.set CG405, 46474
.set CG406, 46472
.set CG407, 46471
.set CG408, 46469
.set CG409, 46467
.set CG410, 46466
.set CG411, 46464
.set CG412, 46462
.set CG413, 46458
.set CG414, 46455
.set CG415, 46452
.set CG416, 46449
.set CG417, 46445
.set CG418, 46442
.set CG419, 46439
.set CG420, 46436
.set CG421, 46432
.set CG422, 46429
.set CG423, 46425
.set CG424, 46422
.set CG425, 46419
.set CG426, 46415
.set CG427, 46412
.set CG428, 46408
.set CG429, 46405
.set CG430, 46401
.set CG431, 46398
.set CG432, 46394
.set CG433, 46390
.set CG434, 46387
.set CG435, 46383
.set CG436, 46379
.set CG437, 46376
.set CG438, 46372
.set CG439, 46368
.set CG440, 46365
.set CG441, 46361
.set CG442, 46357
.set CG443, 46354
.set CG444, 46350
.set CG445, 46346
.set CG446, 46342
.set CG447, 46338
.set CG448, 46333
.set CG449, 46325
.set CG450, 46318
.set CG451, 46310
.set CG452, 46302
.set CG453, 46295
.set CG454, 46287
.set CG455, 46279
.set CG456, 46271
.set CG457, 46263
.set CG458, 46256
.set CG459, 46248
.set CG460, 46240
.set CG461, 46232
.set CG462, 46224
.set CG463, 46216
.set CG464, 46208
.set CG465, 46192
.set CG466, 46176
.set CG467, 46161
.set CG468, 46145
.set CG469, 46129
.set CG470, 46113
.set CG471, 46097
.set CG472, 46081
.set CG473, 46049
.set CG474, 46017
.set CG475, 45985
.set CG476, 45953
.set CG477, 45889
.set CG478, 45825
.set CG479, 45697
.set CG480, 0
.set CG481, 12929
.set CG482, 13057
.set CG483, 13121
.set CG484, 13185
.set CG485, 13217
.set CG486, 13249
.set CG487, 13281
.set CG488, 13313
.set CG489, 13329
.set CG490, 13345
.set CG491, 13361
.set CG492, 13377
.set CG493, 13393
.set CG494, 13408
.set CG495, 13424
.set CG496, 13440
.set CG497, 13448
.set CG498, 13456
.set CG499, 13464
.set CG500, 13472
.set CG501, 13480
.set CG502, 13488
.set CG503, 13495
.set CG504, 13503
.set CG505, 13511
.set CG506, 13519
.set CG507, 13527
.set CG508, 13534
.set CG509, 13542
.set CG510, 13550
.set CG511, 13557
.set CG512, 13565
.set CG513, 13570
.set CG514, 13574
.set CG515, 13578
.set CG516, 13582
.set CG517, 13586
.set CG518, 13589
.set CG519, 13593
.set CG520, 13597
.set CG521, 13600
.set CG522, 13604
.set CG523, 13608
.set CG524, 13611
.set CG525, 13615
.set CG526, 13619
.set CG527, 13622
.set CG528, 13626
.set CG529, 13630
.set CG530, 13633
.set CG531, 13637
.set CG532, 13640
.set CG533, 13644
.set CG534, 13647
.set CG535, 13651
.set CG536, 13654
.set CG537, 13657
.set CG538, 13661
.set CG539, 13664
.set CG540, 13668
.set CG541, 13671
.set CG542, 13674
.set CG543, 13677
.set CG544, 13681
.set CG545, 13684
.set CG546, 13687
.set CG547, 13690
.set CG548, 13694
.set CG549, 13696
.set CG550, 13698
.set CG551, 13699
.set CG552, 13701
.set CG553, 13703
.set CG554, 13704
.set CG555, 13706
.set CG556, 13707
.set CG557, 13708
.set CG558, 13710
.set CG559, 13711
.set CG560, 13713
.set CG561, 13714
.set CG562, 13716
.set CG563, 13717
.set CG564, 13718
.set CG565, 13720
.set CG566, 13721
.set CG567, 13722
.set CG568, 13724
.set CG569, 13725
.set CG570, 13726
.set CG571, 13728
.set CG572, 13729
.set CG573, 13730
.set CG574, 13731
.set CG575, 13732
.set CG576, 13734
.set CG577, 13735
.set CG578, 13736
.set CG579, 13737
.set CG580, 13738
.set CG581, 13739
.set CG582, 13740
.set CG583, 13742
.set CG584, 13743
.set CG585, 13744
.set CG586, 13745
.set CG587, 13746
.set CG588, 13747
.set CG589, 13748
.set CG590, 13749
.set CG591, 13750
.set CG592, 13750
.set CG593, 13751
.set CG594, 13752
.set CG595, 13753
.set CG596, 13754
.set CG597, 13755
.set CG598, 13756
.set CG599, 13756
.set CG600, 13757
.set CG601, 13758
.set CG602, 13759
.set CG603, 13759
.set CG604, 13760
.set CG605, 13761
.set CG606, 13761
.set CG607, 13762
.set CG608, 13763
.set CG609, 13763
.set CG610, 13764
.set CG611, 13765
.set CG612, 13765
.set CG613, 13766
.set CG614, 13766
.set CG615, 13767
.set CG616, 13767
.set CG617, 13768
.set CG618, 13768
.set CG619, 13768
.set CG620, 13769
.set CG621, 13769
.set CG622, 13770
.set CG623, 13770
.set CG624, 13770
.set CG625, 13771
.set CG626, 13771
.set CG627, 13771
.set CG628, 13771
.set CG629, 13772
.set CG630, 13772
.set CG631, 13772
.set CG632, 13772
.set CG633, 13772
.set CG634, 13772
.set CG635, 13773
.set CG636, 13773
.set CG637, 13773
.set CG638, 13773
.set CG639, 13773
.set CH0, 13645
.set CH320, 46413
.set GF_PAD, 0
.set GF_SIZE, 819200

.altmacro
.macro gf_e a0, a1, a2, a3, a4, a5, a6, a7
.long (CG\a0)|(CG\a1<<16), (CG\a2)|(CG\a3<<16), (CG\a4)|(CG\a5<<16), (CG\a6)|(CG\a7<<16)
.endm
.macro gf_e0 b0, a2, a3, a4, a5, a6, a7
.long (CH\b0), (CG\a2)|(CG\a3<<16), (CG\a4)|(CG\a5<<16), (CG\a6)|(CG\a7<<16)
.endm
.macro gf_grp p, d0
.set gf_d, \d0
.rept 16
.if \p == 0
gf_e0 %((320*gf_d)%640), %(gf_d%640), %((gf_d+160)%640), %((2*gf_d)%640), %((2*gf_d+160)%640), %((3*gf_d)%640), %((3*gf_d+160)%640)
.else
gf_e %((\p*gf_d)%640), %((\p*gf_d+160)%640), %(((\p+1)*gf_d)%640), %(((\p+1)*gf_d+160)%640), %(((\p+2)*gf_d)%640), %(((\p+2)*gf_d+160)%640), %(((\p+3)*gf_d)%640), %(((\p+3)*gf_d+160)%640)
.endif
.set gf_d, gf_d+1
.endr
.endm
.p2align 8
.type gf_table,@object
gf_table:
.set gf_n, 0
.rept 40
.set gf_p, 0
.rept 80
gf_grp %gf_p, %gf_n
.set gf_p, gf_p+4
.endr
.zero GF_PAD
.set gf_n, gf_n+16
.endr
.size gf_table, GF_SIZE
.noaltmacro

.p2align 8
.type fft_table,@object
fft_table:
.long 0x3f803f80,0x3f803f80,0x3f803f80,0x3f803f80,0x3f7b3f80,0x3f553f6d,0xbe48248d,0xbf0ebec4
.long 0x3f6d3f80,0x3ec43f35,0xbf6dbf80,0xbec4bf35,0x3f553f80,0xbe483ec4,0x3f0ea554,0x3f7b3f6d
.long 0x3f353f80,0xbf35248d,0x3f353f80,0xbf35248d,0x3f0e3f80,0xbf7bbec4,0xbf55248d,0xbe48bf6d
.long 0x3ec43f80,0xbf6dbf35,0xbec4bf80,0x3f6d3f35,0x3e483f80,0xbf0ebf6d,0x3f7ba554,0xbf553ec4
.long 0x248d3f80,0xa554bf80,0x248d3f80,0xa554bf80,0xbe483f80,0x3f0ebf6d,0xbf7b248d,0x3f553ec4
.long 0xbec43f80,0x3f6dbf35,0x3ec4bf80,0xbf6d3f35,0xbf0e3f80,0x3f7bbec4,0x3f55a554,0x3e48bf6d
.long 0xbf353f80,0x3f35a554,0xbf353f80,0x3f35a554,0xbf553f80,0x3e483ec4,0xbf0e248d,0xbf7b3f6d
.long 0xbf6d3f80,0xbec43f35,0x3f6dbf80,0x3ec4bf35,0xbf7b3f80,0xbf553f6d,0x3e48a554,0x3f0ebec4
.long 0xbf803f80,0xbf803f80,0xbf803f80,0xbf803f80,0xbf7b3f80,0xbf553f6d,0x3e48248d,0x3f0ebec4
.long 0xbf6d3f80,0xbec43f35,0x3f6dbf80,0x3ec4bf35,0xbf553f80,0x3e483ec4,0xbf0ea554,0xbf7b3f6d
.long 0xbf353f80,0x3f35248d,0xbf353f80,0x3f35248d,0xbf0e3f80,0x3f7bbec4,0x3f55248d,0x3e48bf6d
.long 0xbec43f80,0x3f6dbf35,0x3ec4bf80,0xbf6d3f35,0xbe483f80,0x3f0ebf6d,0xbf7ba554,0x3f553ec4
.long 0xa5543f80,0x248dbf80,0xa5543f80,0x248dbf80,0x3e483f80,0xbf0ebf6d,0x3f7b248d,0xbf553ec4
.long 0x3ec43f80,0xbf6dbf35,0xbec4bf80,0x3f6d3f35,0x3f0e3f80,0xbf7bbec4,0xbf55a554,0xbe48bf6d
.long 0x3f353f80,0xbf35a554,0x3f353f80,0xbf35a554,0x3f553f80,0xbe483ec4,0x3f0e248d,0x3f7b3f6d
.long 0x3f6d3f80,0x3ec43f35,0xbf6dbf80,0xbec4bf35,0x3f7b3f80,0x3f553f6d,0xbe48a554,0xbf0ebec4
.long 0x3f803f80,0x3f803f80,0x3f803f80,0x3f803f80,0x3f0e3f35,0x3e483ec4,0xbf55bf35,0xbf7bbf6d
.long 0xbec4248d,0xbf6dbf35,0x3ec4a554,0x3f6d3f35,0xbf7bbf35,0xbf0ebf6d,0x3e483f35,0xbf55bec4
.long 0xbf35bf80,0x3f35a554,0xbf35bf80,0x3f35a554,0x3e48bf35,0x3f553f6d,0x3f7b3f35,0xbf0e3ec4
.long 0x3f6da554,0xbec43f35,0xbf6d248d,0x3ec4bf35,0x3f553f35,0xbf7bbec4,0x3f0ebf35,0xbe483f6d
.long 0x248d3f80,0xa554bf80,0x248d3f80,0xa554bf80,0xbf553f35,0x3f7bbec4,0xbf0ebf35,0x3e483f6d
.long 0xbf6d248d,0x3ec43f35,0x3f6da554,0xbec4bf35,0xbe48bf35,0xbf553f6d,0xbf7b3f35,0x3f0e3ec4
.long 0x3f35bf80,0xbf35248d,0x3f35bf80,0xbf35248d,0x3f7bbf35,0x3f0ebf6d,0xbe483f35,0x3f55bec4
.long 0x3ec4a554,0x3f6dbf35,0xbec4248d,0xbf6d3f35,0xbf0e3f35,0xbe483ec4,0x3f55bf35,0x3f7bbf6d
.long 0xbf803f80,0xbf803f80,0xbf803f80,0xbf803f80,0xbf0e3f35,0xbe483ec4,0x3f55bf35,0x3f7bbf6d
.long 0x3ec4248d,0x3f6dbf35,0xbec4a554,0xbf6d3f35,0x3f7bbf35,0x3f0ebf6d,0xbe483f35,0x3f55bec4
.long 0x3f35bf80,0xbf35a554,0x3f35bf80,0xbf35a554,0xbe48bf35,0xbf553f6d,0xbf7b3f35,0x3f0e3ec4
.long 0xbf6da554,0x3ec43f35,0x3f6d248d,0xbec4bf35,0xbf553f35,0x3f7bbec4,0xbf0ebf35,0x3e483f6d
.long 0xa5543f80,0x248dbf80,0xa5543f80,0x248dbf80,0x3f553f35,0xbf7bbec4,0x3f0ebf35,0xbe483f6d
.long 0x3f6d248d,0xbec43f35,0xbf6da554,0x3ec4bf35,0x3e48bf35,0x3f553f6d,0x3f7b3f35,0xbf0e3ec4
.long 0xbf35bf80,0x3f35248d,0xbf35bf80,0x3f35248d,0xbf7bbf35,0xbf0ebf6d,0x3e483f35,0xbf55bec4
.long 0xbec4a554,0xbf6dbf35,0x3ec4248d,0x3f6d3f35,0x3f0e3f35,0x3e483ec4,0xbf55bf35,0xbf7bbf6d
.long 0x3f803f80,0x3f803f80,0x3f803f80,0x3f803f80,0xbf7bbf80,0xbf55bf6d,0x3e48a554,0x3f0e3ec4
.long 0x3f6d3f80,0x3ec43f35,0xbf6dbf80,0xbec4bf35,0xbf55bf80,0x3e48bec4,0xbf0e248d,0xbf7bbf6d
.long 0x3f353f80,0xbf35248d,0x3f353f80,0xbf35248d,0xbf0ebf80,0x3f7b3ec4,0x3f55a554,0x3e483f6d
.long 0x3ec43f80,0xbf6dbf35,0xbec4bf80,0x3f6d3f35,0xbe48bf80,0x3f0e3f6d,0xbf7b248d,0x3f55bec4
.long 0x248d3f80,0xa554bf80,0x248d3f80,0xa554bf80,0x3e48bf80,0xbf0e3f6d,0x3f7ba554,0xbf55bec4
.long 0xbec43f80,0x3f6dbf35,0x3ec4bf80,0xbf6d3f35,0x3f0ebf80,0xbf7b3ec4,0xbf55248d,0xbe483f6d
.long 0xbf353f80,0x3f35a554,0xbf353f80,0x3f35a554,0x3f55bf80,0xbe48bec4,0x3f0ea554,0x3f7bbf6d
.long 0xbf6d3f80,0xbec43f35,0x3f6dbf80,0x3ec4bf35,0x3f7bbf80,0x3f55bf6d,0xbe48248d,0xbf0e3ec4
.long 0xbf803f80,0xbf803f80,0xbf803f80,0xbf803f80,0x3f7bbf80,0x3f55bf6d,0xbe48a554,0xbf0e3ec4
.long 0xbf6d3f80,0xbec43f35,0x3f6dbf80,0x3ec4bf35,0x3f55bf80,0xbe48bec4,0x3f0e248d,0x3f7bbf6d
.long 0xbf353f80,0x3f35248d,0xbf353f80,0x3f35248d,0x3f0ebf80,0xbf7b3ec4,0xbf55a554,0xbe483f6d
.long 0xbec43f80,0x3f6dbf35,0x3ec4bf80,0xbf6d3f35,0x3e48bf80,0xbf0e3f6d,0x3f7b248d,0xbf55bec4
.long 0xa5543f80,0x248dbf80,0xa5543f80,0x248dbf80,0xbe48bf80,0x3f0e3f6d,0xbf7ba554,0x3f55bec4
.long 0x3ec43f80,0xbf6dbf35,0xbec4bf80,0x3f6d3f35,0xbf0ebf80,0x3f7b3ec4,0x3f55248d,0x3e483f6d
.long 0x3f353f80,0xbf35a554,0x3f353f80,0xbf35a554,0xbf55bf80,0x3e48bec4,0xbf0ea554,0xbf7bbf6d
.long 0x3f6d3f80,0x3ec43f35,0xbf6dbf80,0xbec4bf35,0xbf7bbf80,0xbf55bf6d,0x3e48248d,0x3f0e3ec4
.long 0x3f803f80,0x3f803f80,0x3f803f80,0x3f803f80,0xbf0ebf35,0xbe48bec4,0x3f553f35,0x3f7b3f6d
.long 0xbec4248d,0xbf6dbf35,0x3ec4a554,0x3f6d3f35,0x3f7b3f35,0x3f0e3f6d,0xbe48bf35,0x3f553ec4
.long 0xbf35bf80,0x3f35a554,0xbf35bf80,0x3f35a554,0xbe483f35,0xbf55bf6d,0xbf7bbf35,0x3f0ebec4
.long 0x3f6da554,0xbec43f35,0xbf6d248d,0x3ec4bf35,0xbf55bf35,0x3f7b3ec4,0xbf0e3f35,0x3e48bf6d
.long 0x248d3f80,0xa554bf80,0x248d3f80,0xa554bf80,0x3f55bf35,0xbf7b3ec4,0x3f0e3f35,0xbe48bf6d
.long 0xbf6d248d,0x3ec43f35,0x3f6da554,0xbec4bf35,0x3e483f35,0x3f55bf6d,0x3f7bbf35,0xbf0ebec4
.long 0x3f35bf80,0xbf35248d,0x3f35bf80,0xbf35248d,0xbf7b3f35,0xbf0e3f6d,0x3e48bf35,0xbf553ec4
.long 0x3ec4a554,0x3f6dbf35,0xbec4248d,0xbf6d3f35,0x3f0ebf35,0x3e48bec4,0xbf553f35,0xbf7b3f6d
.long 0xbf803f80,0xbf803f80,0xbf803f80,0xbf803f80,0x3f0ebf35,0x3e48bec4,0xbf553f35,0xbf7b3f6d
.long 0x3ec4248d,0x3f6dbf35,0xbec4a554,0xbf6d3f35,0xbf7b3f35,0xbf0e3f6d,0x3e48bf35,0xbf553ec4
.long 0x3f35bf80,0xbf35a554,0x3f35bf80,0xbf35a554,0x3e483f35,0x3f55bf6d,0x3f7bbf35,0xbf0ebec4
.long 0xbf6da554,0x3ec43f35,0x3f6d248d,0xbec4bf35,0x3f55bf35,0xbf7b3ec4,0x3f0e3f35,0xbe48bf6d
.long 0xa5543f80,0x248dbf80,0xa5543f80,0x248dbf80,0xbf55bf35,0x3f7b3ec4,0xbf0e3f35,0x3e48bf6d
.long 0x3f6d248d,0xbec43f35,0xbf6da554,0x3ec4bf35,0xbe483f35,0xbf55bf6d,0xbf7bbf35,0x3f0ebec4
.long 0xbf35bf80,0x3f35248d,0xbf35bf80,0x3f35248d,0x3f7b3f35,0x3f0e3f6d,0xbe48bf35,0x3f553ec4
.long 0xbec4a554,0xbf6dbf35,0x3ec4248d,0x3f6d3f35,0xbf0ebf35,0xbe48bec4,0x3f553f35,0x3f7b3f6d
.long 0x80008000,0x80008000,0x80008000,0x80008000,0xbe488000,0xbf0ebec4,0xbf7bbf80,0xbf55bf6d
.long 0xbec48000,0xbf6dbf35,0x3ec4a50d,0x3f6d3f35,0xbf0e8000,0xbf7bbf6d,0x3f553f80,0xbe483ec4
.long 0xbf358000,0xbf35bf80,0xbf358000,0xbf35bf80,0xbf558000,0xbe48bf6d,0xbf0ebf80,0x3f7b3ec4
.long 0xbf6d8000,0x3ec4bf35,0x3f6da50d,0xbec43f35,0xbf7b8000,0x3f55bec4,0x3e483f80,0xbf0ebf6d
.long 0xbf808000,0x3f80a50d,0xbf808000,0x3f80a50d,0xbf7b8000,0x3f553ec4,0x3e48bf80,0xbf0e3f6d
.long 0xbf6d8000,0x3ec43f35,0x3f6da50d,0xbec4bf35,0xbf558000,0xbe483f6d,0xbf0e3f80,0x3f7bbec4
.long 0xbf358000,0xbf353f80,0xbf358000,0xbf353f80,0xbf0e8000,0xbf7b3f6d,0x3f55bf80,0xbe48bec4
.long 0xbec48000,0xbf6d3f35,0x3ec4a50d,0x3f6dbf35,0xbe488000,0xbf0e3ec4,0xbf7b3f80,0xbf553f6d
.long 0xa50d8000,0xa50d8000,0xa50d8000,0xa50d8000,0x3e488000,0x3f0ebec4,0x3f7bbf80,0x3f55bf6d
.long 0x3ec48000,0x3f6dbf35,0xbec4a50d,0xbf6d3f35,0x3f0e8000,0x3f7bbf6d,0xbf553f80,0x3e483ec4
.long 0x3f358000,0x3f35bf80,0x3f358000,0x3f35bf80,0x3f558000,0x3e48bf6d,0x3f0ebf80,0xbf7b3ec4
.long 0x3f6d8000,0xbec4bf35,0xbf6da50d,0x3ec43f35,0x3f7b8000,0xbf55bec4,0xbe483f80,0x3f0ebf6d
.long 0x3f808000,0xbf80a50d,0x3f808000,0xbf80a50d,0x3f7b8000,0xbf553ec4,0xbe48bf80,0x3f0e3f6d
.long 0x3f6d8000,0xbec43f35,0xbf6da50d,0x3ec4bf35,0x3f558000,0x3e483f6d,0x3f0e3f80,0xbf7bbec4
.long 0x3f358000,0x3f353f80,0x3f358000,0x3f353f80,0x3f0e8000,0x3f7b3f6d,0xbf55bf80,0x3e48bec4
.long 0x3ec48000,0x3f6d3f35,0xbec4a50d,0xbf6dbf35,0x3e488000,0x3f0e3ec4,0x3f7b3f80,0x3f553f6d
.long 0x80008000,0x80008000,0x80008000,0x80008000,0xbf55bf35,0xbf7bbf6d,0xbf0ebf35,0xbe48bec4
.long 0xbf6dbf80,0xbec4bf35,0x3f6d3f80,0x3ec43f35,0xbe48bf35,0x3f553ec4,0xbf7bbf35,0xbf0ebf6d
.long 0x3f35a50d,0x3f353f80,0x3f35a50d,0x3f353f80,0x3f7b3f35,0xbf0e3ec4,0xbe483f35,0xbf55bf6d
.long 0x3ec43f80,0xbf6dbf35,0xbec4bf80,0x3f6d3f35,0xbf0e3f35,0x3e48bf6d,0x3f553f35,0xbf7bbec4
.long 0xbf808000,0x3f80a50d,0xbf808000,0x3f80a50d,0xbf0ebf35,0x3e483f6d,0x3f55bf35,0xbf7b3ec4
.long 0x3ec4bf80,0xbf6d3f35,0xbec43f80,0x3f6dbf35,0x3f7bbf35,0xbf0ebec4,0xbe48bf35,0xbf553f6d
.long 0x3f35a50d,0x3f35bf80,0x3f35a50d,0x3f35bf80,0xbe483f35,0x3f55bec4,0xbf7b3f35,0xbf0e3f6d
.long 0xbf6d3f80,0xbec43f35,0x3f6dbf80,0x3ec4bf35,0xbf553f35,0xbf7b3f6d,0xbf0e3f35,0xbe483ec4
.long 0xa50d8000,0xa50d8000,0xa50d8000,0xa50d8000,0x3f55bf35,0x3f7bbf6d,0x3f0ebf35,0x3e48bec4
.long 0x3f6dbf80,0x3ec4bf35,0xbf6d3f80,0xbec43f35,0x3e48bf35,0xbf553ec4,0x3f7bbf35,0x3f0ebf6d
.long 0xbf35a50d,0xbf353f80,0xbf35a50d,0xbf353f80,0xbf7b3f35,0x3f0e3ec4,0x3e483f35,0x3f55bf6d
.long 0xbec43f80,0x3f6dbf35,0x3ec4bf80,0xbf6d3f35,0x3f0e3f35,0xbe48bf6d,0xbf553f35,0x3f7bbec4
.long 0x3f808000,0xbf80a50d,0x3f808000,0xbf80a50d,0x3f0ebf35,0xbe483f6d,0xbf55bf35,0x3f7b3ec4
.long 0xbec4bf80,0x3f6d3f35,0x3ec43f80,0xbf6dbf35,0xbf7bbf35,0x3f0ebec4,0x3e48bf35,0x3f553f6d
.long 0xbf35a50d,0xbf35bf80,0xbf35a50d,0xbf35bf80,0x3e483f35,0xbf55bec4,0x3f7b3f35,0x3f0e3f6d
.long 0x3f6d3f80,0x3ec43f35,0xbf6dbf80,0xbec4bf35,0x3f553f35,0x3f7b3f6d,0x3f0e3f35,0x3e483ec4
.long 0x80008000,0x80008000,0x80008000,0x80008000,0x3e48a50d,0x3f0e3ec4,0x3f7b3f80,0x3f553f6d
.long 0xbec48000,0xbf6dbf35,0x3ec4a50d,0x3f6d3f35,0x3f0ea50d,0x3f7b3f6d,0xbf55bf80,0x3e48bec4
.long 0xbf358000,0xbf35bf80,0xbf358000,0xbf35bf80,0x3f55a50d,0x3e483f6d,0x3f0e3f80,0xbf7bbec4
.long 0xbf6d8000,0x3ec4bf35,0x3f6da50d,0xbec43f35,0x3f7ba50d,0xbf553ec4,0xbe48bf80,0x3f0e3f6d
.long 0xbf808000,0x3f80a50d,0xbf808000,0x3f80a50d,0x3f7ba50d,0xbf55bec4,0xbe483f80,0x3f0ebf6d
.long 0xbf6d8000,0x3ec43f35,0x3f6da50d,0xbec4bf35,0x3f55a50d,0x3e48bf6d,0x3f0ebf80,0xbf7b3ec4
.long 0xbf358000,0xbf353f80,0xbf358000,0xbf353f80,0x3f0ea50d,0x3f7bbf6d,0xbf553f80,0x3e483ec4
.long 0xbec48000,0xbf6d3f35,0x3ec4a50d,0x3f6dbf35,0x3e48a50d,0x3f0ebec4,0x3f7bbf80,0x3f55bf6d
.long 0xa50d8000,0xa50d8000,0xa50d8000,0xa50d8000,0xbe48a50d,0xbf0e3ec4,0xbf7b3f80,0xbf553f6d
.long 0x3ec48000,0x3f6dbf35,0xbec4a50d,0xbf6d3f35,0xbf0ea50d,0xbf7b3f6d,0x3f55bf80,0xbe48bec4
.long 0x3f358000,0x3f35bf80,0x3f358000,0x3f35bf80,0xbf55a50d,0xbe483f6d,0xbf0e3f80,0x3f7bbec4
.long 0x3f6d8000,0xbec4bf35,0xbf6da50d,0x3ec43f35,0xbf7ba50d,0x3f553ec4,0x3e48bf80,0xbf0e3f6d
.long 0x3f808000,0xbf80a50d,0x3f808000,0xbf80a50d,0xbf7ba50d,0x3f55bec4,0x3e483f80,0xbf0ebf6d
.long 0x3f6d8000,0xbec43f35,0xbf6da50d,0x3ec4bf35,0xbf55a50d,0xbe48bf6d,0xbf0ebf80,0x3f7b3ec4
.long 0x3f358000,0x3f353f80,0x3f358000,0x3f353f80,0xbf0ea50d,0xbf7bbf6d,0x3f553f80,0xbe483ec4
.long 0x3ec48000,0x3f6d3f35,0xbec4a50d,0xbf6dbf35,0xbe48a50d,0xbf0ebec4,0xbf7bbf80,0xbf55bf6d
.long 0x80008000,0x80008000,0x80008000,0x80008000,0x3f553f35,0x3f7b3f6d,0x3f0e3f35,0x3e483ec4
.long 0xbf6dbf80,0xbec4bf35,0x3f6d3f80,0x3ec43f35,0x3e483f35,0xbf55bec4,0x3f7b3f35,0x3f0e3f6d
.long 0x3f35a50d,0x3f353f80,0x3f35a50d,0x3f353f80,0xbf7bbf35,0x3f0ebec4,0x3e48bf35,0x3f553f6d
.long 0x3ec43f80,0xbf6dbf35,0xbec4bf80,0x3f6d3f35,0x3f0ebf35,0xbe483f6d,0xbf55bf35,0x3f7b3ec4
.long 0xbf808000,0x3f80a50d,0xbf808000,0x3f80a50d,0x3f0e3f35,0xbe48bf6d,0xbf553f35,0x3f7bbec4
.long 0x3ec4bf80,0xbf6d3f35,0xbec43f80,0x3f6dbf35,0xbf7b3f35,0x3f0e3ec4,0x3e483f35,0x3f55bf6d
.long 0x3f35a50d,0x3f35bf80,0x3f35a50d,0x3f35bf80,0x3e48bf35,0xbf553ec4,0x3f7bbf35,0x3f0ebf6d
.long 0xbf6d3f80,0xbec43f35,0x3f6dbf80,0x3ec4bf35,0x3f55bf35,0x3f7bbf6d,0x3f0ebf35,0x3e48bec4
.long 0xa50d8000,0xa50d8000,0xa50d8000,0xa50d8000,0xbf553f35,0xbf7b3f6d,0xbf0e3f35,0xbe483ec4
.long 0x3f6dbf80,0x3ec4bf35,0xbf6d3f80,0xbec43f35,0xbe483f35,0x3f55bec4,0xbf7b3f35,0xbf0e3f6d
.long 0xbf35a50d,0xbf353f80,0xbf35a50d,0xbf353f80,0x3f7bbf35,0xbf0ebec4,0xbe48bf35,0xbf553f6d
.long 0xbec43f80,0x3f6dbf35,0x3ec4bf80,0xbf6d3f35,0xbf0ebf35,0x3e483f6d,0x3f55bf35,0xbf7b3ec4
.long 0x3f808000,0xbf80a50d,0x3f808000,0xbf80a50d,0xbf0e3f35,0x3e48bf6d,0x3f553f35,0xbf7bbec4
.long 0xbec4bf80,0x3f6d3f35,0x3ec43f80,0xbf6dbf35,0x3f7b3f35,0xbf0e3ec4,0xbe483f35,0xbf55bf6d
.long 0xbf35a50d,0xbf35bf80,0xbf35a50d,0xbf35bf80,0xbe48bf35,0x3f553ec4,0xbf7bbf35,0xbf0ebf6d
.long 0x3f6d3f80,0x3ec43f35,0xbf6dbf80,0xbec4bf35,0xbf55bf35,0xbf7bbf6d,0xbf0ebf35,0xbe48bec4
.long 0x0,0x0,0x0,0x0,0x3e480000,0x3f0e3ec4,0x3f7b3f80,0x3f553f6d
.long 0x3ec40000,0x3f6d3f35,0xbec4250d,0xbf6dbf35,0x3f0e0000,0x3f7b3f6d,0xbf55bf80,0x3e48bec4
.long 0x3f350000,0x3f353f80,0x3f350000,0x3f353f80,0x3f550000,0x3e483f6d,0x3f0e3f80,0xbf7bbec4
.long 0x3f6d0000,0xbec43f35,0xbf6d250d,0x3ec4bf35,0x3f7b0000,0xbf553ec4,0xbe48bf80,0x3f0e3f6d
.long 0x3f800000,0xbf80250d,0x3f800000,0xbf80250d,0x3f7b0000,0xbf55bec4,0xbe483f80,0x3f0ebf6d
.long 0x3f6d0000,0xbec4bf35,0xbf6d250d,0x3ec43f35,0x3f550000,0x3e48bf6d,0x3f0ebf80,0xbf7b3ec4
.long 0x3f350000,0x3f35bf80,0x3f350000,0x3f35bf80,0x3f0e0000,0x3f7bbf6d,0xbf553f80,0x3e483ec4
.long 0x3ec40000,0x3f6dbf35,0xbec4250d,0xbf6d3f35,0x3e480000,0x3f0ebec4,0x3f7bbf80,0x3f55bf6d
.long 0x250d0000,0x250d0000,0x250d0000,0x250d0000,0xbe480000,0xbf0e3ec4,0xbf7b3f80,0xbf553f6d
.long 0xbec40000,0xbf6d3f35,0x3ec4250d,0x3f6dbf35,0xbf0e0000,0xbf7b3f6d,0x3f55bf80,0xbe48bec4
.long 0xbf350000,0xbf353f80,0xbf350000,0xbf353f80,0xbf550000,0xbe483f6d,0xbf0e3f80,0x3f7bbec4
.long 0xbf6d0000,0x3ec43f35,0x3f6d250d,0xbec4bf35,0xbf7b0000,0x3f553ec4,0x3e48bf80,0xbf0e3f6d
.long 0xbf800000,0x3f80250d,0xbf800000,0x3f80250d,0xbf7b0000,0x3f55bec4,0x3e483f80,0xbf0ebf6d
.long 0xbf6d0000,0x3ec4bf35,0x3f6d250d,0xbec43f35,0xbf550000,0xbe48bf6d,0xbf0ebf80,0x3f7b3ec4
.long 0xbf350000,0xbf35bf80,0xbf350000,0xbf35bf80,0xbf0e0000,0xbf7bbf6d,0x3f553f80,0xbe483ec4
.long 0xbec40000,0xbf6dbf35,0x3ec4250d,0x3f6d3f35,0xbe480000,0xbf0ebec4,0xbf7bbf80,0xbf55bf6d
.long 0x0,0x0,0x0,0x0,0x3f553f35,0x3f7b3f6d,0x3f0e3f35,0x3e483ec4
.long 0x3f6d3f80,0x3ec43f35,0xbf6dbf80,0xbec4bf35,0x3e483f35,0xbf55bec4,0x3f7b3f35,0x3f0e3f6d
.long 0xbf35250d,0xbf35bf80,0xbf35250d,0xbf35bf80,0xbf7bbf35,0x3f0ebec4,0x3e48bf35,0x3f553f6d
.long 0xbec4bf80,0x3f6d3f35,0x3ec43f80,0xbf6dbf35,0x3f0ebf35,0xbe483f6d,0xbf55bf35,0x3f7b3ec4
.long 0x3f800000,0xbf80250d,0x3f800000,0xbf80250d,0x3f0e3f35,0xbe48bf6d,0xbf553f35,0x3f7bbec4
.long 0xbec43f80,0x3f6dbf35,0x3ec4bf80,0xbf6d3f35,0xbf7b3f35,0x3f0e3ec4,0x3e483f35,0x3f55bf6d
.long 0xbf35250d,0xbf353f80,0xbf35250d,0xbf353f80,0x3e48bf35,0xbf553ec4,0x3f7bbf35,0x3f0ebf6d
.long 0x3f6dbf80,0x3ec4bf35,0xbf6d3f80,0xbec43f35,0x3f55bf35,0x3f7bbf6d,0x3f0ebf35,0x3e48bec4
.long 0x250d0000,0x250d0000,0x250d0000,0x250d0000,0xbf553f35,0xbf7b3f6d,0xbf0e3f35,0xbe483ec4
.long 0xbf6d3f80,0xbec43f35,0x3f6dbf80,0x3ec4bf35,0xbe483f35,0x3f55bec4,0xbf7b3f35,0xbf0e3f6d
.long 0x3f35250d,0x3f35bf80,0x3f35250d,0x3f35bf80,0x3f7bbf35,0xbf0ebec4,0xbe48bf35,0xbf553f6d
.long 0x3ec4bf80,0xbf6d3f35,0xbec43f80,0x3f6dbf35,0xbf0ebf35,0x3e483f6d,0x3f55bf35,0xbf7b3ec4
.long 0xbf800000,0x3f80250d,0xbf800000,0x3f80250d,0xbf0e3f35,0x3e48bf6d,0x3f553f35,0xbf7bbec4
.long 0x3ec43f80,0xbf6dbf35,0xbec4bf80,0x3f6d3f35,0x3f7b3f35,0xbf0e3ec4,0xbe483f35,0xbf55bf6d
.long 0x3f35250d,0x3f353f80,0x3f35250d,0x3f353f80,0xbe48bf35,0x3f553ec4,0xbf7bbf35,0xbf0ebf6d
.long 0xbf6dbf80,0xbec4bf35,0x3f6d3f80,0x3ec43f35,0xbf55bf35,0xbf7bbf6d,0xbf0ebf35,0xbe48bec4
.long 0x0,0x0,0x0,0x0,0xbe48250d,0xbf0ebec4,0xbf7bbf80,0xbf55bf6d
.long 0x3ec40000,0x3f6d3f35,0xbec4250d,0xbf6dbf35,0xbf0e250d,0xbf7bbf6d,0x3f553f80,0xbe483ec4
.long 0x3f350000,0x3f353f80,0x3f350000,0x3f353f80,0xbf55250d,0xbe48bf6d,0xbf0ebf80,0x3f7b3ec4
.long 0x3f6d0000,0xbec43f35,0xbf6d250d,0x3ec4bf35,0xbf7b250d,0x3f55bec4,0x3e483f80,0xbf0ebf6d
.long 0x3f800000,0xbf80250d,0x3f800000,0xbf80250d,0xbf7b250d,0x3f553ec4,0x3e48bf80,0xbf0e3f6d
.long 0x3f6d0000,0xbec4bf35,0xbf6d250d,0x3ec43f35,0xbf55250d,0xbe483f6d,0xbf0e3f80,0x3f7bbec4
.long 0x3f350000,0x3f35bf80,0x3f350000,0x3f35bf80,0xbf0e250d,0xbf7b3f6d,0x3f55bf80,0xbe48bec4
.long 0x3ec40000,0x3f6dbf35,0xbec4250d,0xbf6d3f35,0xbe48250d,0xbf0e3ec4,0xbf7b3f80,0xbf553f6d
.long 0x250d0000,0x250d0000,0x250d0000,0x250d0000,0x3e48250d,0x3f0ebec4,0x3f7bbf80,0x3f55bf6d
.long 0xbec40000,0xbf6d3f35,0x3ec4250d,0x3f6dbf35,0x3f0e250d,0x3f7bbf6d,0xbf553f80,0x3e483ec4
.long 0xbf350000,0xbf353f80,0xbf350000,0xbf353f80,0x3f55250d,0x3e48bf6d,0x3f0ebf80,0xbf7b3ec4
.long 0xbf6d0000,0x3ec43f35,0x3f6d250d,0xbec4bf35,0x3f7b250d,0xbf55bec4,0xbe483f80,0x3f0ebf6d
.long 0xbf800000,0x3f80250d,0xbf800000,0x3f80250d,0x3f7b250d,0xbf553ec4,0xbe48bf80,0x3f0e3f6d
.long 0xbf6d0000,0x3ec4bf35,0x3f6d250d,0xbec43f35,0x3f55250d,0x3e483f6d,0x3f0e3f80,0xbf7bbec4
.long 0xbf350000,0xbf35bf80,0xbf350000,0xbf35bf80,0x3f0e250d,0x3f7b3f6d,0xbf55bf80,0x3e48bec4
.long 0xbec40000,0xbf6dbf35,0x3ec4250d,0x3f6d3f35,0x3e48250d,0x3f0e3ec4,0x3f7b3f80,0x3f553f6d
.long 0x0,0x0,0x0,0x0,0xbf55bf35,0xbf7bbf6d,0xbf0ebf35,0xbe48bec4
.long 0x3f6d3f80,0x3ec43f35,0xbf6dbf80,0xbec4bf35,0xbe48bf35,0x3f553ec4,0xbf7bbf35,0xbf0ebf6d
.long 0xbf35250d,0xbf35bf80,0xbf35250d,0xbf35bf80,0x3f7b3f35,0xbf0e3ec4,0xbe483f35,0xbf55bf6d
.long 0xbec4bf80,0x3f6d3f35,0x3ec43f80,0xbf6dbf35,0xbf0e3f35,0x3e48bf6d,0x3f553f35,0xbf7bbec4
.long 0x3f800000,0xbf80250d,0x3f800000,0xbf80250d,0xbf0ebf35,0x3e483f6d,0x3f55bf35,0xbf7b3ec4
.long 0xbec43f80,0x3f6dbf35,0x3ec4bf80,0xbf6d3f35,0x3f7bbf35,0xbf0ebec4,0xbe48bf35,0xbf553f6d
.long 0xbf35250d,0xbf353f80,0xbf35250d,0xbf353f80,0xbe483f35,0x3f55bec4,0xbf7b3f35,0xbf0e3f6d
.long 0x3f6dbf80,0x3ec4bf35,0xbf6d3f80,0xbec43f35,0xbf553f35,0xbf7b3f6d,0xbf0e3f35,0xbe483ec4
.long 0x250d0000,0x250d0000,0x250d0000,0x250d0000,0x3f55bf35,0x3f7bbf6d,0x3f0ebf35,0x3e48bec4
.long 0xbf6d3f80,0xbec43f35,0x3f6dbf80,0x3ec4bf35,0x3e48bf35,0xbf553ec4,0x3f7bbf35,0x3f0ebf6d
.long 0x3f35250d,0x3f35bf80,0x3f35250d,0x3f35bf80,0xbf7b3f35,0x3f0e3ec4,0x3e483f35,0x3f55bf6d
.long 0x3ec4bf80,0xbf6d3f35,0xbec43f80,0x3f6dbf35,0x3f0e3f35,0xbe48bf6d,0xbf553f35,0x3f7bbec4
.long 0xbf800000,0x3f80250d,0xbf800000,0x3f80250d,0x3f0ebf35,0xbe483f6d,0xbf55bf35,0x3f7b3ec4
.long 0x3ec43f80,0xbf6dbf35,0xbec4bf80,0x3f6d3f35,0xbf7bbf35,0x3f0ebec4,0x3e48bf35,0x3f553f6d
.long 0x3f35250d,0x3f353f80,0x3f35250d,0x3f353f80,0x3e483f35,0xbf55bec4,0x3f7b3f35,0x3f0e3f6d
.long 0xbf6dbf80,0xbec4bf35,0x3f6d3f80,0x3ec43f35,0x3f553f35,0x3f7b3f6d,0x3f0e3f35,0x3e483ec4
.long 0x3f800000,0x3f800000,0x3f800000,0x3f800000,0x3f800000,0x3f7fffb1,0x3f7ffec4,0x3f7ffd39
.long 0x3f800000,0x3f7ffec4,0x3f7ffb11,0x3f7ff4e6,0x3f800000,0x3f7ffd39,0x3f7ff4e6,0x3f7fe705
.long 0x3f800000,0x3f7ffb11,0x3f7fec43,0x3f7fd397,0x3f800000,0x3f7ff84a,0x3f7fe129,0x3f7fba9e
.long 0x3f800000,0x3f7ff4e6,0x3f7fd397,0x3f7f9c18,0x3f800000,0x3f7ff0e3,0x3f7fc38f,0x3f7f7808
.long 0x3f800000,0x3f7fec43,0x3f7fb10f,0x3f7f4e6d,0x3f800000,0x3f7fe705,0x3f7f9c18,0x3f7f1f49
.long 0x3f800000,0x3f7fe129,0x3f7f84ab,0x3f7eea9d,0x3f800000,0x3f7fdaaf,0x3f7f6ac7,0x3f7eb069
.long 0x3f800000,0x3f7fd397,0x3f7f4e6d,0x3f7e70b0,0x3f800000,0x3f7fcbe2,0x3f7f2f9d,0x3f7e2b72
.long 0x3f800000,0x3f7fc38f,0x3f7f0e58,0x3f7de0b1,0x3f800000,0x3f7fba9e,0x3f7eea9d,0x3f7d906e
.long 0x3f800000,0x3f7fb10f,0x3f7ec46d,0x3f7d3aac,0x3f800000,0x3f7fa6e3,0x3f7e9bc9,0x3f7cdf6c
.long 0x3f800000,0x3f7f9c18,0x3f7e70b0,0x3f7c7eb0,0x3f800000,0x3f7f90b1,0x3f7e4323,0x3f7c187a
.long 0x3f800000,0x3f7f84ab,0x3f7e1324,0x3f7baccd,0x3f800000,0x3f7f7808,0x3f7de0b1,0x3f7b3bab
.long 0x3f800000,0x3f7f6ac7,0x3f7dabcc,0x3f7ac516,0x3f800000,0x3f7f5ce9,0x3f7d7474,0x3f7a4910
.long 0x3f800000,0x3f7f4e6d,0x3f7d3aac,0x3f79c79d,0x3f800000,0x3f7f3f54,0x3f7cfe73,0x3f7940c0
.long 0x3f800000,0x3f7f2f9d,0x3f7cbfc9,0x3f78b47b,0x3f800000,0x3f7f1f49,0x3f7c7eb0,0x3f7822d1
.long 0x3f800000,0x3f7f0e58,0x3f7c3b28,0x3f778bc5,0x3f800000,0x3f7efcc9,0x3f7bf531,0x3f76ef5b
.long 0x3f800000,0x3f7eea9d,0x3f7baccd,0x3f764d97,0x3f800000,0x3f7ed7d4,0x3f7b61fc,0x3f75a67b
.long 0x3f800000,0x3f800000,0x3f800000,0x3f800000,0x3f7ffb11,0x3f7ff84a,0x3f7ff4e6,0x3f7ff0e3
.long 0x3f7fec43,0x3f7fe129,0x3f7fd397,0x3f7fc38f,0x3f7fd397,0x3f7fba9e,0x3f7f9c18,0x3f7f7808
.long 0x3f7fb10f,0x3f7f84ab,0x3f7f4e6d,0x3f7f0e58,0x3f7f84ab,0x3f7f3f54,0x3f7eea9d,0x3f7e868b
.long 0x3f7f4e6d,0x3f7eea9d,0x3f7e70b0,0x3f7de0b1,0x3f7f0e58,0x3f7e868b,0x3f7de0b1,0x3f7d1cdd
.long 0x3f7ec46d,0x3f7e1324,0x3f7d3aac,0x3f7c3b28,0x3f7e70b0,0x3f7d906e,0x3f7c7eb0,0x3f7b3bab
.long 0x3f7e1324,0x3f7cfe73,0x3f7baccd,0x3f7a1e84,0x3f7dabcc,0x3f7c5d3a,0x3f7ac516,0x3f78e3d6
.long 0x3f7d3aac,0x3f7baccd,0x3f79c79d,0x3f778bc5,0x3f7cbfc9,0x3f7aed37,0x3f78b47b,0x3f76167a
.long 0x3f7c3b28,0x3f7a1e84,0x3f778bc5,0x3f748422,0x3f7baccd,0x3f7940c0,0x3f764d97,0x3f72d4eb
.long 0x3f7b14be,0x3f7853f8,0x3f74fa0b,0x3f710908,0x3f7a7302,0x3f77583a,0x3f73913f,0x3f6f20b0
.long 0x3f79c79d,0x3f764d97,0x3f721352,0x3f6d1c1d,0x3f791298,0x3f75341d,0x3f708066,0x3f6afb8c
.long 0x3f7853f8,0x3f740bdd,0x3f6ed89e,0x3f68bf3c,0x3f778bc5,0x3f72d4eb,0x3f6d1c1d,0x3f666771
.long 0x3f76ba07,0x3f718f57,0x3f6b4b0c,0x3f63f473,0x3f75dec6,0x3f703b37,0x3f696591,0x3f61668a
.long 0x3f74fa0b,0x3f6ed89e,0x3f676bd8,0x3f5ebe05,0x3f740bdd,0x3f6d67a1,0x3f655e0b,0x3f5bfb34
.long 0x3f731447,0x3f6be858,0x3f633c5a,0x3f591e6a,0x3f721352,0x3f6a5ad9,0x3f6106f2,0x3f5627fe
.long 0x3f710908,0x3f68bf3c,0x3f5ebe05,0x3f531849,0x3f6ff573,0x3f671599,0x3f5c61c7,0x3f4fefa8
.long 0x3f6ed89e,0x3f655e0b,0x3f59f26a,0x3f4cae79,0x3f6db293,0x3f6398ac,0x3f577026,0x3f495521
.long 0x3f800000,0x3f800000,0x3f800000,0x3f800000,0x3f7fec43,0x3f7fe705,0x3f7fe129,0x3f7fdaaf
.long 0x3f7fb10f,0x3f7f9c18,0x3f7f84ab,0x3f7f6ac7,0x3f7f4e6d,0x3f7f1f49,0x3f7eea9d,0x3f7eb069
.long 0x3f7ec46d,0x3f7e70b0,0x3f7e1324,0x3f7dabcc,0x3f7e1324,0x3f7d906e,0x3f7cfe73,0x3f7c5d3a
.long 0x3f7d3aac,0x3f7c7eb0,0x3f7baccd,0x3f7ac516,0x3f7c3b28,0x3f7b3bab,0x3f7a1e84,0x3f78e3d6
.long 0x3f7b14be,0x3f79c79d,0x3f7853f8,0x3f76ba07,0x3f79c79d,0x3f7822d1,0x3f764d97,0x3f74484b
.long 0x3f7853f8,0x3f764d97,0x3f740bdd,0x3f718f57,0x3f76ba07,0x3f74484b,0x3f718f57,0x3f6e8ff8
.long 0x3f74fa0b,0x3f721352,0x3f6ed89e,0x3f6b4b0c,0x3f731447,0x3f6faf1b,0x3f6be858,0x3f67c187
.long 0x3f710908,0x3f6d1c1d,0x3f68bf3c,0x3f63f473,0x3f6ed89e,0x3f6a5ad9,0x3f655e0b,0x3f5fe4e9
.long 0x3f6c835e,0x3f676bd8,0x3f61c598,0x3f5b941a,0x3f6a09a7,0x3f644fac,0x3f5df6be,0x3f570348
.long 0x3f676bd8,0x3f6106f2,0x3f59f26a,0x3f5233c6,0x3f64aa59,0x3f5d924d,0x3f55b993,0x3f4d26fd
.long 0x3f61c598,0x3f59f26a,0x3f514d3d,0x3f47de65,0x3f5ebe05,0x3f5627fe,0x3f4cae79,0x3f425b89
.long 0x3f5b941a,0x3f5233c6,0x3f47de65,0x3f3ca003,0x3f584853,0x3f4e1689,0x3f42de29,0x3f36ad7f
.long 0x3f54db31,0x3f49d112,0x3f3daef9,0x3f3085bb,0x3f514d3d,0x3f456439,0x3f385216,0x3f2a2a80
.long 0x3f4d9f02,0x3f40d0da,0x3f32c8c9,0x3f239da9,0x3f49d112,0x3f3c17d9,0x3f2d1469,0x3f1ce11f
.long 0x3f45e403,0x3f373a23,0x3f273656,0x3f15f6d9,0x3f41d870,0x3f3238aa,0x3f212ff9,0x3f0ee0db
.long 0x3f3daef9,0x3f2d1469,0x3f1b02c6,0x3f07a136,0x3f396842,0x3f27ce61,0x3f14b039,0x3f003a06
.long 0x3f800000,0x3f800000,0x3f800000,0x3f800000,0x3f7fd397,0x3f7fcbe2,0x3f7fc38f,0x3f7fba9e
.long 0x3f7f4e6d,0x3f7f2f9d,0x3f7f0e58,0x3f7eea9d,0x3f7e70b0,0x3f7e2b72,0x3f7de0b1,0x3f7d906e
.long 0x3f7d3aac,0x3f7cbfc9,0x3f7c3b28,0x3f7baccd,0x3f7baccd,0x3f7aed37,0x3f7a1e84,0x3f7940c0
.long 0x3f79c79d,0x3f78b47b,0x3f778bc5,0x3f764d97,0x3f778bc5,0x3f76167a,0x3f748422,0x3f72d4eb
.long 0x3f74fa0b,0x3f731447,0x3f710908,0x3f6ed89e,0x3f721352,0x3f6faf1b,0x3f6d1c1d,0x3f6a5ad9
.long 0x3f6ed89e,0x3f6be858,0x3f68bf3c,0x3f655e0b,0x3f6b4b0c,0x3f67c187,0x3f63f473,0x3f5fe4e9
.long 0x3f676bd8,0x3f633c5a,0x3f5ebe05,0x3f59f26a,0x3f633c5a,0x3f5e5aa6,0x3f591e6a,0x3f5389c7
.long 0x3f5ebe05,0x3f591e6a,0x3f531849,0x3f4cae79,0x3f59f26a,0x3f5389c7,0x3f4cae79,0x3f456439
.long 0x3f54db31,0x3f4d9f02,0x3f45e403,0x3f3daef9,0x3f4f7a1f,0x3f476085,0x3f3ebc1b,0x3f3592e7
.long 0x3f49d112,0x3f40d0da,0x3f373a23,0x3f2d1469,0x3f43e200,0x3f39f2ac,0x3f2f61a5,0x3f24381a
.long 0x3f3daef9,0x3f32c8c9,0x3f273656,0x3f1b02c6,0x3f373a23,0x3f2b561b,0x3f1ebc12,0x3f11796b
.long 0x3f3085bb,0x3f239da9,0x3f15f6d9,0x3f07a136,0x3f299415,0x3f1ba299,0x3f0cead0,0x3efafef7
.long 0x3f226799,0x3f13682a,0x3f039c3d,0x3ee63375,0x3f1b02c6,0x3f0af1b7,0x3ef41f07,0x3ed0eb2a
.long 0x3f13682a,0x3f0242b1,0x3ee0924f,0x3ebb31a0,0x3f0b9a6b,0x3ef2bd43,0x3ecc9b8b,0x3ea5129f
.long 0x3f039c3d,0x3ee0924f,0x3eb8442a,0x3e8e9a22,0x3ef6e0cb,0x3ece0bea,0x3ea395c5,0x3e6fa8b2
.long 0x3ee63375,0x3ebb31a0,0x3e8e9a22,0x3e419b37,0x3ed53641,0x3ea80b1f,0x3e72b651,0x3e1324ca
.long 0x3f800000,0x3f800000,0x3f800000,0x3f800000,0x3f7fb10f,0x3f7fa6e3,0x3f7f9c18,0x3f7f90b1
.long 0x3f7ec46d,0x3f7e9bc9,0x3f7e70b0,0x3f7e4323,0x3f7d3aac,0x3f7cdf6c,0x3f7c7eb0,0x3f7c187a
.long 0x3f7b14be,0x3f7a7302,0x3f79c79d,0x3f791298,0x3f7853f8,0x3f77583a,0x3f764d97,0x3f75341d
.long 0x3f74fa0b,0x3f73913f,0x3f721352,0x3f708066,0x3f710908,0x3f6f20b0,0x3f6d1c1d,0x3f6afb8c
.long 0x3f6c835e,0x3f6a09a7,0x3f676bd8,0x3f64aa59,0x3f676bd8,0x3f644fac,0x3f6106f2,0x3f5d924d
.long 0x3f61c598,0x3f5df6be,0x3f59f26a,0x3f55b993,0x3f5b941a,0x3f570348,0x3f5233c6,0x3f4d26fd
.long 0x3f54db31,0x3f4f7a1f,0x3f49d112,0x3f43e200,0x3f4d9f02,0x3f476085,0x3f40d0da,0x3f39f2ac
.long 0x3f45e403,0x3f3ebc1b,0x3f373a23,0x3f2f61a5,0x3f3daef9,0x3f3592e7,0x3f2d1469,0x3f24381a
.long 0x3f3504f3,0x3f2beb4a,0x3f226799,0x3f187fc0,0x3f2beb4a,0x3f21cbfb,0x3f173c07,0x3f0c42c9
.long 0x3f226799,0x3f173c07,0x3f0b9a6b,0x3eff17b2,0x3f187fc0,0x3f0c42c9,0x3eff17b2,0x3ee4cbfe
.long 0x3f0e39da,0x3f00e7e4,0x3ee63375,0x3ec9b953,0x3f039c3d,0x3eea6681,0x3ecc9b8b,0x3eadf73c
.long 0x3ef15aea,0x3ed25a09,0x3eb263ef,0x3e919ddd,0x3edae880,0x3eb9bb1e,0x3e97a117,0x3e698bba
.long 0x3ec3ef15,0x3ea09ae5,0x3e78cfcc,0x3e2f10a2,0x3eac7cd4,0x3e870ada,0x3e419b37,0x3de7fa9a
.long 0x3e94a031,0x3e5a3997,0x3e09cf86,0x3d621469,0x3e78cfcc,0x3e25c58c,0x3da3308c,0xbb490fc6
.long 0x3e47c5c2,0x3de1bc2e,0x3cc90ab0,0xbd7b2b74,0x3e164083,0x3d6ea038,0xbcfb49ba,0xbdf475c0
.long 0x3dc8bd36,0x3bc90f88,0xbdafb680,0xbe354098,0x3d48fb30,0xbd3c6dd5,0xbe1008b7,0xbe6fa8b2
.long 0x3f800000,0x3f800000,0x3f800000,0x3f800000,0x3f7f84ab,0x3f7f7808,0x3f7f6ac7,0x3f7f5ce9
.long 0x3f7e1324,0x3f7de0b1,0x3f7dabcc,0x3f7d7474,0x3f7baccd,0x3f7b3bab,0x3f7ac516,0x3f7a4910
.long 0x3f7853f8,0x3f778bc5,0x3f76ba07,0x3f75dec6,0x3f740bdd,0x3f72d4eb,0x3f718f57,0x3f703b37
.long 0x3f6ed89e,0x3f6d1c1d,0x3f6b4b0c,0x3f696591,0x3f68bf3c,0x3f666771,0x3f63f473,0x3f61668a
.long 0x3f61c598,0x3f5ebe05,0x3f5b941a,0x3f584853,0x3f59f26a,0x3f5627fe,0x3f5233c6,0x3f4e1689
.long 0x3f514d3d,0x3f4cae79,0x3f47de65,0x3f42de29,0x3f47de65,0x3f425b89,0x3f3ca003,0x3f36ad7f
.long 0x3f3daef9,0x3f373a23,0x3f3085bb,0x3f299415,0x3f32c8c9,0x3f2b561b,0x3f239da9,0x3f1ba299
.long 0x3f273656,0x3f1ebc12,0x3f15f6d9,0x3f0cead0,0x3f1b02c6,0x3f11796b,0x3f07a136,0x3efafef7
.long 0x3f0e39da,0x3f039c3d,0x3ef15aea,0x3edae880,0x3f00e7e4,0x3eea6681,0x3ed25a09,0x3eb9bb1e
.long 0x3ee63375,0x3ecc9b8b,0x3eb263ef,0x3e97a117,0x3ec9b953,0x3eadf73c,0x3e919ddd,0x3e698bba
.long 0x3eac7cd4,0x3e8e9a22,0x3e605c13,0x3e22abb6,0x3e8e9a22,0x3e5d4b1a,0x3e1c76de,0x3db5f8da
.long 0x3e605c13,0x3e1c76de,0x3dafb680,0x3c96c9b6,0x3e22abb6,0x3db5f8da,0x3c96c9b6,0xbd55880e
.long 0x3dc8bd36,0x3cc90ab0,0xbd48fb30,0xbdfab273,0x3d16c32c,0xbd2351cb,0xbdee3876,0xbe44b0b9
.long 0xbcc90ab0,0xbdd53db9,0xbe3b6ecf,0xbe8586ce,0xbdafb680,0xbe2bf804,0xbe7ee6e1,0xbea80b1f
.long 0xbe164083,0xbe6c9a7f,0xbea09ae5,0xbec9b953,0xbe541501,0xbe9620d2,0xbec1071e,0xbeea6681
.long 0xbe888e93,0xbeb554ec,0xbee0924f,0xbf04f484,0xbea68f12,0xbed3c867,0xbeff17b2,0xbf140c5f
.long 0x3f800000,0x3f800000,0x3f800000,0x3f800000,0x3f7f4e6d,0x3f7f3f54,0x3f7f2f9d,0x3f7f1f49
.long 0x3f7d3aac,0x3f7cfe73,0x3f7cbfc9,0x3f7c7eb0,0x3f79c79d,0x3f7940c0,0x3f78b47b,0x3f7822d1
.long 0x3f74fa0b,0x3f740bdd,0x3f731447,0x3f721352,0x3f6ed89e,0x3f6d67a1,0x3f6be858,0x3f6a5ad9
.long 0x3f676bd8,0x3f655e0b,0x3f633c5a,0x3f6106f2,0x3f5ebe05,0x3f5bfb34,0x3f591e6a,0x3f5627fe
.long 0x3f54db31,0x3f514d3d,0x3f4d9f02,0x3f49d112,0x3f49d112,0x3f456439,0x3f40d0da,0x3f3c17d9
.long 0x3f3daef9,0x3f385216,0x3f32c8c9,0x3f2d1469,0x3f3085bb,0x3f2a2a80,0x3f239da9,0x3f1ce11f
.long 0x3f226799,0x3f1b02c6,0x3f13682a,0x3f0b9a6b,0x3f13682a,0x3f0af1b7,0x3f0242b1,0x3ef2bd43
.long 0x3f039c3d,0x3ef41f07,0x3ee0924f,0x3ecc9b8b,0x3ee63375,0x3ed0eb2a,0x3ebb31a0,0x3ea5129f
.long 0x3ec3ef15,0x3eac7cd4,0x3e94a031,0x3e78cfcc,0x3ea09ae5,0x3e870ada,0x3e5a3997,0x3e25c58c
.long 0x3e78cfcc,0x3e419b37,0x3e09cf86,0x3da3308c,0x3e2f10a2,0x3de7fa9a,0x3d621469,0xbb490fc6
.long 0x3dc8bd36,0x3d16c32c,0xbcc90ab0,0xbdafb680,0x3cc90ab0,0xbd2351cb,0xbdd53db9,0xbe2bf804
.long 0xbd48fb30,0xbdee3876,0xbe3b6ecf,0xbe7ee6e1,0xbdfab273,0xbe44b0b9,0xbe8586ce,0xbea80b1f
.long 0xbe47c5c2,0xbe888e93,0xbeac7cd4,0xbecf7bca,0xbe888e93,0xbeadf73c,0xbed25a09,0xbef58035
.long 0xbeac7cd4,0xbed25a09,0xbef6e0cb,0xbf0cead0,0xbecf7bca,0xbef58035,0xbf0cead0,0xbf1e1e22
.long 0xbef15aea,0xbf0b9a6b,0xbf1d7fd1,0xbf2e3bde,0xbf08f59b,0xbf1ba299,0xbf2d1469,0xbf3d27b8
.long 0xbf187fc0,0xbf2ac082,0xbf3b8f3b,0xbf4ac77f,0xbf273656,0xbf38dd65,0xbf48d8b3,0xbf570348
.long 0x3f800000,0x3f800000,0x3f800000,0x3f800000,0x3f7f0e58,0x3f7efcc9,0x3f7eea9d,0x3f7ed7d4
.long 0x3f7c3b28,0x3f7bf531,0x3f7baccd,0x3f7b61fc,0x3f778bc5,0x3f76ef5b,0x3f764d97,0x3f75a67b
.long 0x3f710908,0x3f6ff573,0x3f6ed89e,0x3f6db293,0x3f68bf3c,0x3f671599,0x3f655e0b,0x3f6398ac
.long 0x3f5ebe05,0x3f5c61c7,0x3f59f26a,0x3f577026,0x3f531849,0x3f4fefa8,0x3f4cae79,0x3f495521
.long 0x3f45e403,0x3f41d870,0x3f3daef9,0x3f396842,0x3f373a23,0x3f3238aa,0x3f2d1469,0x3f27ce61
.long 0x3f273656,0x3f212ff9,0x3f1b02c6,0x3f14b039,0x3f15f6d9,0x3f0ee0db,0x3f07a136,0x3f003a06
.long 0x3f039c3d,0x3ef6e0cb,0x3ee63375,0x3ed53641,0x3ee0924f,0x3ece0bea,0x3ebb31a0,0x3ea80b1f
.long 0x3eb8442a,0x3ea395c5,0x3e8e9a22,0x3e72b651,0x3e8e9a22,0x3e6fa8b2,0x3e419b37,0x3e1324ca
.long 0x3e47c5c2,0x3e164083,0x3dc8bd36,0x3d48fb30,0x3de1bc2e,0x3d6ea038,0x3bc90f88,0xbd3c6dd5
.long 0x3cc90ab0,0xbcfb49ba,0xbdafb680,0xbe1008b7,0xbd7b2b74,0xbdf475c0,0xbe354098,0xbe6fa8b2
.long 0xbe164083,0xbe541501,0xbe888e93,0xbea68f12,0xbe6c9a7f,0xbe9620d2,0xbeb554ec,0xbed3c867
.long 0xbea09ae5,0xbec1071e,0xbee0924f,0xbeff17b2,0xbec9b953,0xbeea6681,0xbf04f484,0xbf140c5f
.long 0xbef15aea,0xbf08f59b,0xbf187fc0,0xbf273656,0xbf0b9a6b,0xbf1ba299,0xbf2ac082,0xbf38dd65
.long 0xbf1d7fd1,0xbf2d1469,0xbf3b8f3b,0xbf48d8b3,0xbf2e3bde,0xbf3d27b8,0xbf4ac77f,0xbf570348
.long 0xbf3daef9,0xbf4bbbf8,0xbf584853,0xbf633c5a,0xbf4bbbf8,0xbf58b3a1,0xbf63f473,0xbf6d67a1
.long 0xbf584853,0xbf63f473,0xbf6db293,0xbf756d97,0xbf633c5a,0xbf6d67a1,0xbf756d97,0xbf7b3bab
.long 0x80000000,0x80000000,0x80000000,0x80000000,0x80000000,0xbb490fc6,0xbbc90f88,0xbc16cb58
.long 0x80000000,0xbbc90f88,0xbc490e90,0xbc96c9b6,0x80000000,0xbc16cb58,0xbc96c9b6,0xbce22a7a
.long 0x80000000,0xbc490e90,0xbcc90ab0,0xbd16c32c,0x80000000,0xbc7b514b,0xbcfb49ba,0xbd3c6dd5
.long 0x80000000,0xbc96c9b6,0xbd16c32c,0xbd621469,0x80000000,0xbcafea69,0xbd2fe007,0xbd83db0a
.long 0x80000000,0xbcc90ab0,0xbd48fb30,0xbd96a905,0x80000000,0xbce22a7a,0xbd621469,0xbda973ba
.long 0x80000000,0xbcfb49ba,0xbd7b2b74,0xbdbc3ac3,0x80000000,0xbd0a342f,0xbd8a200a,0xbdcefdb7
.long 0x80000000,0xbd16c32c,0xbd96a905,0xbde1bc2e,0x80000000,0xbd2351cb,0xbda3308c,0xbdf475c0
.long 0x80000000,0xbd2fe007,0xbdafb680,0xbe039502,0x80000000,0xbd3c6dd5,0xbdbc3ac3,0xbe0cec4a
.long 0x80000000,0xbd48fb30,0xbdc8bd36,0xbe164083,0x80000000,0xbd55880e,0xbdd53db9,0xbe1f917b
.long 0x80000000,0xbd621469,0xbde1bc2e,0xbe28defc,0x80000000,0xbd6ea038,0xbdee3876,0xbe3228d4
.long 0x80000000,0xbd7b2b74,0xbdfab273,0xbe3b6ecf,0x80000000,0xbd83db0a,0xbe039502,0xbe44b0b9
.long 0x80000000,0xbd8a200a,0xbe09cf86,0xbe4dee60,0x80000000,0xbd9064b4,0xbe1008b7,0xbe57278f
.long 0x80000000,0xbd96a905,0xbe164083,0xbe605c13,0x80000000,0xbd9cecf9,0xbe1c76de,0xbe698bba
.long 0x80000000,0xbda3308c,0xbe22abb6,0xbe72b651,0x80000000,0xbda973ba,0xbe28defc,0xbe7bdba4
.long 0x80000000,0xbdafb680,0xbe2f10a2,0xbe827dc0,0x80000000,0xbdb5f8da,0xbe354098,0xbe870ada
.long 0x80000000,0xbdbc3ac3,0xbe3b6ecf,0xbe8b9507,0x80000000,0xbdc27c39,0xbe419b37,0xbe901c2c
.long 0x80000000,0x80000000,0x80000000,0x80000000,0xbc490e90,0xbc7b514b,0xbc96c9b6,0xbcafea69
.long 0xbcc90ab0,0xbcfb49ba,0xbd16c32c,0xbd2fe007,0xbd16c32c,0xbd3c6dd5,0xbd621469,0xbd83db0a
.long 0xbd48fb30,0xbd7b2b74,0xbd96a905,0xbdafb680,0xbd7b2b74,0xbd9cecf9,0xbdbc3ac3,0xbddb7d37
.long 0xbd96a905,0xbdbc3ac3,0xbde1bc2e,0xbe039502,0xbdafb680,0xbddb7d37,0xbe039502,0xbe195be0
.long 0xbdc8bd36,0xbdfab273,0xbe164083,0xbe2f10a2,0xbde1bc2e,0xbe0cec4a,0xbe28defc,0xbe44b0b9
.long 0xbdfab273,0xbe1c76de,0xbe3b6ecf,0xbe5a3997,0xbe09cf86,0xbe2bf804,0xbe4dee60,0xbe6fa8b2
.long 0xbe164083,0xbe3b6ecf,0xbe605c13,0xbe827dc0,0xbe22abb6,0xbe4ada4f,0xbe72b651,0xbe8d17c0
.long 0xbe2f10a2,0xbe5a3997,0xbe827dc0,0xbe97a117,0xbe3b6ecf,0xbe698bba,0xbe8b9507,0xbea21887
.long 0xbe47c5c2,0xbe78cfcc,0xbe94a031,0xbeac7cd4,0xbe541501,0xbe840270,0xbe9d9e78,0xbeb6ccc3
.long 0xbe605c13,0xbe8b9507,0xbea68f12,0xbec1071e,0xbe6c9a7f,0xbe931f35,0xbeaf713a,0xbecb2aae
.long 0xbe78cfcc,0xbe9aa086,0xbeb8442a,0xbed53641,0xbe827dc0,0xbea21887,0xbec1071e,0xbedf28a9
.long 0xbe888e93,0xbea986c4,0xbec9b953,0xbee900b7,0xbe8e9a22,0xbeb0eacb,0xbed25a09,0xbef2bd43
.long 0xbe94a031,0xbeb8442a,0xbedae880,0xbefc5d27,0xbe9aa086,0xbebf926f,0xbee363fa,0xbf02ef9f
.long 0xbea09ae5,0xbec6d529,0xbeebcbbb,0xbf07a136,0xbea68f12,0xbece0bea,0xbef41f07,0xbf0c42c9
.long 0xbeac7cd4,0xbed53641,0xbefc5d27,0xbf10d3cd,0xbeb263ef,0xbedc53c1,0xbf0242b1,0xbf1553b7
.long 0xbeb8442a,0xbee363fa,0xbf064b82,0xbf19c200,0xbebe1d4a,0xbeea6681,0xbf0a48ad,0xbf1e1e22
.long 0x80000000,0x80000000,0x80000000,0x80000000,0xbcc90ab0,0xbce22a7a,0xbcfb49ba,0xbd0a342f
.long 0xbd48fb30,0xbd621469,0xbd7b2b74,0xbd8a200a,0xbd96a905,0xbda973ba,0xbdbc3ac3,0xbdcefdb7
.long 0xbdc8bd36,0xbde1bc2e,0xbdfab273,0xbe09cf86,0xbdfab273,0xbe0cec4a,0xbe1c76de,0xbe2bf804
.long 0xbe164083,0xbe28defc,0xbe3b6ecf,0xbe4dee60,0xbe2f10a2,0xbe44b0b9,0xbe5a3997,0xbe6fa8b2
.long 0xbe47c5c2,0xbe605c13,0xbe78cfcc,0xbe888e93,0xbe605c13,0xbe7bdba4,0xbe8b9507,0xbe9920fe
.long 0xbe78cfcc,0xbe8b9507,0xbe9aa086,0xbea986c4,0xbe888e93,0xbe9920fe,0xbea986c4,0xbeb9bb1e
.long 0xbe94a031,0xbea68f12,0xbeb8442a,0xbec9b953,0xbea09ae5,0xbeb3dca5,0xbec6d529,0xbed97cb9
.long 0xbeac7cd4,0xbec1071e,0xbed53641,0xbee900b7,0xbeb8442a,0xbece0bea,0xbee363fa,0xbef840c8
.long 0xbec3ef15,0xbedae880,0xbef15aea,0xbf039c3d,0xbecf7bca,0xbee79a5d,0xbeff17b2,0xbf0af1b7
.long 0xbedae880,0xbef41f07,0xbf064b82,0xbf121eb0,0xbee63375,0xbf003a06,0xbf0cead0,0xbf19210f
.long 0xbef15aea,0xbf064b82,0xbf13682a,0xbf1ff6cb,0xbefc5d27,0xbf0c42c9,0xbf19c200,0xbf269de3
.long 0xbf039c3d,0xbf121eb0,0xbf1ff6cb,0xbf2d1469,0xbf08f59b,0xbf17de12,0xbf26050a,0xbf33587a
.long 0xbf0e39da,0xbf1d7fd1,0xbf2beb4a,0xbf396842,0xbf13682a,0xbf2302d3,0xbf31a81d,0xbf3f41fc
.long 0xbf187fc0,0xbf286605,0xbf373a23,0xbf44e3f5,0xbf1d7fd1,0xbf2da859,0xbf3ca003,0xbf4a4c87
.long 0xbf226799,0xbf32c8c9,0xbf41d870,0xbf4f7a1f,0xbf273656,0xbf37c655,0xbf46e22a,0xbf546b3b
.long 0xbf2beb4a,0xbf3ca003,0xbf4bbbf8,0xbf591e6a,0xbf3085bb,0xbf4154e1,0xbf5064af,0xbf5d924d
.long 0x80000000,0x80000000,0x80000000,0x80000000,0xbd16c32c,0xbd2351cb,0xbd2fe007,0xbd3c6dd5
.long 0xbd96a905,0xbda3308c,0xbdafb680,0xbdbc3ac3,0xbde1bc2e,0xbdf475c0,0xbe039502,0xbe0cec4a
.long 0xbe164083,0xbe22abb6,0xbe2f10a2,0xbe3b6ecf,0xbe3b6ecf,0xbe4ada4f,0xbe5a3997,0xbe698bba
.long 0xbe605c13,0xbe72b651,0xbe827dc0,0xbe8b9507,0xbe827dc0,0xbe8d17c0,0xbe97a117,0xbea21887
.long 0xbe94a031,0xbea09ae5,0xbeac7cd4,0xbeb8442a,0xbea68f12,0xbeb3dca5,0xbec1071e,0xbece0bea
.long 0xbeb8442a,0xbec6d529,0xbed53641,0xbee363fa,0xbec9b953,0xbed97cb9,0xbee900b7,0xbef840c8
.long 0xbedae880,0xbeebcbbb,0xbefc5d27,0xbf064b82,0xbeebcbbb,0xbefdbabb,0xbf07a136,0xbf102dd5
.long 0xbefc5d27,0xbf07a136,0xbf10d3cd,0xbf19c200,0xbf064b82,0xbf102dd5,0xbf19c200,0xbf2302d3
.long 0xbf0e39da,0xbf187fc0,0xbf226799,0xbf2beb4a,0xbf15f6d9,0xbf209393,0xbf2ac082,0xbf34768f
.long 0xbf1d7fd1,0xbf286605,0xbf32c8c9,0xbf3ca003,0xbf24d225,0xbf2ff3e6,0xbf3a7ca4,0xbf446337
.long 0xbf2beb4a,0xbf373a23,0xbf41d870,0xbf4bbbf8,0xbf32c8c9,0xbf3e35c5,0xbf48d8b3,0xbf52a649
.long 0xbf396842,0xbf44e3f5,0xbf4f7a1f,0xbf591e6a,0xbf3fc767,0xbf4b41fa,0xbf55b993,0xbf5f20db
.long 0xbf45e403,0xbf514d3d,0xbf5b941a,0xbf64aa59,0xbf4bbbf8,0xbf570348,0xbf6106f2,0xbf69b7e4
.long 0xbf514d3d,0xbf5c61c7,0xbf660f88,0xbf6e46be,0xbf5695e5,0xbf61668a,0xbf6aab7b,0xbf725470
.long 0xbf5b941a,0xbf660f88,0xbf6ed89e,0xbf75dec6,0xbf604621,0xbf6a5ad9,0xbf7294f8,0xbf78e3d6
.long 0xbf64aa59,0xbf6e46be,0xbf75dec6,0xbf7b61fc,0xbf68bf3c,0xbf71d19f,0xbf78b47b,0xbf7d57de
.long 0x80000000,0x80000000,0x80000000,0x80000000,0xbd48fb30,0xbd55880e,0xbd621469,0xbd6ea038
.long 0xbdc8bd36,0xbdd53db9,0xbde1bc2e,0xbdee3876,0xbe164083,0xbe1f917b,0xbe28defc,0xbe3228d4
.long 0xbe47c5c2,0xbe541501,0xbe605c13,0xbe6c9a7f,0xbe78cfcc,0xbe840270,0xbe8b9507,0xbe931f35
.long 0xbe94a031,0xbe9d9e78,0xbea68f12,0xbeaf713a,0xbeac7cd4,0xbeb6ccc3,0xbec1071e,0xbecb2aae
.long 0xbec3ef15,0xbecf7bca,0xbedae880,0xbee63375,0xbedae880,0xbee79a5d,0xbef41f07,0xbf003a06
.long 0xbef15aea,0xbeff17b2,0xbf064b82,0xbf0cead0,0xbf039c3d,0xbf0af1b7,0xbf121eb0,0xbf19210f
.long 0xbf0e39da,0xbf15f6d9,0xbf1d7fd1,0xbf24d225,0xbf187fc0,0xbf209393,0xbf286605,0xbf2ff3e6
.long 0xbf226799,0xbf2ac082,0xbf32c8c9,0xbf3a7ca4,0xbf2beb4a,0xbf34768f,0xbf3ca003,0xbf446337
.long 0xbf3504f3,0xbf3daef9,0xbf45e403,0xbf4d9f02,0xbf3daef9,0xbf466354,0xbf4e8d90,0xbf5627fe
.long 0xbf45e403,0xbf4e8d90,0xbf5695e5,0xbf5df6be,0xbf4d9f02,0xbf5627fe,0xbf5df6be,0xbf650479
.long 0xbf54db31,0xbf5d2d53,0xbf64aa59,0xbf6b4b0c,0xbf5b941a,0xbf6398ac,0xbf6aab7b,0xbf70c501
.long 0xbf61c598,0xbf696591,0xbf6ff573,0xbf756d97,0xbf676bd8,0xbf6e8ff8,0xbf748422,0xbf7940c0
.long 0xbf6c835e,0xbf731447,0xbf7853f8,0xbf7c3b28,0xbf710908,0xbf76ef5b,0xbf7b61fc,0xbf7e5a38
.long 0xbf74fa0b,0xbf7a1e84,0xbf7dabcc,0xbf7f9c18,0xbf7853f8,0xbf7c9f8a,0xbf7f2f9d,0xbf7fffb1
.long 0xbf7b14be,0xbf7e70b0,0xbf7fec43,0xbf7f84ab,0xbf7d3aac,0xbf7f90b1,0xbf7fe129,0xbf7e2b72
.long 0xbf7ec46d,0xbf7ffec4,0xbf7f0e58,0xbf7bf531,0xbf7fb10f,0xbf7fba9e,0xbf7d7474,0xbf78e3d6
.long 0x80000000,0x80000000,0x80000000,0x80000000,0xbd7b2b74,0xbd83db0a,0xbd8a200a,0xbd9064b4
.long 0xbdfab273,0xbe039502,0xbe09cf86,0xbe1008b7,0xbe3b6ecf,0xbe44b0b9,0xbe4dee60,0xbe57278f
.long 0xbe78cfcc,0xbe827dc0,0xbe888e93,0xbe8e9a22,0xbe9aa086,0xbea21887,0xbea986c4,0xbeb0eacb
.long 0xbeb8442a,0xbec1071e,0xbec9b953,0xbed25a09,0xbed53641,0xbedf28a9,0xbee900b7,0xbef2bd43
.long 0xbef15aea,0xbefc5d27,0xbf039c3d,0xbf08f59b,0xbf064b82,0xbf0c42c9,0xbf121eb0,0xbf17de12
.long 0xbf13682a,0xbf19c200,0xbf1ff6cb,0xbf26050a,0xbf1ff6cb,0xbf269de3,0xbf2d1469,0xbf33587a
.long 0xbf2beb4a,0xbf32c8c9,0xbf396842,0xbf3fc767,0xbf373a23,0xbf3e35c5,0xbf44e3f5,0xbf4b41fa
.long 0xbf41d870,0xbf48d8b3,0xbf4f7a1f,0xbf55b993,0xbf4bbbf8,0xbf52a649,0xbf591e6a,0xbf5f20db
.long 0xbf54db31,0xbf5b941a,0xbf61c598,0xbf676bd8,0xbf5d2d53,0xbf6398ac,0xbf696591,0xbf6e8ff8
.long 0xbf64aa59,0xbf6aab7b,0xbf6ff573,0xbf748422,0xbf6b4b0c,0xbf70c501,0xbf756d97,0xbf7940c0
.long 0xbf710908,0xbf75dec6,0xbf79c79d,0xbf7cbfc9,0xbf75dec6,0xbf79f35e,0xbf7cfe73,0xbf7efcc9
.long 0xbf79c79d,0xbf7cfe73,0xbf7f0e58,0xbf7ff4e6,0xbf7cbfc9,0xbf7efcc9,0xbf7ff4e6,0xbf7fa6e3
.long 0xbf7ec46d,0xbf7fec43,0xbf7fb10f,0xbf7e1324,0xbf7fd397,0xbf7fcbe2,0xbf7e4323,0xbf7b3bab
.long 0xbf7fec43,0xbf7e9bc9,0xbf7baccd,0xbf772417,0xbf7f0e58,0xbf7c5d3a,0xbf77f110,0xbf71d19f
.long 0xbf7d3aac,0xbf791298,0xbf731447,0xbf6b4b0c,0xbf7a7302,0xbf74bf62,0xbf6d1c1d,0xbf6398ac
.long 0xbf76ba07,0xbf6f6830,0xbf660f88,0xbf5ac450,0xbf721352,0xbf6912ae,0xbf5df6be,0xbf50d937
.long 0x80000000,0x80000000,0x80000000,0x80000000,0xbd96a905,0xbd9cecf9,0xbda3308c,0xbda973ba
.long 0xbe164083,0xbe1c76de,0xbe22abb6,0xbe28defc,0xbe605c13,0xbe698bba,0xbe72b651,0xbe7bdba4
.long 0xbe94a031,0xbe9aa086,0xbea09ae5,0xbea68f12,0xbeb8442a,0xbebf926f,0xbec6d529,0xbece0bea
.long 0xbedae880,0xbee363fa,0xbeebcbbb,0xbef41f07,0xbefc5d27,0xbf02ef9f,0xbf07a136,0xbf0c42c9
.long 0xbf0e39da,0xbf13682a,0xbf187fc0,0xbf1d7fd1,0xbf1d7fd1,0xbf2302d3,0xbf286605,0xbf2da859
.long 0xbf2beb4a,0xbf31a81d,0xbf373a23,0xbf3ca003,0xbf396842,0xbf3f41fc,0xbf44e3f5,0xbf4a4c87
.long 0xbf45e403,0xbf4bbbf8,0xbf514d3d,0xbf5695e5,0xbf514d3d,0xbf570348,0xbf5c61c7,0xbf61668a
.long 0xbf5b941a,0xbf6106f2,0xbf660f88,0xbf6aab7b,0xbf64aa59,0xbf69b7e4,0xbf6e46be,0xbf725470
.long 0xbf6c835e,0xbf710908,0xbf74fa0b,0xbf7853f8,0xbf731447,0xbf76ef5b,0xbf7a1e84,0xbf7c9f8a
.long 0xbf7853f8,0xbf7b61fc,0xbf7dabcc,0xbf7f2f9d,0xbf7c3b28,0xbf7e5a38,0xbf7f9c18,0xbf7fffb1
.long 0xbf7ec46d,0xbf7fd397,0xbf7fec43,0xbf7f0e58,0xbf7fec43,0xbf7fcbe2,0xbf7e9bc9,0xbf7c5d3a
.long 0xbf7fb10f,0xbf7e4323,0xbf7baccd,0xbf77f110,0xbf7e1324,0xbf7b3bab,0xbf772417,0xbf71d19f
.long 0xbf7b14be,0xbf76ba07,0xbf710908,0xbf6a09a7,0xbf76ba07,0xbf70c501,0xbf696591,0xbf60a6cf
.long 0xbf710908,0xbf696591,0xbf604621,0xbf55b993,0xbf6a09a7,0xbf60a6cf,0xbf55b993,0xbf495521
.long 0xbf61c598,0xbf5695e5,0xbf49d112,0xbf3b8f3b,0xbf584853,0xbf4b41fa,0xbf3ca003,0xbf2c800f
.long 0xbf4d9f02,0xbf3ebc1b,0xbf2e3bde,0xbf1c420c,0xbf41d870,0xbf311722,0xbf1ebc12,0xbf0af1b7
.long 0x80000000,0x80000000,0x80000000,0x80000000,0xbdafb680,0xbdb5f8da,0xbdbc3ac3,0xbdc27c39
.long 0xbe2f10a2,0xbe354098,0xbe3b6ecf,0xbe419b37,0xbe827dc0,0xbe870ada,0xbe8b9507,0xbe901c2c
.long 0xbeac7cd4,0xbeb263ef,0xbeb8442a,0xbebe1d4a,0xbed53641,0xbedc53c1,0xbee363fa,0xbeea6681
.long 0xbefc5d27,0xbf0242b1,0xbf064b82,0xbf0a48ad,0xbf10d3cd,0xbf1553b7,0xbf19c200,0xbf1e1e22
.long 0xbf226799,0xbf273656,0xbf2beb4a,0xbf3085bb,0xbf32c8c9,0xbf37c655,0xbf3ca003,0xbf4154e1
.long 0xbf41d870,0xbf46e22a,0xbf4bbbf8,0xbf5064af,0xbf4f7a1f,0xbf546b3b,0xbf591e6a,0xbf5d924d
.long 0xbf5b941a,0xbf604621,0xbf64aa59,0xbf68bf3c,0xbf660f88,0xbf6a5ad9,0xbf6e46be,0xbf71d19f
.long 0xbf6ed89e,0xbf7294f8,0xbf75dec6,0xbf78b47b,0xbf75dec6,0xbf78e3d6,0xbf7b61fc,0xbf7d57de
.long 0xbf7b14be,0xbf7d3aac,0xbf7ec46d,0xbf7fb10f,0xbf7e70b0,0xbf7f90b1,0xbf7ffec4,0xbf7fba9e
.long 0xbf7fec43,0xbf7fe129,0xbf7f0e58,0xbf7d7474,0xbf7f84ab,0xbf7e2b72,0xbf7bf531,0xbf78e3d6
.long 0xbf7d3aac,0xbf7a7302,0xbf76ba07,0xbf721352,0xbf791298,0xbf74bf62,0xbf6f6830,0xbf6912ae
.long 0xbf731447,0xbf6d1c1d,0xbf660f88,0xbf5df6be,0xbf6b4b0c,0xbf6398ac,0xbf5ac450,0xbf50d937
.long 0xbf61c598,0xbf584853,0xbf4d9f02,0xbf41d870,0xbf5695e5,0xbf4b41fa,0xbf3ebc1b,0xbf311722
.long 0xbf49d112,0xbf3ca003,0xbf2e3bde,0xbf1ebc12,0xbf3b8f3b,0xbf2c800f,0xbf1c420c,0xbf0af1b7
.long 0xbf2beb4a,0xbf1b02c6,0xbf08f59b,0xbeebcbbb,0xbf1b02c6,0xbf084b92,0xbee900b7,0xbebf926f
.long 0xbf08f59b,0xbee900b7,0xbebe1d4a,0xbe919ddd,0xbeebcbbb,0xbebf926f,0xbe919ddd,0xbe44b0b9
.long 0x3f800000,0x3f7ec46d,0x3f7b14be,0x3f74fa0b,0x3f800000,0x3f7eb069,0x3f7ac516,0x3f74484b
.long 0x3f800000,0x3f7e9bc9,0x3f7a7302,0x3f73913f,0x3f800000,0x3f7e868b,0x3f7a1e84,0x3f72d4eb
.long 0x3f800000,0x3f7e70b0,0x3f79c79d,0x3f721352,0x3f800000,0x3f7e5a38,0x3f796e4e,0x3f714c7a
.long 0x3f800000,0x3f7e4323,0x3f791298,0x3f708066,0x3f800000,0x3f7e2b72,0x3f78b47b,0x3f6faf1b
.long 0x3f800000,0x3f7e1324,0x3f7853f8,0x3f6ed89e,0x3f800000,0x3f7dfa38,0x3f77f110,0x3f6dfcf2
.long 0x3f800000,0x3f7de0b1,0x3f778bc5,0x3f6d1c1d,0x3f800000,0x3f7dc68c,0x3f772417,0x3f6c3624
.long 0x3f800000,0x3f7dabcc,0x3f76ba07,0x3f6b4b0c,0x3f800000,0x3f7d906e,0x3f764d97,0x3f6a5ad9
.long 0x3f800000,0x3f7d7474,0x3f75dec6,0x3f696591,0x3f800000,0x3f7d57de,0x3f756d97,0x3f686b39
.long 0x3f800000,0x3f7d3aac,0x3f74fa0b,0x3f676bd8,0x3f800000,0x3f7d1cdd,0x3f748422,0x3f666771
.long 0x3f800000,0x3f7cfe73,0x3f740bdd,0x3f655e0b,0x3f800000,0x3f7cdf6c,0x3f73913f,0x3f644fac
.long 0x3f800000,0x3f7cbfc9,0x3f731447,0x3f633c5a,0x3f800000,0x3f7c9f8a,0x3f7294f8,0x3f62241a
.long 0x3f800000,0x3f7c7eb0,0x3f721352,0x3f6106f2,0x3f800000,0x3f7c5d3a,0x3f718f57,0x3f5fe4e9
.long 0x3f800000,0x3f7c3b28,0x3f710908,0x3f5ebe05,0x3f800000,0x3f7c187a,0x3f708066,0x3f5d924d
.long 0x3f800000,0x3f7bf531,0x3f6ff573,0x3f5c61c7,0x3f800000,0x3f7bd14d,0x3f6f6830,0x3f5b2c79
.long 0x3f800000,0x3f7baccd,0x3f6ed89e,0x3f59f26a,0x3f800000,0x3f7b87b2,0x3f6e46be,0x3f58b3a1
.long 0x3f800000,0x3f7b61fc,0x3f6db293,0x3f577026,0x3f800000,0x3f7b3bab,0x3f6d1c1d,0x3f5627fe
.long 0x3f6c835e,0x3f61c598,0x3f54db31,0x3f45e403,0x3f6b4b0c,0x3f5fe4e9,0x3f5233c6,0x3f425b89
.long 0x3f6a09a7,0x3f5df6be,0x3f4f7a1f,0x3f3ebc1b,0x3f68bf3c,0x3f5bfb34,0x3f4cae79,0x3f3b0629
.long 0x3f676bd8,0x3f59f26a,0x3f49d112,0x3f373a23,0x3f660f88,0x3f57dc7f,0x3f46e22a,0x3f33587a
.long 0x3f64aa59,0x3f55b993,0x3f43e200,0x3f2f61a5,0x3f633c5a,0x3f5389c7,0x3f40d0da,0x3f2b561b
.long 0x3f61c598,0x3f514d3d,0x3f3daef9,0x3f273656,0x3f604621,0x3f4f0417,0x3f3a7ca4,0x3f2302d3
.long 0x3f5ebe05,0x3f4cae79,0x3f373a23,0x3f1ebc12,0x3f5d2d53,0x3f4a4c87,0x3f33e7bc,0x3f1a6293
.long 0x3f5b941a,0x3f47de65,0x3f3085bb,0x3f15f6d9,0x3f59f26a,0x3f456439,0x3f2d1469,0x3f11796b
.long 0x3f584853,0x3f42de29,0x3f299415,0x3f0cead0,0x3f5695e5,0x3f404c5c,0x3f26050a,0x3f084b92
.long 0x3f54db31,0x3f3daef9,0x3f226799,0x3f039c3d,0x3f531849,0x3f3b0629,0x3f1ebc12,0x3efdbabb
.long 0x3f514d3d,0x3f385216,0x3f1b02c6,0x3ef41f07,0x3f4f7a1f,0x3f3592e7,0x3f173c07,0x3eea6681
.long 0x3f4d9f02,0x3f32c8c9,0x3f13682a,0x3ee0924f,0x3f4bbbf8,0x3f2ff3e6,0x3f0f8784,0x3ed6a399
.long 0x3f49d112,0x3f2d1469,0x3f0b9a6b,0x3ecc9b8b,0x3f47de65,0x3f2a2a80,0x3f07a136,0x3ec27b55
.long 0x3f45e403,0x3f273656,0x3f039c3d,0x3eb8442a,0x3f43e200,0x3f24381a,0x3eff17b2,0x3eadf73c
.long 0x3f41d870,0x3f212ff9,0x3ef6e0cb,0x3ea395c5,0x3f3fc767,0x3f1e1e22,0x3eee9479,0x3e9920fe
.long 0x3f3daef9,0x3f1b02c6,0x3ee63375,0x3e8e9a22,0x3f3b8f3b,0x3f17de12,0x3eddbe79,0x3e840270
.long 0x3f396842,0x3f14b039,0x3ed53641,0x3e72b651,0x3f373a23,0x3f11796b,0x3ecc9b8b,0x3e5d4b1a
.long 0x3f3504f3,0x3f226799,0x3f0e39da,0x3ef15aea,0x3f3085bb,0x3f1ce11f,0x3f07a136,0x3ee1fb6a
.long 0x3f2beb4a,0x3f173c07,0x3f00e7e4,0x3ed25a09,0x3f273656,0x3f11796b,0x3ef41f07,0x3ec27b55
.long 0x3f226799,0x3f0b9a6b,0x3ee63375,0x3eb263ef,0x3f1d7fd1,0x3f05a02c,0x3ed8106b,0x3ea21887
.long 0x3f187fc0,0x3eff17b2,0x3ec9b953,0x3e919ddd,0x3f13682a,0x3ef2bd43,0x3ebb31a0,0x3e80f8c0
.long 0x3f0e39da,0x3ee63375,0x3eac7cd4,0x3e605c13,0x3f08f59b,0x3ed97cb9,0x3e9d9e78,0x3e3e853e
.long 0x3f039c3d,0x3ecc9b8b,0x3e8e9a22,0x3e1c76de,0x3efc5d27,0x3ebf926f,0x3e7ee6e1,0x3df475c0
.long 0x3ef15aea,0x3eb263ef,0x3e605c13,0x3dafb680,0x3ee63375,0x3ea5129f,0x3e419b37,0x3d55880e
.long 0x3edae880,0x3e97a117,0x3e22abb6,0x3c96c9b6,0x3ecf7bca,0x3e8a11f7,0x3e039502,0xbc7b514b
.long 0x3ec3ef15,0x3e78cfcc,0x3dc8bd36,0xbd48fb30,0x3eb8442a,0x3e5d4b1a,0x3d8a200a,0xbda973ba
.long 0x3eac7cd4,0x3e419b37,0x3d16c32c,0xbdee3876,0x3ea09ae5,0x3e25c58c,0x3bc90f88,0xbe195be0
.long 0x3e94a031,0x3e09cf86,0xbcc90ab0,0xbe3b6ecf,0x3e888e93,0x3ddb7d37,0xbd621469,0xbe5d4b1a
.long 0x3e78cfcc,0x3da3308c,0xbdafb680,0xbe7ee6e1,0x3e605c13,0x3d55880e,0xbdee3876,0xbe901c2c
.long 0x3e47c5c2,0x3cc90ab0,0xbe164083,0xbea09ae5,0x3e2f10a2,0xbb490fc6,0xbe354098,0xbeb0eacb
.long 0x3e164083,0xbcfb49ba,0xbe541501,0xbec1071e,0x3dfab273,0xbd6ea038,0xbe72b651,0xbed0eb2a
.long 0x3dc8bd36,0xbdafb680,0xbe888e93,0xbee0924f,0x3d96a905,0xbde7fa9a,0xbe97a117,0xbeeff7fb
.long 0x3d48fb30,0xbe1008b7,0xbea68f12,0xbeff17b2,0x3cc90ab0,0xbe2bf804,0xbeb554ec,0xbf06f686
.long 0x3ec3ef15,0x3e94a031,0x3e47c5c2,0x3dc8bd36,0x3eb263ef,0x3e80f8c0,0x3e1c76de,0x3d55880e
.long 0x3ea09ae5,0x3e5a3997,0x3de1bc2e,0x3bc90f88,0x3e8e9a22,0x3e3228d4,0x3d8a200a,0xbd2351cb
.long 0x3e78cfcc,0x3e09cf86,0x3cc90ab0,0xbdafb680,0x3e541501,0x3dc27c39,0xbc96c9b6,0xbe06b26e
.long 0x3e2f10a2,0x3d621469,0xbd7b2b74,0xbe354098,0x3e09cf86,0x3c7b514b,0xbdd53db9,0xbe636c83
.long 0x3dc8bd36,0xbcc90ab0,0xbe164083,0xbe888e93,0x3d7b2b74,0xbd83db0a,0xbe419b37,0xbe9f1cdf
.long 0x3cc90ab0,0xbdd53db9,0xbe6c9a7f,0xbeb554ec,0xbc490e90,0xbe1324ca,0xbe8b9507,0xbecb2aae
.long 0xbd48fb30,0xbe3b6ecf,0xbea09ae5,0xbee0924f,0xbdafb680,0xbe636c83,0xbeb554ec,0xbef58035
.long 0xbdfab273,0xbe8586ce,0xbec9b953,0xbf04f484,0xbe22abb6,0xbe9920fe,0xbeddbe79,0xbf0ee0db
.long 0xbe47c5c2,0xbeac7cd4,0xbef15aea,0xbf187fc0,0xbe6c9a7f,0xbebf926f,0xbf0242b1,0xbf21cbfb
.long 0xbe888e93,0xbed25a09,0xbf0b9a6b,0xbf2ac082,0xbe9aa086,0xbee4cbfe,0xbf14b039,0xbf33587a
.long 0xbeac7cd4,0xbef6e0cb,0xbf1d7fd1,0xbf3b8f3b,0xbebe1d4a,0xbf044889,0xbf26050a,0xbf436051
.long 0xbecf7bca,0xbf0cead0,0xbf2e3bde,0xbf4ac77f,0xbee0924f,0xbf1553b7,0xbf36206c,0xbf51c0c2
.long 0xbef15aea,0xbf1d7fd1,0xbf3daef9,0xbf584853,0xbf00e7e4,0xbf256bcb,0xbf44e3f5,0xbf5e5aa6
.long 0xbf08f59b,0xbf2d1469,0xbf4bbbf8,0xbf63f473,0xbf10d3cd,0xbf34768f,0xbf5233c6,0xbf6912ae
.long 0xbf187fc0,0xbf3b8f3b,0xbf584853,0xbf6db293,0xbf1ff6cb,0xbf425b89,0xbf5df6be,0xbf71d19f
.long 0xbf273656,0xbf48d8b3,0xbf633c5a,0xbf756d97,0xbf2e3bde,0xbf4f0417,0xbf6816a8,0xbf788486
.long 0x248d3132,0xbdc8bd36,0xbe47c5c2,0xbe94a031,0xbd48fb30,0xbe195be0,0xbe7ee6e1,0xbeb0eacb
.long 0xbdc8bd36,0xbe4dee60,0xbe9aa086,0xbecc9b8b,0xbe164083,0xbe80f8c0,0xbeb554ec,0xbee79a5d
.long 0xbe47c5c2,0xbe9aa086,0xbecf7bca,0xbf00e7e4,0xbe78cfcc,0xbeb3dca5,0xbee900b7,0xbf0d9281
.long 0xbe94a031,0xbecc9b8b,0xbf00e7e4,0xbf19c200,0xbeac7cd4,0xbee4cbfe,0xbf0cead0,0xbf256bcb
.long 0xbec3ef15,0xbefc5d27,0xbf187fc0,0xbf3085bb,0xbedae880,0xbf099f4e,0xbf239da9,0xbf3b0629
.long 0xbef15aea,0xbf14b039,0xbf2e3bde,0xbf44e3f5,0xbf039c3d,0xbf1f599f,0xbf385216,0xbf4e1689
.long 0xbf0e39da,0xbf299415,0xbf41d870,0xbf5695e5,0xbf187fc0,0xbf33587a,0xbf4ac77f,0xbf5e5aa6
.long 0xbf226799,0xbf3ca003,0xbf531849,0xbf655e0b,0xbf2beb4a,0xbf456439,0xbf5ac450,0xbf6b99fb
.long 0xbf3504f3,0xbf4d9f02,0xbf61c598,0xbf710908,0xbf3daef9,0xbf554aa4,0xbf6816a8,0xbf75a67b
.long 0xbf45e403,0xbf5c61c7,0xbf6db293,0xbf796e4e,0xbf4d9f02,0xbf62df7b,0xbf7294f8,0xbf7c5d3a
.long 0xbf54db31,0xbf68bf3c,0xbf76ba07,0xbf7e70b0,0xbf5b941a,0xbf6dfcf2,0xbf7a1e84,0xbf7fa6e3
.long 0xbf61c598,0xbf7294f8,0xbf7cbfc9,0xbf7ffec4,0xbf676bd8,0xbf76841b,0xbf7e9bc9,0xbf7f7808
.long 0xbf6c835e,0xbf79c79d,0xbf7fb10f,0xbf7e1324,0xbf710908,0xbf7c5d3a,0xbf7ffec4,0xbf7bd14d
.long 0xbf74fa0b,0xbf7e4323,0xbf7f84ab,0xbf78b47b,0xbf7853f8,0xbf7f7808,0xbf7e4323,0xbf74bf62
.long 0xbf7b14be,0xbf7ffb11,0xbf7c3b28,0xbf6ff573,0xbf7d3aac,0xbf7fcbe2,0xbf796e4e,0xbf6a5ad9
.long 0xbf7ec46d,0xbf7eea9d,0xbf75dec6,0xbf63f473,0xbf7fb10f,0xbf7d57de,0xbf718f57,0xbf5cc7d1
.long 0xbec3ef15,0xbef15aea,0xbf0e39da,0xbf226799,0xbee0924f,0xbf06f686,0xbf1c420c,0xbf2ff3e6
.long 0xbefc5d27,0xbf14b039,0xbf299415,0xbf3ca003,0xbf0b9a6b,0xbf21cbfb,0xbf36206c,0xbf485bca
.long 0xbf187fc0,0xbf2e3bde,0xbf41d870,0xbf531849,0xbf24d225,0xbf39f2ac,0xbf4cae79,0xbf5cc7d1
.long 0xbf3085bb,0xbf44e3f5,0xbf5695e5,0xbf655e0b,0xbf3b8f3b,0xbf4f0417,0xbf5f8327,0xbf6cd007
.long 0xbf45e403,0xbf584853,0xbf676bd8,0xbf731447,0xbf4f7a1f,0xbf60a6cf,0xbf6e46be,0xbf7822d1
.long 0xbf584853,0xbf6816a8,0xbf740bdd,0xbf7bf531,0xbf604621,0xbf6e8ff8,0xbf78b47b,0xbf7e868b
.long 0xbf676bd8,0xbf740bdd,0xbf7c3b28,0xbf7fd397,0xbf6db293,0xbf788486,0xbf7e9bc9,0xbf7fdaaf
.long 0xbf731447,0xbf7bf531,0xbf7fd397,0xbf7e9bc9,0xbf778bc5,0xbf7e5a38,0xbf7fe129,0xbf7c187a
.long 0xbf7b14be,0xbf7fb10f,0xbf7ec46d,0xbf7853f8,0xbf7dabcc,0xbf7ff84a,0xbf7c7eb0,0xbf73530e
.long 0xbf7f4e6d,0xbf7f2f9d,0xbf791298,0xbf6d1c1d,0xbf7ffb11,0xbf7d57de,0xbf748422,0xbf65b710
.long 0xbf7fb10f,0xbf7a7302,0xbf6ed89e,0xbf5d2d53,0xbf7e70b0,0xbf76841b,0xbf6816a8,0xbf5389c7
.long 0xbf7c3b28,0xbf718f57,0xbf604621,0xbf48d8b3,0xbf791298,0xbf6b99fb,0xbf577026,0xbf3d27b8
.long 0xbf74fa0b,0xbf64aa59,0xbf4d9f02,0xbf3085bb,0xbf6ff573,0xbf5cc7d1,0xbf42de29,0xbf2302d3
.long 0xbf6a09a7,0xbf53fac3,0xbf373a23,0xbf14b039,0xbf633c5a,0xbf4a4c87,0xbf2ac082,0xbf05a02c
.long 0xbf5b941a,0xbf3fc767,0xbf1d7fd1,0xbeebcbbb,0xbf531849,0xbf34768f,0xbf0f8784,0xbecb2aae
.long 0xbf49d112,0xbf286605,0xbf00e7e4,0xbea986c4,0xbf3fc767,0xbf1ba299,0xbee363fa,0xbe870ada
.long 0xbf3504f3,0xbf45e403,0xbf54db31,0xbf61c598,0xbf41d870,0xbf51c0c2,0xbf5f8327,0xbf6afb8c
.long 0xbf4d9f02,0xbf5c61c7,0xbf68bf3c,0xbf7294f8,0xbf584853,0xbf65b710,0xbf708066,0xbf788486
.long 0xbf61c598,0xbf6db293,0xbf76ba07,0xbf7cbfc9,0xbf6a09a7,0xbf74484b,0xbf7b61fc,0xbf7f3f54
.long 0xbf710908,0xbf796e4e,0xbf7e70b0,0xbf7ffec4,0xbf76ba07,0xbf7d1cdd,0xbf7fe129,0xbf7efcc9
.long 0xbf7b14be,0xbf7f4e6d,0xbf7fb10f,0xbf7c3b28,0xbf7e1324,0xbf7fffb1,0xbf7de0b1,0xbf77beb7
.long 0xbf7fb10f,0xbf7f2f9d,0xbf7a7302,0xbf718f57,0xbf7fec43,0xbf7cdf6c,0xbf756d97,0xbf69b7e4
.long 0xbf7ec46d,0xbf791298,0xbf6ed89e,0xbf604621,0xbf7c3b28,0xbf73ced9,0xbf66becc,0xbf554aa4
.long 0xbf7853f8,0xbf6d1c1d,0xbf5d2d53,0xbf48d8b3,0xbf731447,0xbf650479,0xbf5233c6,0xbf3b0629
.long 0xbf6c835e,0xbf5b941a,0xbf45e403,0xbf2beb4a,0xbf64aa59,0xbf50d937,0xbf385216,0xbf1ba299
.long 0xbf5b941a,0xbf44e3f5,0xbf299415,0xbf0a48ad,0xbf514d3d,0xbf37c655,0xbf19c200,0xbeeff7fb
.long 0xbf45e403,0xbf299415,0xbf08f59b,0xbec9b953,0xbf396842,0xbf1a6293,0xbeee9479,0xbea21887
.long 0xbf2beb4a,0xbf0a48ad,0xbec9b953,0xbe72b651,0xbf1d7fd1,0xbef2bd43,0xbea395c5,0xbe1f917b
.long 0xbf0e39da,0xbecf7bca,0xbe78cfcc,0xbd96a905,0xbefc5d27,0xbeab0201,0xbe28defc,0x3c16cb58
.long 0xbedae880,0xbe8586ce,0xbdafb680,0x3dbc3ac3,0xbeb8442a,0xbe3e853e,0xbbc90f88,0x3e3228d4
.long 0xbe94a031,0xbde1bc2e,0x3d96a905,0x3e827dc0,0xbe605c13,0xbd0a342f,0x3e1c76de,0x3eab0201
.long 0xbe164083,0x3d2fe007,0x3e6c9a7f,0x3ed25a09,0xbd96a905,0x3df475c0,0x3e9d9e78,0x3ef840c8
.long 0xbf6c835e,0xbf74fa0b,0xbf7b14be,0xbf7ec46d,0xbf740bdd,0xbf7a9c59,0xbf7e9bc9,0xbf7fffb1
.long 0xbf79c79d,0xbf7e4323,0xbf7ffb11,0xbf7eea9d,0xbf7dabcc,0xbf7fe705,0xbf7f2f9d,0xbf7b87b2
.long 0xbf7fb10f,0xbf7f84ab,0xbf7c3b28,0xbf75dec6,0xbf7fd397,0xbf7d1cdd,0xbf772417,0xbf6dfcf2
.long 0xbf7e1324,0xbf78b47b,0xbf6ff573,0xbf63f473,0xbf7a7302,0xbf725470,0xbf66becc,0xbf57dc7f
.long 0xbf74fa0b,0xbf6a09a7,0xbf5b941a,0xbf49d112,0xbf6db293,0xbf5fe4e9,0xbf4e8d90,0xbf39f2ac
.long 0xbf64aa59,0xbf53fac3,0xbf3fc767,0xbf286605,0xbf59f26a,0xbf466354,0xbf2f61a5,0xbf1553b7
.long 0xbf4d9f02,0xbf373a23,0xbf1d7fd1,0xbf00e7e4,0xbf3fc767,0xbf269de3,0xbf0a48ad,0xbed6a399
.long 0xbf3085bb,0xbf14b039,0xbeebcbbb,0xbea986c4,0xbf1ff6cb,0xbf019573,0xbec1071e,0xbe75c35a
.long 0xbf0e39da,0xbedae880,0xbe94a031,0xbe164083,0xbef6e0cb,0xbeb0eacb,0xbe4dee60,0xbd55880e
.long 0xbecf7bca,0xbe8586ce,0xbde1bc2e,0x3d2fe007,0xbea68f12,0xbe3228d4,0xbc96c9b6,0x3e0cec4a
.long 0xbe78cfcc,0xbdafb680,0x3d96a905,0x3e6c9a7f,0xbe22abb6,0x3b490fc6,0x3e28defc,0x3ea5129f
.long 0xbd96a905,0x3dbc3ac3,0x3e827dc0,0x3ed25a09,0x3c490e90,0x3e3857ec,0x3eaf713a,0x3efdbabb
.long 0x3dc8bd36,0x3e888e93,0x3edae880,0x3f13682a,0x3e3b6ecf,0x3eb3dca5,0x3f0242b1,0x3f269de3
.long 0x3e888e93,0x3eddbe79,0x3f15f6d9,0x3f385216,0x3eb263ef,0x3f02ef9f,0x3f286605,0x3f485bca
.long 0x3edae880,0x3f15f6d9,0x3f396842,0x3f5695e5,0x3f00e7e4,0x3f27ce61,0x3f48d8b3,0x3f62df7b
.long 0x3f13682a,0x3f385216,0x3f5695e5,0x3f6d1c1d,0x3f24d225,0x3f476085,0x3f628210,0x3f75341d
.long 0x80000000,0xbdc8bd36,0xbe47c5c2,0xbe94a031,0x80000000,0xbdcefdb7,0xbe4dee60,0xbe9920fe
.long 0x80000000,0xbdd53db9,0xbe541501,0xbe9d9e78,0x80000000,0xbddb7d37,0xbe5a3997,0xbea21887
.long 0x80000000,0xbde1bc2e,0xbe605c13,0xbea68f12,0x80000000,0xbde7fa9a,0xbe667c66,0xbeab0201
.long 0x80000000,0xbdee3876,0xbe6c9a7f,0xbeaf713a,0x80000000,0xbdf475c0,0xbe72b651,0xbeb3dca5
.long 0x80000000,0xbdfab273,0xbe78cfcc,0xbeb8442a,0x80000000,0xbe007745,0xbe7ee6e1,0xbebca7af
.long 0x80000000,0xbe039502,0xbe827dc0,0xbec1071e,0x80000000,0xbe06b26e,0xbe8586ce,0xbec5625c
.long 0x80000000,0xbe09cf86,0xbe888e93,0xbec9b953,0x80000000,0xbe0cec4a,0xbe8b9507,0xbece0bea
.long 0x80000000,0xbe1008b7,0xbe8e9a22,0xbed25a09,0x80000000,0xbe1324ca,0xbe919ddd,0xbed6a399
.long 0x80000000,0xbe164083,0xbe94a031,0xbedae880,0x80000000,0xbe195be0,0xbe97a117,0xbedf28a9
.long 0x80000000,0xbe1c76de,0xbe9aa086,0xbee363fa,0x80000000,0xbe1f917b,0xbe9d9e78,0xbee79a5d
.long 0x80000000,0xbe22abb6,0xbea09ae5,0xbeebcbbb,0x80000000,0xbe25c58c,0xbea395c5,0xbeeff7fb
.long 0x80000000,0xbe28defc,0xbea68f12,0xbef41f07,0x80000000,0xbe2bf804,0xbea986c4,0xbef840c8
.long 0x80000000,0xbe2f10a2,0xbeac7cd4,0xbefc5d27,0x80000000,0xbe3228d4,0xbeaf713a,0xbf003a06
.long 0x80000000,0xbe354098,0xbeb263ef,0xbf0242b1,0x80000000,0xbe3857ec,0xbeb554ec,0xbf044889
.long 0x80000000,0xbe3b6ecf,0xbeb8442a,0xbf064b82,0x80000000,0xbe3e853e,0xbebb31a0,0xbf084b92
.long 0x80000000,0xbe419b37,0xbebe1d4a,0xbf0a48ad,0x80000000,0xbe44b0b9,0xbec1071e,0xbf0c42c9
.long 0xbec3ef15,0xbef15aea,0xbf0e39da,0xbf226799,0xbec9b953,0xbef840c8,0xbf121eb0,0xbf269de3
.long 0xbecf7bca,0xbeff17b2,0xbf15f6d9,0xbf2ac082,0xbed53641,0xbf02ef9f,0xbf19c200,0xbf2ecef7
.long 0xbedae880,0xbf064b82,0xbf1d7fd1,0xbf32c8c9,0xbee0924f,0xbf099f4e,0xbf212ff9,0xbf36ad7f
.long 0xbee63375,0xbf0cead0,0xbf24d225,0xbf3a7ca4,0xbeebcbbb,0xbf102dd5,0xbf286605,0xbf3e35c5
.long 0xbef15aea,0xbf13682a,0xbf2beb4a,0xbf41d870,0xbef6e0cb,0xbf16999f,0xbf2f61a5,0xbf456439
.long 0xbefc5d27,0xbf19c200,0xbf32c8c9,0xbf48d8b3,0xbf00e7e4,0xbf1ce11f,0xbf36206c,0xbf4c3578
.long 0xbf039c3d,0xbf1ff6cb,0xbf396842,0xbf4f7a1f,0xbf064b82,0xbf2302d3,0xbf3ca003,0xbf52a649
.long 0xbf08f59b,0xbf26050a,0xbf3fc767,0xbf55b993,0xbf0b9a6b,0xbf28fd41,0xbf42de29,0xbf58b3a1
.long 0xbf0e39da,0xbf2beb4a,0xbf45e403,0xbf5b941a,0xbf10d3cd,0xbf2ecef7,0xbf48d8b3,0xbf5e5aa6
.long 0xbf13682a,0xbf31a81d,0xbf4bbbf8,0xbf6106f2,0xbf15f6d9,0xbf34768f,0xbf4e8d90,0xbf6398ac
.long 0xbf187fc0,0xbf373a23,0xbf514d3d,0xbf660f88,0xbf1b02c6,0xbf39f2ac,0xbf53fac3,0xbf686b39
.long 0xbf1d7fd1,0xbf3ca003,0xbf5695e5,0xbf6aab7b,0xbf1ff6cb,0xbf3f41fc,0xbf591e6a,0xbf6cd007
.long 0xbf226799,0xbf41d870,0xbf5b941a,0xbf6ed89e,0xbf24d225,0xbf446337,0xbf5df6be,0xbf70c501
.long 0xbf273656,0xbf46e22a,0xbf604621,0xbf7294f8,0xbf299415,0xbf495521,0xbf628210,0xbf74484b
.long 0xbf2beb4a,0xbf4bbbf8,0xbf64aa59,0xbf75dec6,0xbf2e3bde,0xbf4e1689,0xbf66becc,0xbf77583a
.long 0xbf3085bb,0xbf5064af,0xbf68bf3c,0xbf78b47b,0xbf32c8c9,0xbf52a649,0xbf6aab7b,0xbf79f35e
.long 0xbf3504f3,0xbf45e403,0xbf54db31,0xbf61c598,0xbf396842,0xbf4a4c87,0xbf591e6a,0xbf65b710
.long 0xbf3daef9,0xbf4e8d90,0xbf5d2d53,0xbf696591,0xbf41d870,0xbf52a649,0xbf6106f2,0xbf6cd007
.long 0xbf45e403,0xbf5695e5,0xbf64aa59,0xbf6ff573,0xbf49d112,0xbf5a5ba0,0xbf6816a8,0xbf72d4eb
.long 0xbf4d9f02,0xbf5df6be,0xbf6b4b0c,0xbf756d97,0xbf514d3d,0xbf61668a,0xbf6e46be,0xbf77beb7
.long 0xbf54db31,0xbf64aa59,0xbf710908,0xbf79c79d,0xbf584853,0xbf67c187,0xbf73913f,0xbf7b87b2
.long 0xbf5b941a,0xbf6aab7b,0xbf75dec6,0xbf7cfe73,0xbf5ebe05,0xbf6d67a1,0xbf77f110,0xbf7e2b72
.long 0xbf61c598,0xbf6ff573,0xbf79c79d,0xbf7f0e58,0xbf64aa59,0xbf725470,0xbf7b61fc,0xbf7fa6e3
.long 0xbf676bd8,0xbf748422,0xbf7cbfc9,0xbf7ff4e6,0xbf6a09a7,0xbf76841b,0xbf7de0b1,0xbf7ff84a
.long 0xbf6c835e,0xbf7853f8,0xbf7ec46d,0xbf7fb10f,0xbf6ed89e,0xbf79f35e,0xbf7f6ac7,0xbf7f1f49
.long 0xbf710908,0xbf7b61fc,0xbf7fd397,0xbf7e4323,0xbf731447,0xbf7c9f8a,0xbf7ffec4,0xbf7d1cdd
.long 0xbf74fa0b,0xbf7dabcc,0xbf7fec43,0xbf7baccd,0xbf76ba07,0xbf7e868b,0xbf7f9c18,0xbf79f35e
.long 0xbf7853f8,0xbf7f2f9d,0xbf7f0e58,0xbf77f110,0xbf79c79d,0xbf7fa6e3,0xbf7e4323,0xbf75a67b
.long 0xbf7b14be,0xbf7fec43,0xbf7d3aac,0xbf731447,0xbf7c3b28,0xbf7fffb1,0xbf7bf531,0xbf703b37
.long 0xbf7d3aac,0xbf7fe129,0xbf7a7302,0xbf6d1c1d,0xbf7e1324,0xbf7f90b1,0xbf78b47b,0xbf69b7e4
.long 0xbf7ec46d,0xbf7f0e58,0xbf76ba07,0xbf660f88,0xbf7f4e6d,0xbf7e5a38,0xbf748422,0xbf62241a
.long 0xbf7fb10f,0xbf7d7474,0xbf721352,0xbf5df6be,0xbf7fec43,0xbf7c5d3a,0xbf6f6830,0xbf5988ad
.long 0xbf6c835e,0xbf74fa0b,0xbf7b14be,0xbf7ec46d,0xbf6ff573,0xbf77beb7,0xbf7cfe73,0xbf7fa6e3
.long 0xbf731447,0xbf7a1e84,0xbf7e70b0,0xbf7ffec4,0xbf75dec6,0xbf7c187a,0xbf7f6ac7,0xbf7fcbe2
.long 0xbf7853f8,0xbf7dabcc,0xbf7fec43,0xbf7f0e58,0xbf7a7302,0xbf7ed7d4,0xbf7ff4e6,0xbf7dc68c
.long 0xbf7c3b28,0xbf7f9c18,0xbf7f84ab,0xbf7bf531,0xbf7dabcc,0xbf7ff84a,0xbf7e9bc9,0xbf799b43
.long 0xbf7ec46d,0xbf7fec43,0xbf7d3aac,0xbf76ba07,0xbf7f84ab,0xbf7f7808,0xbf7b61fc,0xbf73530e
.long 0xbf7fec43,0xbf7e9bc9,0xbf791298,0xbf6f6830,0xbf7ffb11,0xbf7d57de,0xbf764d97,0xbf6afb8c
.long 0xbf7fb10f,0xbf7baccd,0xbf731447,0xbf660f88,0xbf7f0e58,0xbf799b43,0xbf6f6830,0xbf60a6cf
.long 0xbf7e1324,0xbf772417,0xbf6b4b0c,0xbf5ac450,0xbf7cbfc9,0xbf74484b,0xbf66becc,0xbf546b3b
.long 0xbf7b14be,0xbf710908,0xbf61c598,0xbf4d9f02,0xbf791298,0xbf6d67a1,0xbf5c61c7,0xbf466354
.long 0xbf76ba07,0xbf696591,0xbf5695e5,0xbf3ebc1b,0xbf740bdd,0xbf650479,0xbf5064af,0xbf36ad7f
.long 0xbf710908,0xbf604621,0xbf49d112,0xbf2e3bde,0xbf6db293,0xbf5b2c79,0xbf42de29,0xbf256bcb
.long 0xbf6a09a7,0xbf55b993,0xbf3b8f3b,0xbf1c420c,0xbf660f88,0xbf4fefa8,0xbf33e7bc,0xbf12c39a
.long 0xbf61c598,0xbf49d112,0xbf2beb4a,0xbf08f59b,0xbf5d2d53,0xbf436051,0xbf239da9,0xbefdbabb
.long 0xbf584853,0xbf3ca003,0xbf1b02c6,0xbee900b7,0xbf531849,0xbf3592e7,0xbf121eb0,0xbed3c867
.long 0xbf4d9f02,0xbf2e3bde,0xbf08f59b,0xbebe1d4a,0xbf47de65,0xbf269de3,0xbeff17b2,0xbea80b1f
.long 0xbf41d870,0xbf1ebc12,0xbeebcbbb,0xbe919ddd,0xbf3b8f3b,0xbf16999f,0xbed8106b,0xbe75c35a
.long 0xbf800000,0xbf7ec46d,0xbf7b14be,0xbf74fa0b,0xbf7fb10f,0xbf7d1cdd,0xbf77f110,0xbf703b37
.long 0xbf7ec46d,0xbf7ac516,0xbf740bdd,0xbf6aab7b,0xbf7d3aac,0xbf77beb7,0xbf6f6830,0xbf644fac
.long 0xbf7b14be,0xbf740bdd,0xbf6a09a7,0xbf5d2d53,0xbf7853f8,0xbf6faf1b,0xbf63f473,0xbf554aa4
.long 0xbf74fa0b,0xbf6aab7b,0xbf5d2d53,0xbf4cae79,0xbf710908,0xbf650479,0xbf55b993,0xbf436051
.long 0xbf6c835e,0xbf5ebe05,0xbf4d9f02,0xbf396842,0xbf676bd8,0xbf57dc7f,0xbf44e3f5,0xbf2ecef7
.long 0xbf61c598,0xbf5064af,0xbf3b8f3b,0xbf239da9,0xbf5b941a,0xbf485bca,0xbf31a81d,0xbf17de12
.long 0xbf54db31,0xbf3fc767,0xbf273656,0xbf0b9a6b,0xbf4d9f02,0xbf36ad7f,0xbf1c420c,0xbefdbabb
.long 0xbf45e403,0xbf2d1469,0xbf10d3cd,0xbee363fa,0xbf3daef9,0xbf2302d3,0xbf04f484,0xbec8477c
.long 0xbf3504f3,0xbf187fc0,0xbef15aea,0xbeac7cd4,0xbf2beb4a,0xbf0d9281,0xbed8106b,0xbe901c2c
.long 0xbf226799,0xbf0242b1,0xbebe1d4a,0xbe667c66,0xbf187fc0,0xbeed3063,0xbea395c5,0xbe2bf804
.long 0xbf0e39da,0xbed53641,0xbe888e93,0xbde1bc2e,0xbf039c3d,0xbebca7af,0xbe5a3997,0xbd55880e
.long 0xbef15aea,0xbea395c5,0xbe22abb6,0x3bc90f88,0xbedae880,0xbe8a11f7,0xbdd53db9,0x3d83db0a
.long 0xbec3ef15,0xbe605c13,0xbd48fb30,0x3dfab273,0xbeac7cd4,0xbe2bf804,0x3bc90f88,0x3e3857ec
.long 0xbe94a031,0xbdee3876,0x3d7b2b74,0x3e72b651,0xbe78cfcc,0xbd83db0a,0x3dee3876,0x3e9620d2
.long 0xbe47c5c2,0xbc490e90,0x3e2f10a2,0x3eb263ef,0xbe164083,0x3d2351cb,0x3e667c66,0x3ece0bea
.long 0xbdc8bd36,0x3dbc3ac3,0x3e8e9a22,0x3ee900b7,0xbd48fb30,0x3e1324ca,0x3ea986c4,0x3f019573
.long 0xbf6c835e,0xbf61c598,0xbf54db31,0xbf45e403,0xbf660f88,0xbf5988ad,0xbf4ac77f,0xbf39f2ac
.long 0xbf5ebe05,0xbf5064af,0xbf3fc767,0xbf2d1469,0xbf5695e5,0xbf466354,0xbf33e7bc,0xbf1f599f
.long 0xbf4d9f02,0xbf3b8f3b,0xbf273656,0xbf10d3cd,0xbf43e200,0xbf2ff3e6,0xbf19c200,0xbf019573
.long 0xbf396842,0xbf239da9,0xbf0b9a6b,0xbee363fa,0xbf2e3bde,0xbf16999f,0xbef9a02d,0xbec27b55
.long 0xbf226799,0xbf08f59b,0xbedae880,0xbea09ae5,0xbf15f6d9,0xbef58035,0xbebb31a0,0xbe7bdba4
.long 0xbf08f59b,0xbed8106b,0xbe9aa086,0xbe354098,0xbef6e0cb,0xbeb9bb1e,0xbe72b651,0xbddb7d37
.long 0xbedae880,0xbe9aa086,0xbe2f10a2,0xbd16c32c,0xbebe1d4a,0xbe75c35a,0xbdd53db9,0x3d0a342f
.long 0xbea09ae5,0xbe354098,0xbd16c32c,0x3dd53db9,0xbe827dc0,0xbde7fa9a,0x3cfb49ba,0x3e3228d4
.long 0xbe47c5c2,0xbd48fb30,0x3dc8bd36,0x3e78cfcc,0xbe09cf86,0x3c7b514b,0x3e28defc,0x3e9f1cdf
.long 0xbd96a905,0x3da3308c,0x3e6c9a7f,0x3ec1071e,0xbc490e90,0x3e1324ca,0x3e97a117,0x3ee1fb6a
.long 0x3d48fb30,0x3e541501,0x3eb8442a,0x3f00e7e4,0x3de1bc2e,0x3e8a11f7,0x3ed8106b,0x3f102dd5
.long 0x3e2f10a2,0x3ea986c4,0x3ef6e0cb,0x3f1ebc12,0x3e6c9a7f,0x3ec8477c,0x3f0a48ad,0x3f2c800f
.long 0x3e94a031,0x3ee63375,0x3f187fc0,0x3f396842,0x3eb263ef,0x3f019573,0x3f26050a,0x3f456439
.long 0x3ecf7bca,0x3f0f8784,0x3f32c8c9,0x3f5064af,0x3eebcbbb,0x3f1ce11f,0x3f3ebc1b,0x3f5a5ba0
.long 0x3f039c3d,0x3f299415,0x3f49d112,0x3f633c5a,0x3f10d3cd,0x3f3592e7,0x3f53fac3,0x3f6afb8c
.long 0x3f1d7fd1,0x3f40d0da,0x3f5d2d53,0x3f718f57,0x3f299415,0x3f4b41fa,0x3f655e0b,0x3f76ef5b
.long 0xbf3504f3,0xbf226799,0xbf0e39da,0xbef15aea,0xbf273656,0xbf12c39a,0xbef9a02d,0xbecb2aae
.long 0xbf187fc0,0xbf0242b1,0xbed53641,0xbea395c5,0xbf08f59b,0xbee1fb6a,0xbeaf713a,0xbe75c35a
.long 0xbef15aea,0xbebe1d4a,0xbe888e93,0xbe22abb6,0xbecf7bca,0xbe9920fe,0xbe419b37,0xbd9cecf9
.long 0xbeac7cd4,0xbe667c66,0xbde1bc2e,0x3bc90f88,0xbe888e93,0xbe195be0,0xbcfb49ba,0x3db5f8da
.long 0xbe47c5c2,0xbd96a905,0x3d48fb30,0x3e2f10a2,0xbdfab273,0x3b490fc6,0x3e039502,0x3e80f8c0
.long 0xbd48fb30,0x3da3308c,0x3e541501,0x3ea986c4,0x3cc90ab0,0x3e1f917b,0x3e919ddd,0x3ed0eb2a
.long 0x3dc8bd36,0x3e6c9a7f,0x3eb8442a,0x3ef6e0cb,0x3e2f10a2,0x3e9c1faf,0x3eddbe79,0x3f0d9281
.long 0x3e78cfcc,0x3ec1071e,0x3f00e7e4,0x3f1ebc12,0x3ea09ae5,0x3ee4cbfe,0x3f121eb0,0x3f2ecef7
.long 0x3ec3ef15,0x3f039c3d,0x3f226799,0x3f3daef9,0x3ee63375,0x3f140c5f,0x3f31a81d,0x3f4b41fa
.long 0x3f039c3d,0x3f239da9,0x3f3fc767,0x3f577026,0x3f13682a,0x3f3238aa,0x3f4cae79,0x3f62241a
.long 0x3f226799,0x3f3fc767,0x3f584853,0x3f6b4b0c,0x3f3085bb,0x3f4c3578,0x3f628210,0x3f72d4eb
.long 0x3f3daef9,0x3f577026,0x3f6b4b0c,0x3f78b47b,0x3f49d112,0x3f61668a,0x3f7294f8,0x3f7cdf6c
.long 0x3f54db31,0x3f6a09a7,0x3f7853f8,0x3f7f4e6d,0x3f5ebe05,0x3f714c7a,0x3f7c7eb0,0x3f7ffd39
.long 0x3f676bd8,0x3f772417,0x3f7f0e58,0x3f7eea9d,0x3f6ed89e,0x3f7b87b2,0x3f7ffec4,0x3f7c187a
.long 0x3f74fa0b,0x3f7e70b0,0x3f7f4e6d,0x3f778bc5,0x3f79c79d,0x3f7fdaaf,0x3f7cfe73,0x3f714c7a
.long 0x3f7d3aac,0x3f7fc38f,0x3f791298,0x3f696591,0x3f7f4e6d,0x3f7e2b72,0x3f73913f,0x3f5fe4e9
.long 0xbec3ef15,0xbe94a031,0xbe47c5c2,0xbdc8bd36,0xbe9aa086,0xbe5101f1,0xbdd53db9,0xbb490fc6
.long 0xbe605c13,0xbdee3876,0xbc490e90,0x3dbc3ac3,0xbe09cf86,0xbce22a7a,0x3da3308c,0x3e3e853e
.long 0xbd48fb30,0x3d7b2b74,0x3e2f10a2,0x3e8e9a22,0x3d16c32c,0x3e195be0,0x3e8586ce,0x3ebca7af
.long 0x3dfab273,0x3e72b651,0x3eb263ef,0x3ee900b7,0x3e541501,0x3ea5129f,0x3eddbe79,0x3f099f4e
.long 0x3e94a031,0x3ecf7bca,0x3f039c3d,0x3f1d7fd1,0x3ebe1d4a,0x3ef840c8,0x3f173c07,0x3f2ff3e6
.long 0x3ee63375,0x3f0f8784,0x3f299415,0x3f40d0da,0x3f064b82,0x3f21cbfb,0x3f3a7ca4,0x3f4fefa8
.long 0x3f187fc0,0x3f32c8c9,0x3f49d112,0x3f5d2d53,0x3f299415,0x3f425b89,0x3f577026,0x3f686b39
.long 0x3f396842,0x3f5064af,0x3f633c5a,0x3f718f57,0x3f47de65,0x3f5cc7d1,0x3f6d1c1d,0x3f788486
.long 0x3f54db31,0x3f676bd8,0x3f74fa0b,0x3f7d3aac,0x3f604621,0x3f703b37,0x3f7ac516,0x3f7fa6e3
.long 0x3f6a09a7,0x3f772417,0x3f7e70b0,0x3f7fc38f,0x3f721352,0x3f7c187a,0x3f7ff4e6,0x3f7d906e
.long 0x3f7853f8,0x3f7f0e58,0x3f7f4e6d,0x3f791298,0x3f7cbfc9,0x3f7fffb1,0x3f7c7eb0,0x3f725470
.long 0x3f7f4e6d,0x3f7eea9d,0x3f778bc5,0x3f696591,0x3f7ffb11,0x3f7bd14d,0x3f708066,0x3f5e5aa6
.long 0x3f7ec46d,0x3f76ba07,0x3f676bd8,0x3f514d3d,0x3f7baccd,0x3f6faf1b,0x3f5c61c7,0x3f425b89
.long 0x3f76ba07,0x3f66becc,0x3f4f7a1f,0x3f31a81d,0x3f6ff573,0x3f5bfb34,0x3f40d0da,0x3f1f599f
.long 0x3f676bd8,0x3f4f7a1f,0x3f3085bb,0x3f0b9a6b,0x3f5d2d53,0x3f4154e1,0x3f1ebc12,0x3eed3063
.long 0x3f514d3d,0x3f31a81d,0x3f0b9a6b,0x3ec1071e,0x3f43e200,0x3f209393,0x3eee9479,0x3e931f35
.long 0x3f800000,0x80000000,0x3f7ec46d,0xbdc8bd36,0x3f7b14be,0xbe47c5c2,0x3f74fa0b,0xbe94a031
.long 0x3f6c835e,0xbec3ef15,0x3f61c598,0xbef15aea,0x3f54db31,0xbf0e39da,0x3f45e403,0xbf226799
.long 0x3f3504f3,0xbf3504f3,0x3f226799,0xbf45e403,0x3f0e39da,0xbf54db31,0x3ef15aea,0xbf61c598
.long 0x3ec3ef15,0xbf6c835e,0x3e94a031,0xbf74fa0b,0x3e47c5c2,0xbf7b14be,0x3dc8bd36,0xbf7ec46d
.long 0x248d3132,0xbf800000,0xbdc8bd36,0xbf7ec46d,0xbe47c5c2,0xbf7b14be,0xbe94a031,0xbf74fa0b
.long 0xbec3ef15,0xbf6c835e,0xbef15aea,0xbf61c598,0xbf0e39da,0xbf54db31,0xbf226799,0xbf45e403
.long 0xbf3504f3,0xbf3504f3,0xbf45e403,0xbf226799,0xbf54db31,0xbf0e39da,0xbf61c598,0xbef15aea
.long 0xbf6c835e,0xbec3ef15,0xbf74fa0b,0xbe94a031,0xbf7b14be,0xbe47c5c2,0xbf7ec46d,0xbdc8bd36
.long 0x3f800000,0x80000000,0x3f7ec46d,0xbdc8bd36,0x3f7b14be,0xbe47c5c2,0x3f74fa0b,0xbe94a031
.long 0x3f6c835e,0xbec3ef15,0x3f61c598,0xbef15aea,0x3f54db31,0xbf0e39da,0x3f45e403,0xbf226799
.long 0x3f3504f3,0xbf3504f3,0x3f226799,0xbf45e403,0x3f0e39da,0xbf54db31,0x3ef15aea,0xbf61c598
.long 0x3ec3ef15,0xbf6c835e,0x3e94a031,0xbf74fa0b,0x3e47c5c2,0xbf7b14be,0x3dc8bd36,0xbf7ec46d
.long 0x248d3132,0xbf800000,0xbdc8bd36,0xbf7ec46d,0xbe47c5c2,0xbf7b14be,0xbe94a031,0xbf74fa0b
.long 0xbec3ef15,0xbf6c835e,0xbef15aea,0xbf61c598,0xbf0e39da,0xbf54db31,0xbf226799,0xbf45e403
.long 0xbf3504f3,0xbf3504f3,0xbf45e403,0xbf226799,0xbf54db31,0xbf0e39da,0xbf61c598,0xbef15aea
.long 0xbf6c835e,0xbec3ef15,0xbf74fa0b,0xbe94a031,0xbf7b14be,0xbe47c5c2,0xbf7ec46d,0xbdc8bd36
.size fft_table, 23040
```
